```python
import torch

def _softmax(x, axis=-1):
    return torch.softmax(x, dim=axis)
def _gelu(x):
    return torch.nn.functional.gelu(x, approximate="tanh")
def _silu(x):
    return torch.nn.functional.silu(x)
def _sigmoid(x):
    return torch.sigmoid(x)
def _layernorm(x, axis=-1, eps=1e-5):
    m = x.mean(dim=axis, keepdim=True)
    v = x.var(dim=axis, keepdim=True, unbiased=False)
    return (x - m) / torch.sqrt(v + eps)
def _scatter_add(tgt, idx, src, axis=0):
    return tgt.clone().index_add_(axis, idx, src)
def _segment_sum(src, seg, n):
    out = torch.zeros((n,) + src.shape[1:], dtype=src.dtype)
    return out.index_add_(0, seg, src)
def _pad(x, pw):
    flat = tuple(v for pair in reversed(pw) for v in pair)
    return torch.nn.functional.pad(x, flat)

kernel_name = 'sequential_preLN__linear_kernel_hedgehog__mixer_s_mlp__prompt'

def setup_inputs():

    _w = (lambda a: (lambda t: t.to(torch.bfloat16) if t.is_floating_point() else t)(torch.as_tensor(a)))
    def _A_setup():
        B, S, D, H = 1, 2048, 640, 32
        Dh = D // H
        return {
            "x": _w((lambda *s: torch.randn(*s, dtype=torch.bfloat16) * 0.05)(B, S, D)),
            "wqkv": _w((lambda *s: torch.randn(*s, dtype=torch.bfloat16) * 0.2)(D, 3 * D)),
            "w_phi": _w((lambda *s: torch.randn(*s, dtype=torch.bfloat16) * 0.2)(H, Dh, Dh) * (Dh ** -0.5)),
            "wo": _w((lambda *s: torch.randn(*s, dtype=torch.bfloat16) * 0.05)(D, D)),
        }
    _A_in = _A_setup()

    def _B_setup():
        B, S, D, F = 1, 2048, 640, 1536
        return {
            "x":  _w((lambda *s: torch.randn(*s, dtype=torch.bfloat16) * 0.05)(B, S, D)),
            "w1": _w((lambda *s: torch.randn(*s, dtype=torch.bfloat16) * 3.2)(D, D) * (D ** -0.5)),
            "w2": _w((lambda *s: torch.randn(*s, dtype=torch.bfloat16) * 3.2)(D, D) * (D ** -0.5)),
            "w3": _w((lambda *s: torch.randn(*s, dtype=torch.bfloat16) * 3.2)(D, F) * (D ** -0.5)),
            "w4": _w((lambda *s: torch.randn(*s, dtype=torch.bfloat16) * 3.2)(F, D) * (F ** -0.5)),
        }
    _B_in = _B_setup()

    return {
        "A_x": _A_in["x"],
        "A_wqkv": _A_in["wqkv"],
        "A_w_phi": _A_in["w_phi"],
        "A_wo": _A_in["wo"],
        "B_x": _B_in["x"],
        "B_w1": _B_in["w1"],
        "B_w2": _B_in["w2"],
        "B_w3": _B_in["w3"],
        "B_w4": _B_in["w4"],
    }

def reference(A_x, A_wqkv, A_w_phi, A_wo, B_x, B_w1, B_w2, B_w3, B_w4):
    def _A_ref(x, wqkv, w_phi, wo):
        B, S, D = x.shape
        H = 32; Dh = D // H
        qkv = (lambda x, *d: x.permute(*d))((x @ wqkv).reshape(B, S, 3, H, Dh), 2, 0, 3, 1, 4)
        q, k, v = qkv[0], qkv[1], qkv[2]
        pq = torch.einsum("bhsd,hdf->bhsf", q, w_phi)
        pk = torch.einsum("bhsd,hdf->bhsf", k, w_phi)
        phi_q = torch.concatenate([_softmax(pq, axis=-1), _softmax(-pq, axis=-1)], axis=-1)
        phi_k = torch.concatenate([_softmax(pk, axis=-1), _softmax(-pk, axis=-1)], axis=-1)
        kv = torch.einsum("bhsf,bhsd->bhfd", phi_k, v)
        z  = torch.einsum("bhsf->bhf", phi_k)
        num = torch.einsum("bhqf,bhfd->bhqd", phi_q, kv)
        den = torch.einsum("bhqf,bhf->bhq", phi_q, z)[..., None] + 1e-6
        o = num / den
        return (lambda x, *d: x.permute(*d))(o, 0, 2, 1, 3).reshape(B, S, D) @ wo

    def _B_ref(x, w1, w2, w3, w4):
        B, S, D = x.shape
        h = _gelu(_layernorm(x, axis=-1) @ w1)
        c = D // 4
        g0 = _pad(h[:, :, 0*c:1*c], ((0, 0), (1, 0), (0, 0)))[:, :S, :]
        g1 = _pad(h[:, :, 1*c:2*c], ((0, 0), (0, 1), (0, 0)))[:, 1:, :]
        g2 = _pad(h[:, :, 2*c:3*c], ((0, 0), (2, 0), (0, 0)))[:, :S, :]
        g3 = _pad(h[:, :, 3*c:   ], ((0, 0), (0, 2), (0, 0)))[:, 2:, :]
        hs = torch.concatenate([g0, g1, g2, g3], axis=-1) @ w2
        x1 = x + hs
        h2 = _gelu(_layernorm(x1, axis=-1) @ w3) @ w4
        return x1 + h2

    x = A_x
    h = x + _A_ref(_layernorm(x, axis=-1), A_wqkv, A_w_phi, A_wo)
    h2 = h + _B_ref(_layernorm(h, axis=-1), B_w1, B_w2, B_w3, B_w4)
    return h2
```

```asm
; @launch grid=(256,1,1) block=(256,1,1) lds=163840
.amdgcn_target "amdgcn-amd-amdhsa--gfx950"
.text
.globl sequential_preLN__linear_kernel_hedgehog__mixer_s_mlp__prompt_kernel
.p2align 8
.type sequential_preLN__linear_kernel_hedgehog__mixer_s_mlp__prompt_kernel,@function
sequential_preLN__linear_kernel_hedgehog__mixer_s_mlp__prompt_kernel:
    s_load_dwordx16 s[32:47], s[0:1], 0
    s_load_dwordx8 s[48:55], s[0:1], 64
    s_cmp_ge_u32 s2, 256
    s_cbranch_scc1 L_end
    s_getpc_b64 s[82:83]
L_pc:
    s_lshr_b32 s27, s2, 3
    s_lshl_b32 s27, s27, 11
    v_lshl_add_u32 v246, v0, 3, s27
    v_min_u32 v246, L_codeend-L_pc-8, v246
    global_load_dwordx2 v[248:249], v246, s[82:83]
    v_and_b32 v1, 63, v0
    v_lshrrev_b32 v236, 6, v0
    s_lshr_b32 s25, s2, 5
    s_bfe_u32 s96, s2, 0x20001
    s_lshl_b32 s96, s96, 3
    s_lshr_b32 s28, s2, 5
    v_readfirstlane_b32 s26, v236
    s_or_b32 s96, s96, s28
    s_and_b32 s97, s2, 1
    s_lshl_b32 s97, s97, 2
    s_bfe_u32 s27, s2, 0x20003
    s_or_b32 s97, s97, s27
    v_bfe_u32 v238, v1, 2, 2
    v_and_b32 v239, 3, v1
    v_max_u32 v240, 1, v238
    v_subrev_u32 v240, 1, v240
    v_mul_u32_u24 v240, 1280, v240
    v_lshl_add_u32 v240, v239, 3, v240
    v_lshrrev_b32 v241, 1, v239
    v_sub_u32 v241, v239, v241
    v_mul_u32_u24 v241, 1280, v241
    v_add_u32 v241, 32, v241
    v_cmp_eq_u32 vcc, 1, v238
    s_lshl_b32 s31, s27, 1
    s_add_u32 s31, s31, s28
    v_cndmask_b32 v240, v240, v241, vcc
    v_lshrrev_b32 v241, 4, v1
    v_mul_u32_u24 v242, 3840, v241
    v_add_u32 v236, v240, v242
    v_and_b32 v242, 15, v1
    v_cmp_eq_u32 vcc, 6, v242
    v_mov_b32 v242, 0x40000000
    s_and_b32 s98, s96, 3
    v_cndmask_b32 v236, v236, v242, vcc
    s_lshl_b32 s98, s98, 3
    s_or_b32 s98, s98, s97
    s_and_b32 s99, s96, 28
    s_add_u32 s99, s99, s26
    s_mul_i32 s28, s98, 76800
    s_mul_i32 s29, s99, 40
    s_add_u32 s28, s28, s29
    s_mov_b32 s14, 0x258000
    s_mov_b32 s15, 0x00020000
    s_waitcnt lgkmcnt(0)
    s_mov_b32 s12, s34
    s_mov_b32 s13, s35
    buffer_load_dwordx2 v[128:129], v236, s[12:15], s28 offen nt
    s_add_u32 s28, s28, 15360
    buffer_load_dwordx2 v[130:131], v236, s[12:15], s28 offen nt
    s_add_u32 s28, s28, 15360
    buffer_load_dwordx2 v[132:133], v236, s[12:15], s28 offen nt
    s_add_u32 s28, s28, 15360
    buffer_load_dwordx2 v[134:135], v236, s[12:15], s28 offen nt
    s_add_u32 s28, s28, 15360
    buffer_load_dwordx2 v[136:137], v236, s[12:15], s28 offen nt
    s_mov_b32 s4, s54
    s_mov_b32 s5, s55
    s_mov_b32 s6, 0x1af8000
    s_mov_b32 s7, 0x00020000
    s_buffer_load_dword s56, s[4:7], 0
    s_mov_b32 s8, s32
    s_mov_b32 s9, s33
    s_mov_b32 s10, 0x280000
    s_mov_b32 s11, 0x00020000
    s_mov_b32 s40, s96
    s_mov_b32 s41, s97
    s_and_b32 s31, s31, 7
    s_mul_i32 s31, s31, 10
    s_lshr_b32 s31, s31, 3
    v_lshrrev_b32 v238, 3, v1
    v_mul_u32_u24 v238, 1280, v238
    v_and_b32 v240, 7, v1
    v_xor_b32 v240, v240, v241
    v_lshl_add_u32 v2, v240, 4, v238
    v_xor_b32 v240, 4, v240
    v_lshl_add_u32 v3, v240, 4, v238
    v_add_u32 v4, 18432, v2
    v_add_u32 v5, 27648, v3
    v_add_u32 v3, 9216, v3
    s_lshl_b32 s80, s97, 2
    s_add_u32 s80, s80, s26
    s_mul_i32 s62, s80, 81920
    s_lshl_b32 s63, s26, 14
    s_mov_b32 s16, s31
    v_lshlrev_b32 v252, 4, v1
    v_lshlrev_b32 v253, 3, v1
    v_lshrrev_b32 v239, 5, v1
    v_and_b32 v240, 31, v1
    s_lshl_b32 s96, s80, 9
    s_add_u32 s96, s96, 0x22000
    s_mul_i32 s27, s99, 90112
    s_add_u32 s27, s27, 0xe0000
    s_mul_i32 s87, s98, 2560
    s_add_u32 s87, s87, s27
    s_lshl_b32 s85, s98, 8
    s_add_u32 s85, s85, s27
    s_add_u32 s85, s85, 81920
    s_lshl_b32 s86, s99, 9
    s_lshl_b32 s28, s98, 2
    s_lshr_b32 s29, s98, 3
    s_mul_i32 s29, s29, 96
    s_add_u32 s28, s28, s29
    s_add_u32 s86, s86, s28
    s_add_u32 s86, s86, 0x1000
    s_lshl_b32 s27, s2, 2
    s_add_u32 s27, s27, s26
    s_lshl_b32 s27, s27, 7
    s_add_u32 s27, s27, 0x1000
    s_buffer_load_dword s60, s[4:7], s27 glc
    s_mov_b32 s58, 0
    s_mov_b32 s59, -1
    s_mov_b32 s61, 0x3f803f80
    s_lshl_b32 s27, s41, 7
    s_lshl_b32 s28, s40, 2
    s_add_u32 s27, s27, s28
    s_add_u32 s84, s27, s26
    v_bfe_u32 v241, v1, 1, 3
    v_xor_b32 v241, v241, v239
    v_lshlrev_b32 v238, 7, v240
    v_add_u32 v238, s63, v238
    v_lshl_add_u32 v6, v241, 4, v238
    v_xor_b32 v7, 32, v6
    v_xor_b32 v8, 64, v6
    v_xor_b32 v9, 96, v6
    s_lshl_b32 s18, s40, 7
    s_add_u32 s18, s18, 0x0
    s_mul_i32 s17, s40, 90112
    s_add_u32 s17, s17, 0xe0000
    s_lshl_b32 s19, s41, 7
    s_add_u32 s19, s19, 0x1d000
    v_bfe_u32 v241, v1, 2, 2
    v_lshl_add_u32 v241, v239, 3, v241
    v_lshlrev_b32 v241, 7, v241
    v_bfe_u32 v242, v1, 4, 1
    v_and_b32 v243, 3, v1
    v_lshl_or_b32 v243, v242, 2, v243
    v_bfe_u32 v244, v1, 3, 1
    v_lshlrev_b32 v245, 6, v244
    v_lshl_add_u32 v245, v243, 3, v245
    v_add_u32 v10, v241, v245
    v_add_u32 v10, 65536, v10
    v_xor_b32 v11, 64, v10
    v_add_u32 v12, 40960, v10
    v_add_u32 v13, 40960, v11
    v_lshlrev_b32 v242, 6, v242
    v_xor_b32 v14, v252, v242
    v_and_b32 v242, 5, v1
    v_bfe_u32 v245, v1, 1, 1
    v_lshl_or_b32 v242, v245, 3, v242
    v_lshl_or_b32 v242, v244, 1, v242
    v_xor_b32 v242, v242, v239
    v_lshl_add_u32 v60, v242, 3, v238
    s_mov_b32 s80, 0xeeefdbca
    v_add_u32 v241, s63, v241
    v_bfe_u32 v242, v1, 2, 1
    v_lshl_or_b32 v242, v239, 1, v242
    v_lshl_or_b32 v242, v244, 3, v242
    v_xor_b32 v245, v243, v242
    v_lshl_add_u32 v61, v245, 3, v241
    v_and_b32 v245, 1, v243
    v_or_b32 v245, 8, v245
    v_xor_b32 v245, v245, v242
    v_lshl_add_u32 v62, v245, 3, v241
    v_lshlrev_b32 v243, 2, v243
    v_bfe_u32 v245, s80, v243, 4
    v_xor_b32 v245, v245, v242
    v_lshl_add_u32 v63, v245, 3, v241
    v_and_b32 v241, 3, v1
    v_bfe_u32 v242, v1, 3, 2
    v_lshl_add_u32 v241, v242, 2, v241
    v_bfe_u32 v242, v1, 2, 1
    v_mul_u32_u24 v242, 10, v242
    v_add_lshl_u32 v241, v241, v242, 1
    s_lshl_b32 s80, s26, 10
    s_add_u32 s80, s80, 155648
    v_add_u32 v241, s80, v241
    v_mul_u32_u24 v242, 160, v239
    v_add_u32 v242, v241, v242
    v_mov_b32 v152, 0
    v_mov_b32 v153, 0
    v_mov_b32 v154, 0
    v_mov_b32 v155, 0
    v_mov_b32 v156, 0
    v_mov_b32 v157, 0
    v_mul_u32_u24 v238, 1280, v239
    v_lshl_add_u32 v244, v240, 4, v238
    v_lshl_add_u32 v245, v240, 3, v238
    v_lshlrev_b32 v20, 2, v240
    v_lshlrev_b32 v21, 3, v240
    s_mov_b32 s80, 0x3f80
    s_mov_b32 s81, 0x3f800000
    s_mov_b32 s88, s36
    s_mov_b32 s89, s37
    s_mov_b32 s90, 25600
    s_mov_b32 s91, 0x00020000
    s_mul_i32 s92, s40, 800
    s_lshl_b32 s93, s26, 10
    s_mul_i32 s94, s84, 2560
    s_add_u32 m0, s93, 155648
    s_nop 0
    buffer_load_dwordx4 v252, s[88:91], s92 offen lds
    s_and_b32 s80, s2, 7
    s_lshl_b32 s80, s80, 2
    s_bfe_u32 s81, s2, 0x20003
    s_or_b32 s24, s80, s81
    s_lshl_b32 s78, s26, 5
    s_add_u32 s78, s78, s24
    s_mov_b32 s20, s38
    s_mov_b32 s21, s39
    s_mov_b32 s22, 0xc8000
    s_mov_b32 s23, 0x00020000
    s_mov_b32 s79, 0
    s_mov_b32 s98, 0x14e0000
    s_cmp_ge_u32 s78, 20
    s_cselect_b32 s20, s42, s20
    s_cselect_b32 s21, s43, s21
    s_cselect_b32 s79, 20, s79
    s_cselect_b32 s98, 0x15a8000, s98
    s_cmp_ge_u32 s78, 40
    s_cselect_b32 s20, s44, s20
    s_cselect_b32 s21, s45, s21
    s_cselect_b32 s79, 40, s79
    s_cselect_b32 s98, 0x1670000, s98
    s_sub_u32 s79, s78, s79
    s_mul_i32 s80, s25, 102400
    s_add_u32 s98, s98, s80
    s_mul_i32 s80, s79, 5120
    s_add_u32 s98, s98, s80
    s_mul_i32 s70, s79, 52
    s_lshr_b32 s70, s70, 8
    s_mul_i32 s71, s70, 5
    s_sub_u32 s71, s79, s71
    s_mul_i32 s70, s70, 160
    s_mul_i32 s72, s71, 40
    s_cmp_eq_u32 s71, 4
    s_cselect_b32 s72, 16, s72
    s_cselect_b32 s68, 2, 4
    s_cselect_b32 s69, 3, 15
    s_add_u32 s70, s70, s72
    s_lshl_b32 s71, s79, 5
    s_cmp_lt_u32 s78, 20
    s_cselect_b32 s70, s70, s71
    s_cselect_b32 s68, s68, 5
    s_cselect_b32 s69, s69, 31
    s_mul_i32 s97, s70, 1280
    s_mul_i32 s80, s25, 160
    s_add_u32 s97, s97, s80
    s_cmp_ge_u32 s78, 60
    s_cselect_b32 s97, 0x40000000, s97
    s_cselect_b32 s98, 0x40000000, s98
    s_mov_b32 s14, 0x1e0000
    s_mov_b32 s34, 0x1918000
    s_movk_i32 s80, 5120
    s_movk_i32 s81, 3072
    s_movk_i32 s77, 1280
    s_movk_i32 s95, 160
    s_cmp_ge_u32 s78, 88
    s_cselect_b32 s12, s46, s48
    s_cselect_b32 s13, s47, s49
    s_cselect_b32 s34, 0x1738000, s34
    s_cselect_b32 s80, 3072, s80
    s_cselect_b32 s81, 61440, s81
    s_cselect_b32 s77, 3072, s77
    s_cselect_b32 s95, 384, s95
    s_cselect_b32 s79, 88, 40
    s_cselect_b32 s91, 1, 0
    s_cselect_b32 s88, 12, 10
    s_cselect_b32 s89, 24, 40
    s_cselect_b32 s90, 96, 24
    s_cselect_b64 s[82:83], -1, 0
    s_sub_u32 s79, s78, s79
    s_and_b32 s27, s79, s91
    s_lshr_b32 s79, s79, s91
    s_mul_i32 s80, s80, s79
    s_add_u32 s34, s34, s80
    s_mul_i32 s80, s25, 245760
    s_add_u32 s34, s34, s80
    s_mul_i32 s80, s27, 122880
    s_add_u32 s34, s34, s80
    s_mul_i32 s99, s79, s77
    s_lshl_b32 s99, s99, 5
    s_mul_i32 s95, s95, s25
    s_add_u32 s99, s99, s95
    s_mul_i32 s80, s27, 192
    s_add_u32 s99, s99, s80
    s_cmp_lt_u32 s78, 40
    s_cselect_b32 s99, 0x40000000, s99
    s_cselect_b32 s34, 0x40000000, s34
    s_add_u32 s35, s34, s81
    v_mov_b32 v246, 0x40000000
    v_add_u32 v250, 0, v1
    v_mul_u32_u24 v251, 5462, v250
    v_lshrrev_b32 v251, 16, v251
    v_mul_u32_u24 v247, 12, v251
    v_sub_u32 v250, v250, v247
    v_lshrrev_b32 v247, s68, v251
    v_and_b32 v251, s69, v251
    v_mad_u32_u24 v251, v247, 20, v251
    v_mul_u32_u24 v251, s77, v251
    v_cmp_gt_u32 s[66:67], s88, v250
    v_lshl_add_u32 v251, v250, 4, v251
    s_nop 0
    v_cndmask_b32 v22, v246, v251, s[66:67]
    v_add_u32 v250, 64, v1
    v_mul_u32_u24 v251, 5462, v250
    v_lshrrev_b32 v251, 16, v251
    v_mul_u32_u24 v247, 12, v251
    v_sub_u32 v250, v250, v247
    v_lshrrev_b32 v247, s68, v251
    v_and_b32 v251, s69, v251
    v_mad_u32_u24 v251, v247, 20, v251
    v_mul_u32_u24 v251, s77, v251
    v_cmp_gt_u32 s[66:67], s88, v250
    v_lshl_add_u32 v251, v250, 4, v251
    s_nop 0
    v_cndmask_b32 v23, v246, v251, s[66:67]
    v_add_u32 v250, 128, v1
    v_mul_u32_u24 v251, 5462, v250
    v_lshrrev_b32 v251, 16, v251
    v_mul_u32_u24 v247, 12, v251
    v_sub_u32 v250, v250, v247
    v_lshrrev_b32 v247, s68, v251
    v_and_b32 v251, s69, v251
    v_mad_u32_u24 v251, v247, 20, v251
    v_mul_u32_u24 v251, s77, v251
    v_cmp_gt_u32 s[66:67], s88, v250
    v_lshl_add_u32 v251, v250, 4, v251
    s_nop 0
    v_cndmask_b32 v24, v246, v251, s[66:67]
    v_add_u32 v250, 192, v1
    v_mul_u32_u24 v251, 5462, v250
    v_lshrrev_b32 v251, 16, v251
    v_mul_u32_u24 v247, 12, v251
    v_sub_u32 v250, v250, v247
    v_lshrrev_b32 v247, s68, v251
    v_and_b32 v251, s69, v251
    v_mad_u32_u24 v251, v247, 20, v251
    v_mul_u32_u24 v251, s77, v251
    v_cmp_gt_u32 s[66:67], s88, v250
    v_lshl_add_u32 v251, v250, 4, v251
    s_nop 0
    v_cndmask_b32 v25, v246, v251, s[66:67]
    v_add_u32 v250, 256, v1
    v_mul_u32_u24 v251, 5462, v250
    v_lshrrev_b32 v251, 16, v251
    v_mul_u32_u24 v247, 12, v251
    v_sub_u32 v250, v250, v247
    v_lshrrev_b32 v247, s68, v251
    v_and_b32 v251, s69, v251
    v_mad_u32_u24 v251, v247, 20, v251
    v_mul_u32_u24 v251, s77, v251
    v_cmp_gt_u32 s[66:67], s88, v250
    v_lshl_add_u32 v251, v250, 4, v251
    s_nop 0
    v_cndmask_b32 v26, v246, v251, s[66:67]
    v_add_u32 v250, 320, v1
    v_mul_u32_u24 v251, 5462, v250
    v_lshrrev_b32 v251, 16, v251
    v_mul_u32_u24 v247, 12, v251
    v_sub_u32 v250, v250, v247
    v_lshrrev_b32 v247, s68, v251
    v_and_b32 v251, s69, v251
    v_mad_u32_u24 v251, v247, 20, v251
    v_mul_u32_u24 v251, s77, v251
    v_cmp_gt_u32 s[66:67], s88, v250
    v_lshl_add_u32 v251, v250, 4, v251
    s_nop 0
    v_cndmask_b32 v27, v246, v251, s[66:67]
    v_lshrrev_b32 v250, 4, v1
    v_bfe_u32 v251, v1, 2, 2
    v_lshl_add_u32 v250, v250, 3, v251
    v_mul_u32_u24 v250, 192, v250
    s_mul_i32 s91, s26, 6144
    s_add_u32 s91, s91, 65536
    v_add_u32 v250, s91, v250
    v_and_b32 v251, 3, v1
    v_mul_u32_u24 v251, s89, v251
    v_add_u32 v250, v250, v251
    v_and_b32 v251, 1, v1
    v_lshl_add_u32 v28, v251, 3, v250
    v_add_u32 v29, 8, v28
    v_xor_b32 v251, 1, v251
    s_sub_u32 s89, s89, 8
    v_mad_u32_u24 v250, v251, s89, v250
    v_add_u32 v251, 16, v28
    v_cndmask_b32 v30, v251, v250, s[82:83]
    v_add_u32 v31, s90, v28
    v_add_u32 v251, 104, v28
    v_cndmask_b32 v32, v250, v251, s[82:83]
    v_add_u32 v33, 96, v250
    v_cndmask_b32 v34, v246, v252, s[82:83]
    v_add_u32 v35, s91, v252
    s_mov_b32 s80, 0x3f80
    s_mov_b32 s81, 0x3f800000
    s_waitcnt vmcnt(5)
    buffer_store_dwordx2 v[128:129], v253, s[4:7], s87 offen offset:0 sc1
    v_dot2c_f32_bf16 v152, s80, v128
    v_dot2c_f32_bf16 v153, s81, v128
    v_dot2c_f32_bf16 v154, s80, v129
    v_dot2c_f32_bf16 v155, s81, v129
    s_waitcnt vmcnt(5)
    buffer_store_dwordx2 v[130:131], v253, s[4:7], s87 offen offset:512 sc1
    v_dot2c_f32_bf16 v152, s80, v130
    v_dot2c_f32_bf16 v153, s81, v130
    v_dot2c_f32_bf16 v154, s80, v131
    v_dot2c_f32_bf16 v155, s81, v131
    s_waitcnt vmcnt(5)
    buffer_store_dwordx2 v[132:133], v253, s[4:7], s87 offen offset:1024 sc1
    v_dot2c_f32_bf16 v152, s80, v132
    v_dot2c_f32_bf16 v153, s81, v132
    v_dot2c_f32_bf16 v154, s80, v133
    v_dot2c_f32_bf16 v155, s81, v133
    s_waitcnt vmcnt(5)
    buffer_store_dwordx2 v[134:135], v253, s[4:7], s87 offen offset:1536 sc1
    v_dot2c_f32_bf16 v152, s80, v134
    v_dot2c_f32_bf16 v153, s81, v134
    v_dot2c_f32_bf16 v154, s80, v135
    v_dot2c_f32_bf16 v155, s81, v135
    s_waitcnt vmcnt(5)
    buffer_store_dwordx2 v[136:137], v253, s[4:7], s87 offen offset:2048 sc1
    v_dot2c_f32_bf16 v152, s80, v136
    v_dot2c_f32_bf16 v153, s81, v136
    v_dot2c_f32_bf16 v154, s80, v137
    v_dot2c_f32_bf16 v155, s81, v137
    v_mov_b32 v158, v152
    v_mov_b32 v159, v153
    v_mov_b32 v160, v154
    v_mov_b32 v161, v155
    v_permlane16_swap_b32 v152, v158
    v_permlane16_swap_b32 v153, v159
    v_permlane16_swap_b32 v154, v160
    v_permlane16_swap_b32 v155, v161
    v_pk_add_f32 v[152:153], v[152:153], v[158:159]
    v_pk_add_f32 v[154:155], v[154:155], v[160:161]
    v_mov_b32 v158, v152
    v_mov_b32 v159, v153
    v_mov_b32 v160, v154
    v_mov_b32 v161, v155
    v_permlane32_swap_b32 v152, v158
    v_permlane32_swap_b32 v153, v159
    v_permlane32_swap_b32 v154, v160
    v_permlane32_swap_b32 v155, v161
    v_pk_add_f32 v[152:153], v[152:153], v[158:159]
    v_pk_add_f32 v[154:155], v[154:155], v[160:161]
    v_cvt_pk_bf16_f32 v158, v152, v153
    v_cvt_pk_bf16_f32 v159, v154, v155
    s_mov_b64 vcc, 0xffff
    v_lshlrev_b32 v160, 16, v158
    v_and_b32 v161, 0xffff0000, v158
    v_lshlrev_b32 v162, 16, v159
    v_and_b32 v163, 0xffff0000, v159
    v_pk_add_f32 v[152:153], v[152:153], v[160:161] neg_lo:[0,1] neg_hi:[0,1]
    v_pk_add_f32 v[154:155], v[154:155], v[162:163] neg_lo:[0,1] neg_hi:[0,1]
    v_cvt_pk_bf16_f32 v152, v152, v153
    v_cvt_pk_bf16_f32 v153, v154, v155
    v_cndmask_b32 v152, v152, v158, vcc
    v_cndmask_b32 v153, v153, v159, vcc
    s_mov_b32 exec_hi, 0
    buffer_store_dwordx2 v[152:153], v253, s[4:7], s85 offen sc1
    s_mov_b64 exec, -1
    s_lshl_b32 s30, s31, 7
    s_add_u32 s30, s30, s62
    s_add_u32 s31, s31, 1
    s_cmp_eq_u32 s31, 10
    s_cselect_b32 s31, 0, s31
    s_add_u32 m0, s63, 0
    s_nop 0
    buffer_load_dwordx4 v2, s[8:11], s30 offen offset:0  lds
    buffer_load_dwordx4 v3, s[8:11], s30 offen offset:1024  lds
    buffer_load_dwordx4 v4, s[8:11], s30 offen offset:2048  lds
    buffer_load_dwordx4 v5, s[8:11], s30 offen offset:3072  lds
    s_waitcnt lgkmcnt(0)
    s_mul_i32 s56, s56, 0x9e3779b1
    s_add_u32 s56, s56, 0x7f4a7c15
    s_mov_b32 s57, s56
    v_mov_b32 v254, s56
    s_waitcnt vmcnt(4)
    s_mov_b64 exec, 1
    buffer_store_dword v254, off, s[4:7], s86 sc1
    s_mov_b64 exec, -1
    s_add_u32 s30, s30, 40960
    s_add_u32 m0, s63, 4096
    s_nop 0
    buffer_load_dwordx4 v2, s[8:11], s30 offen offset:0  lds
    buffer_load_dwordx4 v3, s[8:11], s30 offen offset:1024  lds
    buffer_load_dwordx4 v4, s[8:11], s30 offen offset:2048  lds
    buffer_load_dwordx4 v5, s[8:11], s30 offen offset:3072  lds
    s_lshl_b32 s30, s31, 7
    s_add_u32 s30, s30, s62
    s_add_u32 s31, s31, 1
    s_cmp_eq_u32 s31, 10
    s_cselect_b32 s31, 0, s31
    s_add_u32 m0, s63, 8192
    s_nop 0
    buffer_load_dwordx4 v2, s[8:11], s30 offen offset:0  lds
    buffer_load_dwordx4 v3, s[8:11], s30 offen offset:1024  lds
    buffer_load_dwordx4 v4, s[8:11], s30 offen offset:2048  lds
    buffer_load_dwordx4 v5, s[8:11], s30 offen offset:3072  lds
    s_add_u32 s30, s30, 40960
    s_add_u32 m0, s63, 12288
    s_nop 0
    buffer_load_dwordx4 v2, s[8:11], s30 offen offset:0  lds
    buffer_load_dwordx4 v3, s[8:11], s30 offen offset:1024  lds
    buffer_load_dwordx4 v4, s[8:11], s30 offen offset:2048  lds
    buffer_load_dwordx4 v5, s[8:11], s30 offen offset:3072  lds
    buffer_load_dwordx4 v[140:143], v244, s[8:11], s94 offen
    buffer_load_dwordx4 v[144:147], v244, s[8:11], s94 offen offset:512
    buffer_load_dwordx2 v[148:149], v245, s[8:11], s94 offen offset:1024
    s_lshl_b32 s29, s84, 4
    s_add_u32 s29, s29, 0x22000
    s_add_u32 s27, s18, 64
    s_lshl_b32 s27, s40, 2
    s_add_u32 s27, s27, s26
    s_lshl_b32 s27, s27, 7
    s_add_u32 s27, s27, 0x1000
    s_lshl_b32 s28, s40, 2
    s_add_u32 s28, s28, s19
    s_waitcnt vmcnt(11)
    ds_read_b128 a[0:3], v6 offset:0
    ds_read_b128 a[4:7], v7 offset:0
    ds_read_b128 a[8:11], v8 offset:0
    ds_read_b128 a[12:15], v9 offset:0
    ds_read_b128 a[16:19], v6 offset:4096
    ds_read_b128 a[20:23], v7 offset:4096
    ds_read_b128 a[24:27], v8 offset:4096
    ds_read_b128 a[28:31], v9 offset:4096
    s_waitcnt lgkmcnt(0)
    s_lshl_b32 s30, s31, 7
    s_add_u32 s30, s30, s62
    s_add_u32 s31, s31, 1
    s_cmp_eq_u32 s31, 10
    s_cselect_b32 s31, 0, s31
    s_add_u32 m0, s63, 0
    s_nop 0
    buffer_load_dwordx4 v2, s[8:11], s30 offen offset:0  lds
    buffer_load_dwordx4 v3, s[8:11], s30 offen offset:1024  lds
    buffer_load_dwordx4 v4, s[8:11], s30 offen offset:2048  lds
    buffer_load_dwordx4 v5, s[8:11], s30 offen offset:3072  lds
    s_add_u32 s30, s30, 40960
    s_add_u32 m0, s63, 4096
    s_nop 0
    buffer_load_dwordx4 v2, s[8:11], s30 offen offset:0  lds
    buffer_load_dwordx4 v3, s[8:11], s30 offen offset:1024  lds
    buffer_load_dwordx4 v4, s[8:11], s30 offen offset:2048  lds
    buffer_load_dwordx4 v5, s[8:11], s30 offen offset:3072  lds
    s_buffer_load_dwordx8 s[64:71], s[4:7], s27 glc
    s_waitcnt vmcnt(11)
    ds_read_b128 a[32:35], v6 offset:8192
    ds_read_b128 a[36:39], v7 offset:8192
    ds_read_b128 a[40:43], v8 offset:8192
    ds_read_b128 a[44:47], v9 offset:8192
    ds_read_b128 a[48:51], v6 offset:12288
    ds_read_b128 a[52:55], v7 offset:12288
    ds_read_b128 a[56:59], v8 offset:12288
    ds_read_b128 a[60:63], v9 offset:12288
    s_waitcnt vmcnt(8)
    v_dot2c_f32_bf16 v156, s61, v140
    v_dot2c_f32_bf16 v157, v140, v140
    v_dot2c_f32_bf16 v156, s61, v141
    v_dot2c_f32_bf16 v157, v141, v141
    v_dot2c_f32_bf16 v156, s61, v142
    v_dot2c_f32_bf16 v157, v142, v142
    v_dot2c_f32_bf16 v156, s61, v143
    v_dot2c_f32_bf16 v157, v143, v143
    v_dot2c_f32_bf16 v156, s61, v144
    v_dot2c_f32_bf16 v157, v144, v144
    v_dot2c_f32_bf16 v156, s61, v145
    v_dot2c_f32_bf16 v157, v145, v145
    v_dot2c_f32_bf16 v156, s61, v146
    v_dot2c_f32_bf16 v157, v146, v146
    v_dot2c_f32_bf16 v156, s61, v147
    s_waitcnt lgkmcnt(0)
    s_lshl_b32 s30, s31, 7
    s_add_u32 s30, s30, s62
    s_add_u32 s31, s31, 1
    s_cmp_eq_u32 s31, 10
    s_cselect_b32 s31, 0, s31
    s_add_u32 m0, s63, 8192
    s_nop 0
    buffer_load_dwordx4 v2, s[8:11], s30 offen offset:0  lds
    v_dot2c_f32_bf16 v157, v147, v147
    v_dot2c_f32_bf16 v156, s61, v148
    v_dot2c_f32_bf16 v157, v148, v148
    v_dot2c_f32_bf16 v156, s61, v149
    v_dot2c_f32_bf16 v157, v149, v149
    s_nop 1
    v_add_f32_dpp v156, v156, v156 row_ror:8 row_mask:0xf bank_mask:0xf
    v_add_f32_dpp v157, v157, v157 row_ror:8 row_mask:0xf bank_mask:0xf
    s_nop 0
    v_add_f32_dpp v156, v156, v156 row_ror:4 row_mask:0xf bank_mask:0xf
    buffer_load_dwordx4 v3, s[8:11], s30 offen offset:1024  lds
    v_add_f32_dpp v157, v157, v157 row_ror:4 row_mask:0xf bank_mask:0xf
    v_add_f32_dpp v156, v156, v156 row_ror:2 row_mask:0xf bank_mask:0xf
    s_nop 0
    v_add_f32_dpp v157, v157, v157 row_ror:2 row_mask:0xf bank_mask:0xf
    v_add_f32_dpp v156, v156, v156 row_ror:1 row_mask:0xf bank_mask:0xf
    s_nop 0
    v_add_f32_dpp v157, v157, v157 row_ror:1 row_mask:0xf bank_mask:0xf
    v_mov_b32 v158, v156
    v_mov_b32 v159, v157
    v_lshlrev_b32 v238, 3, v239
    buffer_load_dwordx4 v4, s[8:11], s30 offen offset:2048  lds
    v_permlane16_swap_b32 v156, v158
    v_permlane16_swap_b32 v157, v159
    v_pk_add_f32 v[156:157], v[156:157], v[158:159]
    v_mul_f32 v244, -0.0015625, v156
    v_mul_f32 v157, 0.0015625, v157
    v_fma_f32 v157, -v244, v244, v157
    v_max_f32 v157, 0, v157
    v_add_f32 v157, 0x3727c5ac, v157
    buffer_load_dwordx4 v5, s[8:11], s30 offen offset:3072  lds
    v_rsq_f32 v245, v157
    s_mov_b32 exec_lo, 1
    s_mov_b32 exec_hi, 1
    buffer_store_dwordx2 v[244:245], v238, s[4:7], s29 offen sc1
    s_mov_b64 exec, -1
    s_add_u32 s30, s30, 40960
    s_add_u32 m0, s63, 12288
    s_nop 0
    buffer_load_dwordx4 v2, s[8:11], s30 offen offset:0  lds
    buffer_load_dwordx4 v3, s[8:11], s30 offen offset:1024  lds
    buffer_load_dwordx4 v4, s[8:11], s30 offen offset:2048  lds
    buffer_load_dwordx4 v5, s[8:11], s30 offen offset:3072  lds
    s_mov_b32 s60, 0
    s_branch L_pc_3
L_poll_2:
    s_buffer_load_dwordx8 s[64:71], s[4:7], s27 glc
    s_add_u32 s60, s60, 1
    s_cmp_gt_u32 s60, 400000
    s_cbranch_scc1 L_end
L_pc_3:
    s_waitcnt lgkmcnt(0)
    s_xor_b64 s[64:65], s[64:65], s[56:57]
    s_xor_b64 s[66:67], s[66:67], s[56:57]
    s_or_b64 s[64:65], s[64:65], s[66:67]
    s_xor_b64 s[68:69], s[68:69], s[56:57]
    s_or_b64 s[64:65], s[64:65], s[68:69]
    s_xor_b64 s[70:71], s[70:71], s[56:57]
    s_or_b64 s[64:65], s[64:65], s[70:71]
    s_cbranch_scc1 L_poll_2
L_p1_1:
    s_barrier
    s_lshl_b32 s85, s26, 11
    s_add_u32 s84, s17, s85
    s_lshl_b32 s86, s16, 13
    s_add_u32 s86, s86, s84
    s_add_u32 s16, s16, 1
    s_add_u32 m0, s85, 65536
    s_nop 0
    buffer_load_dwordx4 v14, s[4:7], s86 offen sc1 lds
    buffer_load_dwordx4 v14, s[4:7], s86 offen offset:1024 sc1 lds
    s_cmp_eq_u32 s16, 10
    s_cselect_b32 s16, 0, s16
    s_lshl_b32 s86, s16, 13
    s_add_u32 s86, s86, s84
    s_add_u32 s16, s16, 1
    s_add_u32 m0, s85, 73728
    s_nop 0
    buffer_load_dwordx4 v14, s[4:7], s86 offen sc1 lds
    buffer_load_dwordx4 v14, s[4:7], s86 offen offset:1024 sc1 lds
    s_cmp_eq_u32 s16, 10
    s_cselect_b32 s16, 0, s16
    s_lshl_b32 s86, s16, 13
    s_add_u32 s86, s86, s84
    s_add_u32 s16, s16, 1
    s_add_u32 m0, s85, 81920
    s_nop 0
    buffer_load_dwordx4 v14, s[4:7], s86 offen sc1 lds
    buffer_load_dwordx4 v14, s[4:7], s86 offen offset:1024 sc1 lds
    s_cmp_eq_u32 s16, 10
    s_cselect_b32 s16, 0, s16
    s_lshl_b32 s86, s16, 13
    s_add_u32 s86, s86, s84
    s_add_u32 s16, s16, 1
    s_add_u32 m0, s85, 90112
    s_nop 0
    buffer_load_dwordx4 v14, s[4:7], s86 offen sc1 lds
    buffer_load_dwordx4 v14, s[4:7], s86 offen offset:1024 sc1 lds
    s_cmp_eq_u32 s16, 10
    s_cselect_b32 s16, 0, s16
    s_waitcnt vmcnt(17)
    ds_read_b128 a[64:67], v6 offset:0
    ds_read_b128 a[68:71], v7 offset:0
    ds_read_b128 a[72:75], v8 offset:0
    ds_read_b128 a[76:79], v9 offset:0
    ds_read_b128 a[80:83], v6 offset:4096
    ds_read_b128 a[84:87], v7 offset:4096
    ds_read_b128 a[88:91], v8 offset:4096
    ds_read_b128 a[92:95], v9 offset:4096
    s_waitcnt lgkmcnt(0)
    s_lshl_b32 s30, s31, 7
    s_add_u32 s30, s30, s62
    s_add_u32 s31, s31, 1
    s_cmp_eq_u32 s31, 10
    s_cselect_b32 s31, 0, s31
    s_add_u32 m0, s63, 0
    s_nop 0
    buffer_load_dwordx4 v2, s[8:11], s30 offen offset:0  lds
    buffer_load_dwordx4 v3, s[8:11], s30 offen offset:1024  lds
    buffer_load_dwordx4 v4, s[8:11], s30 offen offset:2048  lds
    buffer_load_dwordx4 v5, s[8:11], s30 offen offset:3072  lds
    s_add_u32 s30, s30, 40960
    s_add_u32 m0, s63, 4096
    s_nop 0
    buffer_load_dwordx4 v2, s[8:11], s30 offen offset:0  lds
    buffer_load_dwordx4 v3, s[8:11], s30 offen offset:1024  lds
    buffer_load_dwordx4 v4, s[8:11], s30 offen offset:2048  lds
    buffer_load_dwordx4 v5, s[8:11], s30 offen offset:3072  lds
    s_waitcnt vmcnt(12)
    s_barrier
    ds_read_b64_tr_b16 v[192:193], v10 offset:0
    ds_read_b64_tr_b16 v[194:195], v10 offset:512
    ds_read_b64_tr_b16 v[196:197], v11 offset:0
    ds_read_b64_tr_b16 v[198:199], v11 offset:512
    ds_read_b64_tr_b16 v[200:201], v10 offset:2048
    ds_read_b64_tr_b16 v[202:203], v10 offset:2560
    ds_read_b64_tr_b16 v[204:205], v11 offset:2048
    ds_read_b64_tr_b16 v[206:207], v11 offset:2560
    s_waitcnt lgkmcnt(4)
    v_mfma_f32_32x32x16_bf16 v[128:143], v[192:195], a[0:3], 0
    ds_read_b64_tr_b16 v[208:209], v10 offset:4096
    s_add_u32 m0, s85, 98304
    s_lshl_b32 s86, s16, 13
    s_add_u32 s86, s86, s84
    buffer_load_dwordx4 v14, s[4:7], s86 offen sc1 lds
    v_mfma_f32_32x32x16_bf16 v[144:159], v[192:195], a[16:19], 0
    ds_read_b64_tr_b16 v[210:211], v10 offset:4608
    ds_read_b128 a[96:99], v6 offset:8192
    ds_read_b128 a[100:103], v7 offset:8192
    ds_read_b128 a[104:107], v8 offset:8192
    ds_read_b128 a[108:111], v9 offset:8192
    ds_read_b128 a[112:115], v6 offset:12288
    v_mfma_f32_32x32x16_bf16 v[160:175], v[196:199], a[0:3], 0
    ds_read_b64_tr_b16 v[212:213], v11 offset:4096
    s_add_u32 m0, s85, 98304
    s_add_u32 s16, s16, 1
    s_cmp_eq_u32 s16, 10
    s_cselect_b32 s16, 0, s16
    buffer_load_dwordx4 v14, s[4:7], s86 offen offset:1024 sc1 lds
    ds_read_b128 a[116:119], v7 offset:12288
    v_mfma_f32_32x32x16_bf16 v[176:191], v[196:199], a[16:19], 0
    ds_read_b64_tr_b16 v[214:215], v11 offset:4608
    ds_read_b128 a[120:123], v8 offset:12288
    ds_read_b128 a[124:127], v9 offset:12288
    s_lshr_b32 s80, s40, 3
    s_mul_i32 s80, s80, 5120
    s_and_b32 s81, s40, 7
    s_waitcnt lgkmcnt(12)
    v_mfma_f32_32x32x16_bf16 v[128:143], v[200:203], a[4:7], v[128:143]
    ds_read_b64_tr_b16 v[216:217], v10 offset:6144
    s_add_u32 m0, s85, 106496
    s_lshl_b32 s86, s16, 13
    s_add_u32 s86, s86, s84
    buffer_load_dwordx4 v14, s[4:7], s86 offen sc1 lds
    s_lshl_b32 s82, s81, 9
    v_mfma_f32_32x32x16_bf16 v[144:159], v[200:203], a[20:23], v[144:159]
    ds_read_b64_tr_b16 v[218:219], v10 offset:6656
    s_add_u32 s82, s82, s80
    s_lshr_b32 s81, s81, 1
    s_lshl_b32 s81, s81, 7
    s_add_u32 s80, s80, s81
    s_and_b32 s81, s40, 1
    v_mfma_f32_32x32x16_bf16 v[160:175], v[204:207], a[4:7], v[160:175]
    ds_read_b64_tr_b16 v[220:221], v11 offset:6144
    s_waitcnt lgkmcnt(3)
    s_add_u32 m0, s63, 8192
    s_lshl_b32 s30, s31, 7
    s_add_u32 s30, s30, s62
    buffer_load_dwordx4 v2, s[8:11], s30 offen offset:0  lds
    s_lshl_b32 s81, s81, 9
    v_mfma_f32_32x32x16_bf16 v[176:191], v[204:207], a[20:23], v[176:191]
    ds_read_b64_tr_b16 v[222:223], v11 offset:6656
    s_add_u32 s80, s80, s81
    s_add_u32 s80, s80, 4096
    v_and_b32 v250, 15, v1
    v_bfe_u32 v251, v1, 4, 1
    v_mul_u32_u24 v251, 20480, v251
    v_mfma_f32_32x32x16_bf16 v[128:143], v[208:211], a[8:11], v[128:143]
    ds_read_b64_tr_b16 v[192:193], v10 offset:8192
    s_add_u32 m0, s63, 8192
    s_add_u32 s31, s31, 1
    s_cmp_eq_u32 s31, 10
    s_cselect_b32 s31, 0, s31
    buffer_load_dwordx4 v3, s[8:11], s30 offen offset:1024  lds
    v_lshl_add_u32 v249, v250, 3, v251
    v_mfma_f32_32x32x16_bf16 v[144:159], v[208:211], a[24:27], v[144:159]
    ds_read_b64_tr_b16 v[194:195], v10 offset:8704
    v_add_u32 v249, s80, v249
    v_lshl_add_u32 v250, v250, 4, v251
    v_lshrrev_b32 v251, 5, v1
    v_lshl_add_u32 v250, v251, 8, v250
    v_add_u32 v248, s82, v250
    v_mfma_f32_32x32x16_bf16 v[160:175], v[212:215], a[8:11], v[160:175]
    ds_read_b64_tr_b16 v[196:197], v11 offset:8192
    s_add_u32 m0, s63, 8192
    s_nop 0
    buffer_load_dwordx4 v4, s[8:11], s30 offen offset:2048  lds
    s_lshl_b32 s36, s41, 2
    v_mfma_f32_32x32x16_bf16 v[176:191], v[212:215], a[24:27], v[176:191]
    ds_read_b64_tr_b16 v[198:199], v11 offset:8704
    s_add_u32 s36, s36, s26
    s_mul_i32 s36, s36, 81920
    s_add_u32 s36, s36, 0x4e0000
    s_add_u32 s37, s36, 40960
    ds_read_u16 v36, v242 offset:0
    s_waitcnt lgkmcnt(5)
    v_mfma_f32_32x32x16_bf16 v[128:143], v[216:219], a[12:15], v[128:143]
    ds_read_b64_tr_b16 v[200:201], v10 offset:10240
    s_add_u32 m0, s63, 8192
    s_nop 0
    buffer_load_dwordx4 v5, s[8:11], s30 offen offset:3072  lds
    ds_read_u16 v37, v242 offset:40
    v_mfma_f32_32x32x16_bf16 v[144:159], v[216:219], a[28:31], v[144:159]
    ds_read_b64_tr_b16 v[202:203], v10 offset:10752
    ds_read_u16 v38, v242 offset:80
    ds_read_u16 v39, v242 offset:120
    ds_read_u16 v40, v242 offset:320
    ds_read_u16 v41, v242 offset:360
    ds_read_u16 v42, v242 offset:400
    v_mfma_f32_32x32x16_bf16 v[160:175], v[220:223], a[12:15], v[160:175]
    ds_read_b64_tr_b16 v[204:205], v11 offset:10240
    s_add_u32 m0, s63, 12288
    s_add_u32 s30, s30, 40960
    buffer_load_dwordx4 v2, s[8:11], s30 offen offset:0  lds
    ds_read_u16 v43, v242 offset:440
    v_mfma_f32_32x32x16_bf16 v[176:191], v[220:223], a[28:31], v[176:191]
    ds_read_b64_tr_b16 v[206:207], v11 offset:10752
    ds_read_u16 v44, v241 offset:640
    ds_read_u16 v45, v241 offset:680
    ds_read_u16 v46, v241 offset:720
    ds_read_u16 v47, v241 offset:760
    s_waitcnt lgkmcnt(0)
    v_mfma_f32_32x32x16_bf16 v[128:143], v[192:195], a[32:35], v[128:143]
    ds_read_b64_tr_b16 v[208:209], v10 offset:12288
    s_add_u32 m0, s63, 12288
    s_nop 0
    buffer_load_dwordx4 v3, s[8:11], s30 offen offset:1024  lds
    s_waitcnt vmcnt(9)
    v_mfma_f32_32x32x16_bf16 v[144:159], v[192:195], a[48:51], v[144:159]
    ds_read_b64_tr_b16 v[210:211], v10 offset:12800
    ds_read_b128 a[128:131], v6 offset:0
    ds_read_b128 a[132:135], v7 offset:0
    ds_read_b128 a[136:139], v8 offset:0
    ds_read_b128 a[140:143], v9 offset:0
    ds_read_b128 a[144:147], v6 offset:4096
    v_mfma_f32_32x32x16_bf16 v[160:175], v[196:199], a[32:35], v[160:175]
    ds_read_b64_tr_b16 v[212:213], v11 offset:12288
    s_add_u32 m0, s63, 12288
    s_nop 0
    buffer_load_dwordx4 v4, s[8:11], s30 offen offset:2048  lds
    ds_read_b128 a[148:151], v7 offset:4096
    v_mfma_f32_32x32x16_bf16 v[176:191], v[196:199], a[48:51], v[176:191]
    ds_read_b64_tr_b16 v[214:215], v11 offset:12800
    ds_read_b128 a[152:155], v8 offset:4096
    ds_read_b128 a[156:159], v9 offset:4096
    v_lshl_or_b32 v224, v37, 16, v36
    v_lshl_or_b32 v225, v39, 16, v38
    v_lshl_or_b32 v226, v41, 16, v40
    v_mfma_f32_32x32x16_bf16 v[128:143], v[200:203], a[36:39], v[128:143]
    ds_read_b64_tr_b16 v[216:217], v10 offset:14336
    s_add_u32 m0, s63, 12288
    s_nop 0
    buffer_load_dwordx4 v5, s[8:11], s30 offen offset:3072  lds
    v_lshl_or_b32 v227, v43, 16, v42
    v_mfma_f32_32x32x16_bf16 v[144:159], v[200:203], a[52:55], v[144:159]
    ds_read_b64_tr_b16 v[218:219], v10 offset:14848
    v_lshl_or_b32 v36, v45, 16, v44
    v_lshl_or_b32 v37, v47, 16, v46
    v_cndmask_b32 v228, v36, 0, s[58:59]
    v_cndmask_b32 v229, v37, 0, s[58:59]
    v_cndmask_b32 v232, 0, v36, s[58:59]
    v_mfma_f32_32x32x16_bf16 v[160:175], v[204:207], a[36:39], v[160:175]
    ds_read_b64_tr_b16 v[220:221], v11 offset:14336
    s_waitcnt lgkmcnt(3)
    s_add_u32 m0, s63, 0
    s_lshl_b32 s30, s31, 7
    s_add_u32 s30, s30, s62
    buffer_load_dwordx4 v2, s[8:11], s30 offen offset:0  lds
    v_cndmask_b32 v233, 0, v37, s[58:59]
    v_mfma_f32_32x32x16_bf16 v[176:191], v[204:207], a[52:55], v[176:191]
    ds_read_b64_tr_b16 v[222:223], v11 offset:14848
    v_mov_b32 v230, 0
    v_mov_b32 v231, 0
    v_mov_b32 v234, 0
    v_mov_b32 v235, 0
    s_barrier
    s_cmp_lg_u32 s26, 0
    s_cbranch_scc1 L_sig_4
    s_mov_b64 exec, 1
    buffer_store_dword v254, off, s[4:7], s28 sc1
    s_mov_b64 exec, -1
L_sig_4:
    v_mfma_f32_32x32x16_bf16 v[128:143], v[208:211], a[40:43], v[128:143]
    ds_read_b64_tr_b16 v[192:193], v10 offset:16384
    s_add_u32 m0, s63, 0
    s_add_u32 s31, s31, 1
    s_cmp_eq_u32 s31, 10
    s_cselect_b32 s31, 0, s31
    buffer_load_dwordx4 v3, s[8:11], s30 offen offset:1024  lds
    v_mfma_f32_32x32x16_bf16 v[144:159], v[208:211], a[56:59], v[144:159]
    ds_read_b64_tr_b16 v[194:195], v10 offset:16896
    v_mfma_f32_32x32x16_bf16 v[160:175], v[212:215], a[40:43], v[160:175]
    ds_read_b64_tr_b16 v[196:197], v11 offset:16384
    s_add_u32 m0, s63, 0
    s_nop 0
    buffer_load_dwordx4 v4, s[8:11], s30 offen offset:2048  lds
    v_mfma_f32_32x32x16_bf16 v[176:191], v[212:215], a[56:59], v[176:191]
    ds_read_b64_tr_b16 v[198:199], v11 offset:16896
    s_waitcnt lgkmcnt(4)
    v_mfma_f32_32x32x16_bf16 v[128:143], v[216:219], a[44:47], v[128:143]
    ds_read_b64_tr_b16 v[200:201], v10 offset:18432
    s_add_u32 m0, s63, 0
    s_nop 0
    buffer_load_dwordx4 v5, s[8:11], s30 offen offset:3072  lds
    v_mfma_f32_32x32x16_bf16 v[144:159], v[216:219], a[60:63], v[144:159]
    ds_read_b64_tr_b16 v[202:203], v10 offset:18944
    v_mfma_f32_32x32x16_bf16 v[160:175], v[220:223], a[44:47], v[160:175]
    ds_read_b64_tr_b16 v[204:205], v11 offset:18432
    s_add_u32 m0, s85, 106496
    s_add_u32 s16, s16, 1
    s_cmp_eq_u32 s16, 10
    s_cselect_b32 s16, 0, s16
    buffer_load_dwordx4 v14, s[4:7], s86 offen offset:1024 sc1 lds
    v_mfma_f32_32x32x16_bf16 v[176:191], v[220:223], a[60:63], v[176:191]
    ds_read_b64_tr_b16 v[206:207], v11 offset:18944
    s_waitcnt lgkmcnt(4)
    v_mfma_f32_32x32x16_bf16 v[128:143], v[192:195], a[64:67], v[128:143]
    ds_read_b64_tr_b16 v[208:209], v10 offset:20480
    s_add_u32 m0, s85, 114688
    s_lshl_b32 s86, s16, 13
    s_add_u32 s86, s86, s84
    buffer_load_dwordx4 v14, s[4:7], s86 offen sc1 lds
    s_waitcnt vmcnt(6)
    v_mfma_f32_32x32x16_bf16 v[144:159], v[192:195], a[80:83], v[144:159]
    ds_read_b64_tr_b16 v[210:211], v10 offset:20992
    ds_read_b128 a[160:163], v6 offset:8192
    ds_read_b128 a[164:167], v7 offset:8192
    ds_read_b128 a[168:171], v8 offset:8192
    ds_read_b128 a[172:175], v9 offset:8192
    ds_read_b128 a[176:179], v6 offset:12288
    v_mfma_f32_32x32x16_bf16 v[160:175], v[196:199], a[64:67], v[160:175]
    ds_read_b64_tr_b16 v[212:213], v11 offset:20480
    s_add_u32 m0, s85, 114688
    s_add_u32 s16, s16, 1
    s_cmp_eq_u32 s16, 10
    s_cselect_b32 s16, 0, s16
    buffer_load_dwordx4 v14, s[4:7], s86 offen offset:1024 sc1 lds
    ds_read_b128 a[180:183], v7 offset:12288
    v_mfma_f32_32x32x16_bf16 v[176:191], v[196:199], a[80:83], v[176:191]
    ds_read_b64_tr_b16 v[214:215], v11 offset:20992
    ds_read_b128 a[184:187], v8 offset:12288
    ds_read_b128 a[188:191], v9 offset:12288
    s_waitcnt lgkmcnt(12)
    v_mfma_f32_32x32x16_bf16 v[128:143], v[200:203], a[68:71], v[128:143]
    ds_read_b64_tr_b16 v[216:217], v10 offset:22528
    s_add_u32 m0, s63, 4096
    s_add_u32 s30, s30, 40960
    buffer_load_dwordx4 v2, s[8:11], s30 offen offset:0  lds
    v_mfma_f32_32x32x16_bf16 v[144:159], v[200:203], a[84:87], v[144:159]
    ds_read_b64_tr_b16 v[218:219], v10 offset:23040
    v_mfma_f32_32x32x16_bf16 v[160:175], v[204:207], a[68:71], v[160:175]
    ds_read_b64_tr_b16 v[220:221], v11 offset:22528
    s_add_u32 m0, s63, 4096
    s_nop 0
    buffer_load_dwordx4 v3, s[8:11], s30 offen offset:1024  lds
    v_mfma_f32_32x32x16_bf16 v[176:191], v[204:207], a[84:87], v[176:191]
    ds_read_b64_tr_b16 v[222:223], v11 offset:23040
    s_waitcnt lgkmcnt(6)
    v_mfma_f32_32x32x16_bf16 v[128:143], v[208:211], a[72:75], v[128:143]
    ds_read_b64_tr_b16 v[192:193], v10 offset:24576
    s_add_u32 m0, s63, 4096
    s_nop 0
    buffer_load_dwordx4 v4, s[8:11], s30 offen offset:2048  lds
    v_mfma_f32_32x32x16_bf16 v[144:159], v[208:211], a[88:91], v[144:159]
    ds_read_b64_tr_b16 v[194:195], v10 offset:25088
    v_mfma_f32_32x32x16_bf16 v[160:175], v[212:215], a[72:75], v[160:175]
    ds_read_b64_tr_b16 v[196:197], v11 offset:24576
    s_add_u32 m0, s63, 4096
    s_nop 0
    buffer_load_dwordx4 v5, s[8:11], s30 offen offset:3072  lds
    v_mfma_f32_32x32x16_bf16 v[176:191], v[212:215], a[88:91], v[176:191]
    ds_read_b64_tr_b16 v[198:199], v11 offset:25088
    s_waitcnt lgkmcnt(4)
    v_mfma_f32_32x32x16_bf16 v[128:143], v[216:219], a[76:79], v[128:143]
    ds_read_b64_tr_b16 v[200:201], v10 offset:26624
    s_add_u32 m0, s63, 8192
    s_lshl_b32 s30, s31, 7
    s_add_u32 s30, s30, s62
    buffer_load_dwordx4 v2, s[8:11], s30 offen offset:0  lds
    v_mfma_f32_32x32x16_bf16 v[144:159], v[216:219], a[92:95], v[144:159]
    ds_read_b64_tr_b16 v[202:203], v10 offset:27136
    v_mfma_f32_32x32x16_bf16 v[160:175], v[220:223], a[76:79], v[160:175]
    ds_read_b64_tr_b16 v[204:205], v11 offset:26624
    s_add_u32 m0, s63, 8192
    s_add_u32 s31, s31, 1
    s_cmp_eq_u32 s31, 10
    s_cselect_b32 s31, 0, s31
    buffer_load_dwordx4 v3, s[8:11], s30 offen offset:1024  lds
    v_mfma_f32_32x32x16_bf16 v[176:191], v[220:223], a[92:95], v[176:191]
    ds_read_b64_tr_b16 v[206:207], v11 offset:27136
    s_waitcnt lgkmcnt(4)
    v_mfma_f32_32x32x16_bf16 v[128:143], v[192:195], a[96:99], v[128:143]
    ds_read_b64_tr_b16 v[208:209], v10 offset:28672
    s_add_u32 m0, s63, 8192
    s_nop 0
    buffer_load_dwordx4 v4, s[8:11], s30 offen offset:2048  lds
    v_mfma_f32_32x32x16_bf16 v[144:159], v[192:195], a[112:115], v[144:159]
    ds_read_b64_tr_b16 v[210:211], v10 offset:29184
    v_mfma_f32_32x32x16_bf16 v[160:175], v[196:199], a[96:99], v[160:175]
    ds_read_b64_tr_b16 v[212:213], v11 offset:28672
    s_add_u32 m0, s63, 8192
    s_nop 0
    buffer_load_dwordx4 v5, s[8:11], s30 offen offset:3072  lds
    v_mfma_f32_32x32x16_bf16 v[176:191], v[196:199], a[112:115], v[176:191]
    ds_read_b64_tr_b16 v[214:215], v11 offset:29184
    s_waitcnt lgkmcnt(4)
    v_mfma_f32_32x32x16_bf16 v[128:143], v[200:203], a[100:103], v[128:143]
    ds_read_b64_tr_b16 v[216:217], v10 offset:30720
    s_add_u32 m0, s63, 12288
    s_add_u32 s30, s30, 40960
    buffer_load_dwordx4 v2, s[8:11], s30 offen offset:0  lds
    v_mfma_f32_32x32x16_bf16 v[144:159], v[200:203], a[116:119], v[144:159]
    ds_read_b64_tr_b16 v[218:219], v10 offset:31232
    v_mfma_f32_32x32x16_bf16 v[160:175], v[204:207], a[100:103], v[160:175]
    ds_read_b64_tr_b16 v[220:221], v11 offset:30720
    s_add_u32 m0, s63, 12288
    s_nop 0
    buffer_load_dwordx4 v3, s[8:11], s30 offen offset:1024  lds
    s_waitcnt vmcnt(6)
    v_mfma_f32_32x32x16_bf16 v[176:191], v[204:207], a[116:119], v[176:191]
    ds_read_b64_tr_b16 v[222:223], v11 offset:31232
    ds_read_b128 a[192:195], v6 offset:0
    ds_read_b128 a[196:199], v7 offset:0
    ds_read_b128 a[200:203], v8 offset:0
    ds_read_b128 a[204:207], v9 offset:0
    ds_read_b128 a[208:211], v6 offset:4096
    s_barrier
    s_waitcnt lgkmcnt(9)
    v_mfma_f32_32x32x16_bf16 v[128:143], v[208:211], a[104:107], v[128:143]
    ds_read_b64_tr_b16 v[192:193], v10 offset:32768
    s_add_u32 m0, s63, 12288
    s_nop 0
    buffer_load_dwordx4 v4, s[8:11], s30 offen offset:2048  lds
    ds_read_b128 a[212:215], v7 offset:4096
    v_mfma_f32_32x32x16_bf16 v[144:159], v[208:211], a[120:123], v[144:159]
    ds_read_b64_tr_b16 v[194:195], v10 offset:33280
    ds_read_b128 a[216:219], v8 offset:4096
    ds_read_b128 a[220:223], v9 offset:4096
    v_mfma_f32_32x32x16_bf16 v[160:175], v[212:215], a[104:107], v[160:175]
    ds_read_b64_tr_b16 v[196:197], v11 offset:32768
    s_add_u32 m0, s63, 12288
    s_nop 0
    buffer_load_dwordx4 v5, s[8:11], s30 offen offset:3072  lds
    v_mfma_f32_32x32x16_bf16 v[176:191], v[212:215], a[120:123], v[176:191]
    ds_read_b64_tr_b16 v[198:199], v11 offset:33280
    s_waitcnt lgkmcnt(12)
    v_mfma_f32_32x32x16_bf16 v[128:143], v[216:219], a[108:111], v[128:143]
    ds_read_b64_tr_b16 v[200:201], v10 offset:34816
    buffer_load_dword v15, v20, s[4:7], s19 offen sc1
    v_mfma_f32_32x32x16_bf16 v[144:159], v[216:219], a[124:127], v[144:159]
    ds_read_b64_tr_b16 v[202:203], v10 offset:35328
    v_mfma_f32_32x32x16_bf16 v[160:175], v[220:223], a[108:111], v[160:175]
    ds_read_b64_tr_b16 v[204:205], v11 offset:34816
    s_waitcnt lgkmcnt(5)
    s_add_u32 m0, s63, 0
    s_lshl_b32 s30, s31, 7
    s_add_u32 s30, s30, s62
    buffer_load_dwordx4 v2, s[8:11], s30 offen offset:0  lds
    v_mfma_f32_32x32x16_bf16 v[176:191], v[220:223], a[124:127], v[176:191]
    ds_read_b64_tr_b16 v[206:207], v11 offset:35328
    s_waitcnt lgkmcnt(4)
    v_mfma_f32_32x32x16_bf16 v[128:143], v[192:195], a[128:131], v[128:143]
    ds_read_b64_tr_b16 v[208:209], v10 offset:36864
    s_add_u32 m0, s63, 0
    s_add_u32 s31, s31, 1
    s_cmp_eq_u32 s31, 10
    s_cselect_b32 s31, 0, s31
    buffer_load_dwordx4 v3, s[8:11], s30 offen offset:1024  lds
    v_mfma_f32_32x32x16_bf16 v[144:159], v[192:195], a[144:147], v[144:159]
    ds_read_b64_tr_b16 v[210:211], v10 offset:37376
    v_mfma_f32_32x32x16_bf16 v[160:175], v[196:199], a[128:131], v[160:175]
    ds_read_b64_tr_b16 v[212:213], v11 offset:36864
    s_add_u32 m0, s63, 0
    s_nop 0
    buffer_load_dwordx4 v4, s[8:11], s30 offen offset:2048  lds
    v_mfma_f32_32x32x16_bf16 v[176:191], v[196:199], a[144:147], v[176:191]
    ds_read_b64_tr_b16 v[214:215], v11 offset:37376
    s_waitcnt lgkmcnt(4)
    v_mfma_f32_32x32x16_bf16 v[128:143], v[200:203], a[132:135], v[128:143]
    ds_read_b64_tr_b16 v[216:217], v10 offset:38912
    s_add_u32 m0, s85, 122880
    s_lshl_b32 s86, s16, 13
    s_add_u32 s86, s86, s84
    buffer_load_dwordx4 v14, s[4:7], s86 offen sc1 lds
    v_mfma_f32_32x32x16_bf16 v[144:159], v[200:203], a[148:151], v[144:159]
    ds_read_b64_tr_b16 v[218:219], v10 offset:39424
    v_mfma_f32_32x32x16_bf16 v[160:175], v[204:207], a[132:135], v[160:175]
    ds_read_b64_tr_b16 v[220:221], v11 offset:38912
    s_add_u32 m0, s85, 122880
    s_add_u32 s16, s16, 1
    s_cmp_eq_u32 s16, 10
    s_cselect_b32 s16, 0, s16
    buffer_load_dwordx4 v14, s[4:7], s86 offen offset:1024 sc1 lds
    s_waitcnt vmcnt(6)
    v_mfma_f32_32x32x16_bf16 v[176:191], v[204:207], a[148:151], v[176:191]
    ds_read_b64_tr_b16 v[222:223], v11 offset:39424
    ds_read_b128 a[224:227], v6 offset:8192
    ds_read_b128 a[228:231], v7 offset:8192
    ds_read_b128 a[232:235], v8 offset:8192
    ds_read_b128 a[236:239], v9 offset:8192
    ds_read_b128 a[240:243], v6 offset:12288
    s_waitcnt lgkmcnt(9)
    v_mfma_f32_32x32x16_bf16 v[128:143], v[208:211], a[136:139], v[128:143]
    ds_read_b64_tr_b16 v[192:193], v12 offset:0
    s_add_u32 m0, s85, 131072
    s_lshl_b32 s86, s16, 13
    s_add_u32 s86, s86, s84
    buffer_load_dwordx4 v14, s[4:7], s86 offen sc1 lds
    ds_read_b128 a[244:247], v7 offset:12288
    v_mfma_f32_32x32x16_bf16 v[144:159], v[208:211], a[152:155], v[144:159]
    ds_read_b64_tr_b16 v[194:195], v12 offset:512
    ds_read_b128 a[248:251], v8 offset:12288
    ds_read_b128 a[252:255], v9 offset:12288
    v_mfma_f32_32x32x16_bf16 v[160:175], v[212:215], a[136:139], v[160:175]
    ds_read_b64_tr_b16 v[196:197], v13 offset:0
    s_add_u32 m0, s85, 131072
    s_add_u32 s16, s16, 1
    s_cmp_eq_u32 s16, 10
    s_cselect_b32 s16, 0, s16
    buffer_load_dwordx4 v14, s[4:7], s86 offen offset:1024 sc1 lds
    v_mfma_f32_32x32x16_bf16 v[176:191], v[212:215], a[152:155], v[176:191]
    ds_read_b64_tr_b16 v[198:199], v13 offset:512
    s_waitcnt lgkmcnt(12)
    v_mfma_f32_32x32x16_bf16 v[128:143], v[216:219], a[140:143], v[128:143]
    ds_read_b64_tr_b16 v[200:201], v12 offset:2048
    s_add_u32 m0, s85, 139264
    s_lshl_b32 s86, s16, 13
    s_add_u32 s86, s86, s84
    buffer_load_dwordx4 v14, s[4:7], s86 offen sc1 lds
    v_mfma_f32_32x32x16_bf16 v[144:159], v[216:219], a[156:159], v[144:159]
    ds_read_b64_tr_b16 v[202:203], v12 offset:2560
    v_mfma_f32_32x32x16_bf16 v[160:175], v[220:223], a[140:143], v[160:175]
    ds_read_b64_tr_b16 v[204:205], v13 offset:2048
    s_add_u32 m0, s85, 139264
    s_add_u32 s16, s16, 1
    s_cmp_eq_u32 s16, 10
    s_cselect_b32 s16, 0, s16
    buffer_load_dwordx4 v14, s[4:7], s86 offen offset:1024 sc1 lds
    v_mfma_f32_32x32x16_bf16 v[176:191], v[220:223], a[156:159], v[176:191]
    ds_read_b64_tr_b16 v[206:207], v13 offset:2560
    s_waitcnt lgkmcnt(4)
    v_mfma_f32_32x32x16_bf16 v[128:143], v[192:195], a[160:163], v[128:143]
    ds_read_b64_tr_b16 v[208:209], v12 offset:4096
    s_add_u32 m0, s85, 147456
    s_add_u32 s86, s84, 81920
    buffer_load_dwordx4 v14, s[4:7], s86 offen sc1 lds
    v_mfma_f32_32x32x16_bf16 v[144:159], v[192:195], a[176:179], v[144:159]
    ds_read_b64_tr_b16 v[210:211], v12 offset:4608
    v_mfma_f32_32x32x16_bf16 v[160:175], v[196:199], a[160:163], v[160:175]
    ds_read_b64_tr_b16 v[212:213], v13 offset:4096
    s_add_u32 m0, s85, 147456
    s_nop 0
    buffer_load_dwordx4 v14, s[4:7], s86 offen offset:1024 sc1 lds
    v_mfma_f32_32x32x16_bf16 v[176:191], v[196:199], a[176:179], v[176:191]
    ds_read_b64_tr_b16 v[214:215], v13 offset:4608
    s_waitcnt lgkmcnt(4)
    v_mfma_f32_32x32x16_bf16 v[128:143], v[200:203], a[164:167], v[128:143]
    ds_read_b64_tr_b16 v[216:217], v12 offset:6144
    s_waitcnt vmcnt(11)
    v_cmp_ne_u32 vcc, s56, v15
    s_cbranch_vccz L_vc_5
    s_mov_b32 s60, 0
L_vs_6:
    buffer_load_dword v15, v20, s[4:7], s19 offen sc1
    s_add_u32 s60, s60, 1
    s_cmp_gt_u32 s60, 400000
    s_cbranch_scc1 L_end
    s_waitcnt vmcnt(0)
    v_cmp_ne_u32 vcc, s56, v15
    s_cbranch_vccnz L_vs_6
L_vc_5:
    buffer_load_dwordx2 v[16:17], v21, s[4:7], s96 offen sc1
    v_mfma_f32_32x32x16_bf16 v[144:159], v[200:203], a[180:183], v[144:159]
    ds_read_b64_tr_b16 v[218:219], v12 offset:6656
    v_mfma_f32_32x32x16_bf16 v[160:175], v[204:207], a[164:167], v[160:175]
    ds_read_b64_tr_b16 v[220:221], v13 offset:6144
    buffer_load_dwordx2 v[18:19], v21, s[4:7], s96 offen offset:256 sc1
    v_mfma_f32_32x32x16_bf16 v[176:191], v[204:207], a[180:183], v[176:191]
    ds_read_b64_tr_b16 v[222:223], v13 offset:6656
    s_waitcnt lgkmcnt(4)
    v_mfma_f32_32x32x16_bf16 v[128:143], v[208:211], a[168:171], v[128:143]
    ds_read_b64_tr_b16 v[192:193], v12 offset:8192
    s_add_u32 m0, s63, 0
    s_nop 0
    buffer_load_dwordx4 v5, s[8:11], s30 offen offset:3072  lds
    v_mfma_f32_32x32x16_bf16 v[144:159], v[208:211], a[184:187], v[144:159]
    ds_read_b64_tr_b16 v[194:195], v12 offset:8704
    v_mfma_f32_32x32x16_bf16 v[160:175], v[212:215], a[168:171], v[160:175]
    ds_read_b64_tr_b16 v[196:197], v13 offset:8192
    s_add_u32 m0, s63, 4096
    s_add_u32 s30, s30, 40960
    buffer_load_dwordx4 v2, s[8:11], s30 offen offset:0  lds
    v_mfma_f32_32x32x16_bf16 v[176:191], v[212:215], a[184:187], v[176:191]
    ds_read_b64_tr_b16 v[198:199], v13 offset:8704
    s_waitcnt lgkmcnt(4)
    v_mfma_f32_32x32x16_bf16 v[128:143], v[216:219], a[172:175], v[128:143]
    ds_read_b64_tr_b16 v[200:201], v12 offset:10240
    s_add_u32 m0, s63, 4096
    s_nop 0
    buffer_load_dwordx4 v3, s[8:11], s30 offen offset:1024  lds
    v_mfma_f32_32x32x16_bf16 v[144:159], v[216:219], a[188:191], v[144:159]
    ds_read_b64_tr_b16 v[202:203], v12 offset:10752
    v_mfma_f32_32x32x16_bf16 v[160:175], v[220:223], a[172:175], v[160:175]
    ds_read_b64_tr_b16 v[204:205], v13 offset:10240
    s_add_u32 m0, s63, 4096
    s_nop 0
    buffer_load_dwordx4 v4, s[8:11], s30 offen offset:2048  lds
    v_mfma_f32_32x32x16_bf16 v[176:191], v[220:223], a[188:191], v[176:191]
    ds_read_b64_tr_b16 v[206:207], v13 offset:10752
    s_waitcnt lgkmcnt(4)
    v_mfma_f32_32x32x16_bf16 v[128:143], v[192:195], a[192:195], v[128:143]
    ds_read_b64_tr_b16 v[208:209], v12 offset:12288
    s_add_u32 m0, s63, 4096
    s_nop 0
    buffer_load_dwordx4 v5, s[8:11], s30 offen offset:3072  lds
    v_mfma_f32_32x32x16_bf16 v[144:159], v[192:195], a[208:211], v[144:159]
    ds_read_b64_tr_b16 v[210:211], v12 offset:12800
    v_mfma_f32_32x32x16_bf16 v[160:175], v[196:199], a[192:195], v[160:175]
    ds_read_b64_tr_b16 v[212:213], v13 offset:12288
    s_add_u32 m0, s63, 8192
    s_lshl_b32 s30, s31, 7
    s_add_u32 s30, s30, s62
    buffer_load_dwordx4 v2, s[8:11], s30 offen offset:0  lds
    v_mfma_f32_32x32x16_bf16 v[176:191], v[196:199], a[208:211], v[176:191]
    ds_read_b64_tr_b16 v[214:215], v13 offset:12800
    s_waitcnt lgkmcnt(4)
    v_mfma_f32_32x32x16_bf16 v[128:143], v[200:203], a[196:199], v[128:143]
    ds_read_b64_tr_b16 v[216:217], v12 offset:14336
    s_add_u32 m0, s63, 8192
    s_add_u32 s31, s31, 1
    s_cmp_eq_u32 s31, 10
    s_cselect_b32 s31, 0, s31
    buffer_load_dwordx4 v3, s[8:11], s30 offen offset:1024  lds
    v_mfma_f32_32x32x16_bf16 v[144:159], v[200:203], a[212:215], v[144:159]
    ds_read_b64_tr_b16 v[218:219], v12 offset:14848
    v_mfma_f32_32x32x16_bf16 v[160:175], v[204:207], a[196:199], v[160:175]
    ds_read_b64_tr_b16 v[220:221], v13 offset:14336
    s_add_u32 m0, s63, 8192
    s_nop 0
    buffer_load_dwordx4 v4, s[8:11], s30 offen offset:2048  lds
    v_mfma_f32_32x32x16_bf16 v[176:191], v[204:207], a[212:215], v[176:191]
    ds_read_b64_tr_b16 v[222:223], v13 offset:14848
    s_waitcnt vmcnt(10)
    s_barrier
    s_waitcnt lgkmcnt(4)
    v_mfma_f32_32x32x16_bf16 v[128:143], v[208:211], a[200:203], v[128:143]
    ds_read_b64_tr_b16 v[192:193], v12 offset:16384
    s_add_u32 m0, s63, 8192
    s_nop 0
    buffer_load_dwordx4 v5, s[8:11], s30 offen offset:3072  lds
    v_mfma_f32_32x32x16_bf16 v[144:159], v[208:211], a[216:219], v[144:159]
    ds_read_b64_tr_b16 v[194:195], v12 offset:16896
    v_mfma_f32_32x32x16_bf16 v[160:175], v[212:215], a[200:203], v[160:175]
    ds_read_b64_tr_b16 v[196:197], v13 offset:16384
    s_add_u32 m0, s63, 12288
    s_add_u32 s30, s30, 40960
    buffer_load_dwordx4 v2, s[8:11], s30 offen offset:0  lds
    v_mfma_f32_32x32x16_bf16 v[176:191], v[212:215], a[216:219], v[176:191]
    ds_read_b64_tr_b16 v[198:199], v13 offset:16896
    s_waitcnt lgkmcnt(4)
    v_mfma_f32_32x32x16_bf16 v[128:143], v[216:219], a[204:207], v[128:143]
    ds_read_b64_tr_b16 v[200:201], v12 offset:18432
    s_add_u32 m0, s63, 12288
    s_nop 0
    buffer_load_dwordx4 v3, s[8:11], s30 offen offset:1024  lds
    s_waitcnt vmcnt(6)
    v_mfma_f32_32x32x16_bf16 v[144:159], v[216:219], a[220:223], v[144:159]
    ds_read_b64_tr_b16 v[202:203], v12 offset:18944
    ds_read_b128 a[0:3], v6 offset:0
    ds_read_b128 a[4:7], v7 offset:0
    ds_read_b128 a[8:11], v8 offset:0
    ds_read_b128 a[12:15], v9 offset:0
    ds_read_b128 a[16:19], v6 offset:4096
    v_mfma_f32_32x32x16_bf16 v[160:175], v[220:223], a[204:207], v[160:175]
    ds_read_b64_tr_b16 v[204:205], v13 offset:18432
    s_add_u32 m0, s63, 12288
    s_nop 0
    buffer_load_dwordx4 v4, s[8:11], s30 offen offset:2048  lds
    ds_read_b128 a[20:23], v7 offset:4096
    v_mfma_f32_32x32x16_bf16 v[176:191], v[220:223], a[220:223], v[176:191]
    ds_read_b64_tr_b16 v[206:207], v13 offset:18944
    ds_read_b128 a[24:27], v8 offset:4096
    ds_read_b128 a[28:31], v9 offset:4096
    s_waitcnt lgkmcnt(12)
    v_mfma_f32_32x32x16_bf16 v[128:143], v[192:195], a[224:227], v[128:143]
    ds_read_b64_tr_b16 v[208:209], v12 offset:20480
    s_add_u32 m0, s63, 12288
    s_nop 0
    buffer_load_dwordx4 v5, s[8:11], s30 offen offset:3072  lds
    v_mfma_f32_32x32x16_bf16 v[144:159], v[192:195], a[240:243], v[144:159]
    ds_read_b64_tr_b16 v[210:211], v12 offset:20992
    v_mfma_f32_32x32x16_bf16 v[160:175], v[196:199], a[224:227], v[160:175]
    ds_read_b64_tr_b16 v[212:213], v13 offset:20480
    buffer_load_dwordx4 a[64:67], v22, s[20:23], s97 offen nt
    v_mfma_f32_32x32x16_bf16 v[176:191], v[196:199], a[240:243], v[176:191]
    ds_read_b64_tr_b16 v[214:215], v13 offset:20992
    s_waitcnt lgkmcnt(6)
    v_mfma_f32_32x32x16_bf16 v[128:143], v[200:203], a[228:231], v[128:143]
    ds_read_b64_tr_b16 v[216:217], v12 offset:22528
    buffer_load_dwordx4 a[68:71], v23, s[20:23], s97 offen nt
    v_mfma_f32_32x32x16_bf16 v[144:159], v[200:203], a[244:247], v[144:159]
    ds_read_b64_tr_b16 v[218:219], v12 offset:23040
    v_mfma_f32_32x32x16_bf16 v[160:175], v[204:207], a[228:231], v[160:175]
    ds_read_b64_tr_b16 v[220:221], v13 offset:22528
    buffer_load_dwordx4 a[72:75], v24, s[20:23], s97 offen nt
    v_mfma_f32_32x32x16_bf16 v[176:191], v[204:207], a[244:247], v[176:191]
    ds_read_b64_tr_b16 v[222:223], v13 offset:23040
    s_waitcnt lgkmcnt(4)
    v_mfma_f32_32x32x16_bf16 v[128:143], v[208:211], a[232:235], v[128:143]
    ds_read_b64_tr_b16 a[144:145], v12 offset:24576
    buffer_load_dwordx4 a[76:79], v25, s[20:23], s97 offen nt
    v_mfma_f32_32x32x16_bf16 v[144:159], v[208:211], a[248:251], v[144:159]
    ds_read_b64_tr_b16 a[146:147], v12 offset:25088
    v_mfma_f32_32x32x16_bf16 v[160:175], v[212:215], a[232:235], v[160:175]
    ds_read_b64_tr_b16 a[148:149], v13 offset:24576
    buffer_load_dwordx4 a[80:83], v26, s[20:23], s97 offen nt
    v_mfma_f32_32x32x16_bf16 v[176:191], v[212:215], a[248:251], v[176:191]
    ds_read_b64_tr_b16 a[150:151], v13 offset:25088
    s_waitcnt lgkmcnt(4)
    v_mfma_f32_32x32x16_bf16 v[128:143], v[216:219], a[236:239], v[128:143]
    ds_read_b64_tr_b16 a[152:153], v12 offset:26624
    buffer_load_dwordx4 a[84:87], v27, s[20:23], s97 offen nt
    s_waitcnt vmcnt(6)
    v_mfma_f32_32x32x16_bf16 v[144:159], v[216:219], a[252:255], v[144:159]
    ds_read_b64_tr_b16 a[154:155], v12 offset:27136
    ds_read_b128 a[32:35], v6 offset:8192
    ds_read_b128 a[36:39], v7 offset:8192
    ds_read_b128 a[40:43], v8 offset:8192
    ds_read_b128 a[44:47], v9 offset:8192
    ds_read_b128 a[48:51], v6 offset:12288
    v_mfma_f32_32x32x16_bf16 v[160:175], v[220:223], a[236:239], v[160:175]
    ds_read_b64_tr_b16 a[156:157], v13 offset:26624
    buffer_load_dwordx4 a[88:91], v22, s[12:15], s99 offen nt
    ds_read_b128 a[52:55], v7 offset:12288
    v_mfma_f32_32x32x16_bf16 v[176:191], v[220:223], a[252:255], v[176:191]
    ds_read_b64_tr_b16 a[158:159], v13 offset:27136
    ds_read_b128 a[56:59], v8 offset:12288
    ds_read_b128 a[60:63], v9 offset:12288
    s_waitcnt lgkmcnt(12)
    v_mfma_f32_32x32x16_bf16 v[128:143], a[144:147], a[0:3], v[128:143]
    ds_read_b64_tr_b16 a[160:161], v12 offset:28672
    ds_read_b64_tr_b16 a[162:163], v12 offset:29184
    buffer_load_dwordx4 a[92:95], v23, s[12:15], s99 offen nt
    v_mfma_f32_32x32x16_bf16 v[160:175], a[148:151], a[0:3], v[160:175]
    ds_read_b64_tr_b16 a[164:165], v13 offset:28672
    ds_read_b64_tr_b16 a[166:167], v13 offset:29184
    v_mul_f32 v244, 0x3fb8aa3b, v17
    v_mul_f32 v245, 0x3fb8aa3b, v19
    v_mov_b32 v236, s61
    v_mov_b32 v237, s61
    v_mov_b32 v238, s61
    s_waitcnt lgkmcnt(6)
    v_mfma_f32_32x32x16_bf16 v[128:143], a[152:155], a[4:7], v[128:143]
    ds_read_b64_tr_b16 a[168:169], v12 offset:30720
    ds_read_b64_tr_b16 a[170:171], v12 offset:31232
    buffer_load_dwordx4 a[96:99], v24, s[12:15], s99 offen nt
    v_mov_b32 v239, s61
    v_mfma_f32_32x32x16_bf16 v[160:175], a[156:159], a[4:7], v[160:175]
    ds_read_b64_tr_b16 a[172:173], v13 offset:30720
    ds_read_b64_tr_b16 a[174:175], v13 offset:31232
    v_mov_b32 v246, v34
    v_add_u32 v247, 36864, v35
    v_mov_b32 v48, v61
    v_xor_b32 v49, 32, v61
    v_mov_b32 v50, v62
    s_waitcnt lgkmcnt(4)
    v_mfma_f32_32x32x16_bf16 v[128:143], a[160:163], a[8:11], v[128:143]
    ds_read_b64_tr_b16 a[176:177], v12 offset:32768
    ds_read_b64_tr_b16 a[178:179], v12 offset:33280
    buffer_load_dwordx4 a[100:103], v25, s[12:15], s99 offen nt
    v_xor_b32 v51, 32, v62
    v_mfma_f32_32x32x16_bf16 v[160:175], a[164:167], a[8:11], v[160:175]
    ds_read_b64_tr_b16 a[180:181], v13 offset:32768
    ds_read_b64_tr_b16 a[182:183], v13 offset:33280
    v_mov_b32 v52, v63
    v_xor_b32 v53, 32, v63
    v_mov_b32 v2, v60
    v_xor_b32 v3, 16, v60
    v_xor_b32 v4, 32, v60
    s_waitcnt lgkmcnt(4)
    v_mfma_f32_32x32x16_bf16 v[128:143], a[168:171], a[12:15], v[128:143]
    ds_read_b64_tr_b16 a[184:185], v12 offset:34816
    ds_read_b64_tr_b16 a[186:187], v12 offset:35328
    buffer_load_dwordx4 a[104:107], v26, s[12:15], s99 offen nt
    v_xor_b32 v5, 48, v60
    v_mfma_f32_32x32x16_bf16 v[160:175], a[172:175], a[12:15], v[160:175]
    ds_read_b64_tr_b16 a[188:189], v13 offset:34816
    ds_read_b64_tr_b16 a[190:191], v13 offset:35328
    v_xor_b32 v6, 64, v60
    v_xor_b32 v7, 80, v60
    v_xor_b32 v8, 96, v60
    v_xor_b32 v9, 112, v60
    s_lshl_b32 s27, s26, 10
    s_waitcnt lgkmcnt(4)
    v_mfma_f32_32x32x16_bf16 v[128:143], a[176:179], a[32:35], v[128:143]
    ds_read_b64_tr_b16 a[192:193], v12 offset:36864
    ds_read_b64_tr_b16 a[194:195], v12 offset:37376
    buffer_load_dwordx4 a[108:111], v27, s[12:15], s99 offen nt
    v_add_u32 v63, s27, v252
    v_mfma_f32_32x32x16_bf16 v[160:175], a[180:183], a[32:35], v[160:175]
    ds_read_b64_tr_b16 a[196:197], v13 offset:36864
    ds_read_b64_tr_b16 a[198:199], v13 offset:37376
    v_add_u32 v20, s63, v252
    s_mov_b32 s80, 0xff000000
    s_mov_b32 s81, 0xff000000
    v_mov_b32 v61, 0x40000000
    v_cndmask_b32 v62, v63, v61, s[80:81]
    s_waitcnt lgkmcnt(4)
    v_mfma_f32_32x32x16_bf16 v[128:143], a[184:187], a[36:39], v[128:143]
    ds_read_b64_tr_b16 a[200:201], v12 offset:38912
    ds_read_b64_tr_b16 a[202:203], v12 offset:39424
    v_cndmask_b32 v60, v252, v61, s[80:81]
    s_lshl_b32 s28, s26, 4
    s_mov_b64 s[82:83], 0xffff
    s_lshl_b64 s[82:83], s[82:83], s28
    s_mul_i32 s31, s40, 40960
    v_mfma_f32_32x32x16_bf16 v[160:175], a[188:191], a[36:39], v[160:175]
    ds_read_b64_tr_b16 a[204:205], v13 offset:38912
    ds_read_b64_tr_b16 a[206:207], v13 offset:39424
    s_mul_i32 s29, s41, 5120
    s_add_u32 s31, s31, 0x3a0000
    s_add_u32 s29, s29, s31
    s_add_u32 s30, s29, 4096
    s_lshl_b32 s62, s40, 9
    s_waitcnt lgkmcnt(4)
    v_mfma_f32_32x32x16_bf16 v[128:143], a[192:195], a[40:43], v[128:143]
    ds_read_b64_tr_b16 a[208:209], v12 offset:40960
    ds_read_b64_tr_b16 a[210:211], v12 offset:41472
    s_add_u32 s62, s62, 0x5000
    s_lshr_b32 s27, s41, 1
    s_mul_i32 s27, s27, 120
    s_lshl_b32 s80, s41, 2
    s_add_u32 s27, s27, s80
    v_mfma_f32_32x32x16_bf16 v[160:175], a[196:199], a[40:43], v[160:175]
    ds_read_b64_tr_b16 a[212:213], v13 offset:40960
    ds_read_b64_tr_b16 a[214:215], v13 offset:41472
    s_add_u32 s27, s27, s62
    s_lshl_b32 s80, s26, 7
    s_add_u32 s62, s62, s80
    s_lshl_b32 s88, s25, 8
    s_add_u32 s88, s88, 0x1d800
    s_waitcnt lgkmcnt(4)
    v_mfma_f32_32x32x16_bf16 v[128:143], a[200:203], a[44:47], v[128:143]
    ds_read_b64_tr_b16 a[216:217], v12 offset:43008
    ds_read_b64_tr_b16 a[218:219], v12 offset:43520
    s_lshl_b32 s28, s26, 7
    s_lshl_b32 s80, s24, 2
    s_add_u32 s28, s28, s80
    s_add_u32 s28, s28, s88
    s_lshr_b32 s80, s26, 1
    v_mfma_f32_32x32x16_bf16 v[160:175], a[204:207], a[44:47], v[160:175]
    ds_read_b64_tr_b16 a[220:221], v13 offset:43008
    ds_read_b64_tr_b16 a[222:223], v13 offset:43520
    s_lshl_b32 s80, s80, 30
    s_add_u32 s28, s28, s80
    v_lshlrev_b32 v59, 2, v1
    s_waitcnt lgkmcnt(4)
    v_mfma_f32_32x32x16_bf16 v[192:207], a[208:211], v[236:239], 0
    ds_read_b64_tr_b16 a[224:225], v12 offset:45056
    ds_read_b64_tr_b16 a[226:227], v12 offset:45568
    v_mfma_f32_32x32x16_bf16 v[208:223], a[212:215], v[236:239], 0
    ds_read_b64_tr_b16 a[228:229], v13 offset:45056
    ds_read_b64_tr_b16 a[230:231], v13 offset:45568
    s_waitcnt lgkmcnt(4)
    v_mfma_f32_32x32x16_bf16 v[192:207], a[216:219], v[236:239], v[192:207]
    ds_read_b64_tr_b16 a[232:233], v12 offset:47104
    ds_read_b64_tr_b16 a[234:235], v12 offset:47616
    v_mfma_f32_32x32x16_bf16 v[208:223], a[220:223], v[236:239], v[208:223]
    ds_read_b64_tr_b16 a[236:237], v13 offset:47104
    ds_read_b64_tr_b16 a[238:239], v13 offset:47616
    s_waitcnt lgkmcnt(4)
    v_mfma_f32_32x32x16_bf16 v[192:207], a[224:227], v[236:239], v[192:207]
    v_mfma_f32_32x32x16_bf16 v[208:223], a[228:231], v[236:239], v[208:223]
    s_waitcnt lgkmcnt(0)
    v_mfma_f32_32x32x16_bf16 v[192:207], a[232:235], v[236:239], v[192:207]
    s_waitcnt vmcnt(6)
    ds_write_b128 v35, a[64:67] offset:0
    v_mfma_f32_32x32x16_bf16 v[208:223], a[236:239], v[236:239], v[208:223]
    ds_write_b128 v35, a[68:71] offset:1024
    ds_write_b128 v35, a[72:75] offset:2048
    v_mfma_f32_32x32x16_bf16 v[144:159], a[144:147], a[16:19], v[144:159]
    ds_write_b128 v35, a[76:79] offset:3072
    v_mfma_f32_32x32x16_bf16 v[176:191], a[148:151], a[16:19], v[176:191]
    ds_write_b128 v35, a[80:83] offset:4096
    ds_write_b128 v35, a[84:87] offset:5120
    v_mfma_f32_32x32x16_bf16 v[144:159], a[152:155], a[20:23], v[144:159]
    ds_read_b64_tr_b16 a[112:113], v28 offset:0
    ds_read_b64_tr_b16 a[114:115], v28 offset:768
    ds_read_b64_tr_b16 a[116:117], v29 offset:0
    ds_read_b64_tr_b16 a[118:119], v29 offset:768
    ds_read_b64_tr_b16 a[120:121], v30 offset:0
    ds_read_b64_tr_b16 a[122:123], v30 offset:768
    v_mfma_f32_32x32x16_bf16 v[176:191], a[156:159], a[20:23], v[176:191]
    ds_read_b64_tr_b16 a[124:125], v31 offset:0
    ds_read_b64_tr_b16 a[126:127], v31 offset:768
    ds_read_b64_tr_b16 a[128:129], v32 offset:0
    ds_read_b64_tr_b16 a[130:131], v32 offset:768
    v_add_u32 v10, 36864, v28
    v_add_u32 v11, 36864, v29
    v_add_u32 v12, 36864, v30
    v_mfma_f32_32x32x16_bf16 v[144:159], a[160:163], a[24:27], v[144:159]
    s_waitcnt lgkmcnt(0)
    buffer_store_dwordx4 a[112:115], v252, s[4:7], s98 offen offset:0 sc1
    v_add_u32 v13, 36864, v31
    v_add_u32 v14, 36864, v32
    v_add_u32 v15, 36864, v33
    v_mfma_f32_32x32x16_bf16 v[176:191], a[164:167], a[24:27], v[176:191]
    v_pk_fma_f32 v[136:137], v[200:201], v[16:17], v[136:137] op_sel_hi:[1,0,1]
    v_pk_fma_f32 v[138:139], v[202:203], v[16:17], v[138:139] op_sel_hi:[1,0,1]
    v_pk_fma_f32 v[140:141], v[204:205], v[16:17], v[140:141] op_sel_hi:[1,0,1]
    v_pk_fma_f32 v[142:143], v[206:207], v[16:17], v[142:143] op_sel_hi:[1,0,1]
    v_pk_mul_f32 v[140:141], v[140:141], v[16:17] op_sel:[0,1] op_sel_hi:[1,1]
    v_pk_mul_f32 v[142:143], v[142:143], v[16:17] op_sel:[0,1] op_sel_hi:[1,1]
    v_cvt_pk_bf16_f32 v68, v136, v137
    v_mfma_f32_32x32x16_bf16 v[144:159], a[168:171], a[28:31], v[144:159]
    buffer_store_dwordx4 a[116:119], v252, s[4:7], s98 offen offset:1024 sc1
    v_cvt_pk_bf16_f32 v69, v138, v139
    v_cvt_pk_bf16_f32 v70, v140, v141
    v_cvt_pk_bf16_f32 v71, v142, v143
    v_mfma_f32_32x32x16_bf16 v[176:191], a[172:175], a[28:31], v[176:191]
    v_pk_fma_f32 v[160:161], v[208:209], v[16:17], v[160:161] op_sel_hi:[1,0,1]
    v_pk_fma_f32 v[162:163], v[210:211], v[16:17], v[162:163] op_sel_hi:[1,0,1]
    v_pk_fma_f32 v[164:165], v[212:213], v[16:17], v[164:165] op_sel_hi:[1,0,1]
    v_pk_fma_f32 v[166:167], v[214:215], v[16:17], v[166:167] op_sel_hi:[1,0,1]
    v_cvt_pk_bf16_f32 v72, v160, v161
    v_cvt_pk_bf16_f32 v73, v162, v163
    v_cvt_pk_bf16_f32 v74, v164, v165
    v_mfma_f32_32x32x16_bf16 v[144:159], a[176:179], a[48:51], v[144:159]
    buffer_store_dwordx4 a[120:123], v252, s[4:7], s98 offen offset:2048 sc1
    v_cvt_pk_bf16_f32 v75, v166, v167
    v_mfma_f32_32x32x16_bf16 v[112:127], v[232:235], v[68:71], 0
    s_nop 0
    v_mfma_f32_32x32x16_bf16 v[112:127], v[224:227], v[72:75], v[112:127]
    v_mfma_f32_32x32x16_bf16 v[176:191], a[180:183], a[48:51], v[176:191]
    v_pk_fma_f32 v[168:169], v[216:217], v[16:17], v[168:169] op_sel_hi:[1,0,1]
    v_pk_fma_f32 v[170:171], v[218:219], v[16:17], v[170:171] op_sel_hi:[1,0,1]
    v_pk_fma_f32 v[172:173], v[220:221], v[16:17], v[172:173] op_sel_hi:[1,0,1]
    v_pk_fma_f32 v[174:175], v[222:223], v[16:17], v[174:175] op_sel_hi:[1,0,1]
    v_pk_mul_f32 v[168:169], v[168:169], v[16:17] op_sel:[0,1] op_sel_hi:[1,1]
    v_pk_mul_f32 v[170:171], v[170:171], v[16:17] op_sel:[0,1] op_sel_hi:[1,1]
    v_pk_mul_f32 v[172:173], v[172:173], v[16:17] op_sel:[0,1] op_sel_hi:[1,1]
    v_mfma_f32_32x32x16_bf16 v[144:159], a[184:187], a[52:55], v[144:159]
    buffer_store_dwordx4 a[124:127], v252, s[4:7], s98 offen offset:3072 sc1
    v_pk_mul_f32 v[174:175], v[174:175], v[16:17] op_sel:[0,1] op_sel_hi:[1,1]
    v_cvt_pk_bf16_f32 v76, v168, v169
    v_cvt_pk_bf16_f32 v77, v170, v171
    v_mfma_f32_32x32x16_bf16 v[176:191], a[188:191], a[52:55], v[176:191]
    v_cvt_pk_bf16_f32 v78, v172, v173
    v_cvt_pk_bf16_f32 v79, v174, v175
    v_mov_b32 v58, s61
    v_cndmask_b32 v56, v58, v70, s[58:59]
    v_cndmask_b32 v57, v58, v71, s[58:59]
    ds_write_b64 v7, v[76:77] offset:0
    v_mfma_f32_32x32x16_bf16 v[144:159], a[192:195], a[56:59], v[144:159]
    s_add_u32 s98, s98, 4096
    buffer_store_dwordx4 a[128:131], v252, s[4:7], s98 offen offset:0 sc1
    ds_write_b64 v8, v[78:79] offset:0
    v_mfma_f32_32x32x16_bf16 v[176:191], a[196:199], a[56:59], v[176:191]
    ds_write_b64 v9, v[56:57] offset:0
    v_pk_fma_f32 v[128:129], v[192:193], v[16:17], v[128:129] op_sel_hi:[1,0,1]
    v_pk_fma_f32 v[130:131], v[194:195], v[16:17], v[130:131] op_sel_hi:[1,0,1]
    v_pk_fma_f32 v[132:133], v[196:197], v[16:17], v[132:133] op_sel_hi:[1,0,1]
    v_mfma_f32_32x32x16_bf16 v[144:159], a[200:203], a[60:63], v[144:159]
    v_pk_fma_f32 v[134:135], v[198:199], v[16:17], v[134:135] op_sel_hi:[1,0,1]
    v_cvt_pk_bf16_f32 v64, v128, v129
    v_cvt_pk_bf16_f32 v65, v130, v131
    v_cvt_pk_bf16_f32 v66, v132, v133
    v_cvt_pk_bf16_f32 v67, v134, v135
    v_max3_f32 v36, v112, v113, v114
    v_min3_f32 v37, v112, v113, v114
    v_mfma_f32_32x32x16_bf16 v[176:191], a[204:207], a[60:63], v[176:191]
    v_max3_f32 v36, v36, v115, v116
    v_min3_f32 v37, v37, v115, v116
    v_max3_f32 v36, v36, v117, v118
    v_min3_f32 v37, v37, v117, v118
    v_max3_f32 v36, v36, v119, v120
    v_min3_f32 v37, v37, v119, v120
    v_max_f32 v38, v36, v121
    v_min_f32 v39, v37, v121
    v_max_f32 v36, v36, v121
    v_min_f32 v37, v37, v121
    s_nop 0
    v_permlane32_swap_b32 v36, v38
    v_permlane32_swap_b32 v37, v39
    v_max_f32 v36, v36, v38
    v_min_f32 v37, v37, v39
    v_pk_mul_f32 v[36:37], v[36:37], v[244:245] op_sel:[0,0] op_sel_hi:[1,0]
    v_pk_fma_f32 v[88:89], v[112:113], v[244:245], v[36:37] op_sel:[0,0,0] op_sel_hi:[1,0,0] neg_lo:[0,0,1] neg_hi:[0,0,1]
    v_pk_fma_f32 v[98:99], v[112:113], v[244:245], v[36:37] op_sel:[0,0,1] op_sel_hi:[1,0,1] neg_lo:[1,0,0] neg_hi:[1,0,0]
    v_pk_fma_f32 v[90:91], v[114:115], v[244:245], v[36:37] op_sel:[0,0,0] op_sel_hi:[1,0,0] neg_lo:[0,0,1] neg_hi:[0,0,1]
    v_pk_fma_f32 v[100:101], v[114:115], v[244:245], v[36:37] op_sel:[0,0,1] op_sel_hi:[1,0,1] neg_lo:[1,0,0] neg_hi:[1,0,0]
    v_pk_fma_f32 v[92:93], v[116:117], v[244:245], v[36:37] op_sel:[0,0,0] op_sel_hi:[1,0,0] neg_lo:[0,0,1] neg_hi:[0,0,1]
    v_pk_fma_f32 v[102:103], v[116:117], v[244:245], v[36:37] op_sel:[0,0,1] op_sel_hi:[1,0,1] neg_lo:[1,0,0] neg_hi:[1,0,0]
    v_pk_fma_f32 v[94:95], v[118:119], v[244:245], v[36:37] op_sel:[0,0,0] op_sel_hi:[1,0,0] neg_lo:[0,0,1] neg_hi:[0,0,1]
    v_pk_fma_f32 v[104:105], v[118:119], v[244:245], v[36:37] op_sel:[0,0,1] op_sel_hi:[1,0,1] neg_lo:[1,0,0] neg_hi:[1,0,0]
    v_pk_fma_f32 v[96:97], v[120:121], v[244:245], v[36:37] op_sel:[0,0,0] op_sel_hi:[1,0,0] neg_lo:[0,0,1] neg_hi:[0,0,1]
    v_pk_fma_f32 v[106:107], v[120:121], v[244:245], v[36:37] op_sel:[0,0,1] op_sel_hi:[1,0,1] neg_lo:[1,0,0] neg_hi:[1,0,0]
    v_exp_f32 v88, v88
    v_exp_f32 v89, v89
    v_exp_f32 v90, v90
    v_exp_f32 v91, v91
    v_exp_f32 v92, v92
    v_exp_f32 v93, v93
    v_exp_f32 v94, v94
    v_exp_f32 v95, v95
    v_exp_f32 v96, v96
    v_exp_f32 v97, v97
    v_exp_f32 v98, v98
    v_exp_f32 v99, v99
    v_exp_f32 v100, v100
    v_exp_f32 v101, v101
    v_exp_f32 v102, v102
    v_exp_f32 v103, v103
    v_exp_f32 v104, v104
    v_exp_f32 v105, v105
    v_exp_f32 v106, v106
    v_exp_f32 v107, v107
    v_pk_add_f32 v[40:41], v[88:89], v[90:91]
    v_pk_add_f32 v[42:43], v[98:99], v[100:101]
    v_pk_add_f32 v[40:41], v[40:41], v[92:93]
    v_pk_add_f32 v[42:43], v[42:43], v[102:103]
    v_pk_add_f32 v[40:41], v[40:41], v[94:95]
    v_pk_add_f32 v[42:43], v[42:43], v[104:105]
    v_pk_add_f32 v[40:41], v[40:41], v[96:97]
    v_pk_add_f32 v[42:43], v[42:43], v[106:107]
    v_pk_add_f32 v[40:41], v[40:41], v[40:41] op_sel:[0,1] op_sel_hi:[1,0]
    v_pk_add_f32 v[42:43], v[42:43], v[42:43] op_sel:[0,1] op_sel_hi:[1,0]
    s_nop 0
    v_permlane32_swap_b32 v40, v41
    v_permlane32_swap_b32 v42, v43
    v_add_f32 v40, v40, v41
    v_add_f32 v42, v42, v43
    v_rcp_f32 v40, v40
    v_rcp_f32 v42, v42
    v_pk_mul_f32 v[88:89], v[88:89], v[40:41] op_sel_hi:[1,0]
    v_pk_mul_f32 v[98:99], v[98:99], v[42:43] op_sel_hi:[1,0]
    v_pk_mul_f32 v[90:91], v[90:91], v[40:41] op_sel_hi:[1,0]
    v_pk_mul_f32 v[100:101], v[100:101], v[42:43] op_sel_hi:[1,0]
    v_pk_mul_f32 v[92:93], v[92:93], v[40:41] op_sel_hi:[1,0]
    v_pk_mul_f32 v[102:103], v[102:103], v[42:43] op_sel_hi:[1,0]
    v_pk_mul_f32 v[94:95], v[94:95], v[40:41] op_sel_hi:[1,0]
    v_pk_mul_f32 v[104:105], v[104:105], v[42:43] op_sel_hi:[1,0]
    v_pk_mul_f32 v[96:97], v[96:97], v[40:41] op_sel_hi:[1,0]
    v_pk_mul_f32 v[106:107], v[106:107], v[42:43] op_sel_hi:[1,0]
    v_cvt_pk_bf16_f32 v112, v88, v89
    v_cvt_pk_bf16_f32 v113, v90, v91
    v_cvt_pk_bf16_f32 v114, v92, v93
    v_cvt_pk_bf16_f32 v115, v94, v95
    v_cvt_pk_bf16_f32 v116, v96, v97
    v_cvt_pk_bf16_f32 v117, v98, v99
    v_cvt_pk_bf16_f32 v118, v100, v101
    v_cvt_pk_bf16_f32 v119, v102, v103
    v_cvt_pk_bf16_f32 v120, v104, v105
    v_cvt_pk_bf16_f32 v121, v106, v107
    ds_write_b64 v2, v[112:113] offset:0
    ds_write_b64 v3, v[114:115] offset:0
    ds_write_b64 v4, v[116:117] offset:0
    ds_write_b64 v5, v[118:119] offset:0
    ds_write_b64 v6, v[120:121] offset:0
    v_pk_fma_f32 v[152:153], v[200:201], v[18:19], v[152:153] op_sel_hi:[1,0,1]
    v_pk_fma_f32 v[154:155], v[202:203], v[18:19], v[154:155] op_sel_hi:[1,0,1]
    v_pk_fma_f32 v[156:157], v[204:205], v[18:19], v[156:157] op_sel_hi:[1,0,1]
    v_pk_fma_f32 v[158:159], v[206:207], v[18:19], v[158:159] op_sel_hi:[1,0,1]
    v_pk_mul_f32 v[156:157], v[156:157], v[18:19] op_sel:[0,1] op_sel_hi:[1,1]
    v_pk_mul_f32 v[158:159], v[158:159], v[18:19] op_sel:[0,1] op_sel_hi:[1,1]
    v_cvt_pk_bf16_f32 v84, v152, v153
    v_cvt_pk_bf16_f32 v85, v154, v155
    v_cvt_pk_bf16_f32 v86, v156, v157
    v_cvt_pk_bf16_f32 v87, v158, v159
    v_pk_fma_f32 v[176:177], v[208:209], v[18:19], v[176:177] op_sel_hi:[1,0,1]
    v_pk_fma_f32 v[178:179], v[210:211], v[18:19], v[178:179] op_sel_hi:[1,0,1]
    v_pk_fma_f32 v[180:181], v[212:213], v[18:19], v[180:181] op_sel_hi:[1,0,1]
    v_pk_fma_f32 v[182:183], v[214:215], v[18:19], v[182:183] op_sel_hi:[1,0,1]
    v_cvt_pk_bf16_f32 v88, v176, v177
    v_cvt_pk_bf16_f32 v89, v178, v179
    v_cvt_pk_bf16_f32 v90, v180, v181
    v_cvt_pk_bf16_f32 v91, v182, v183
    v_mfma_f32_32x32x16_bf16 v[112:127], v[232:235], v[84:87], 0
    s_nop 0
    v_mfma_f32_32x32x16_bf16 v[112:127], v[224:227], v[88:91], v[112:127]
    v_pk_fma_f32 v[184:185], v[216:217], v[18:19], v[184:185] op_sel_hi:[1,0,1]
    v_pk_fma_f32 v[186:187], v[218:219], v[18:19], v[186:187] op_sel_hi:[1,0,1]
    v_pk_fma_f32 v[188:189], v[220:221], v[18:19], v[188:189] op_sel_hi:[1,0,1]
    v_pk_fma_f32 v[190:191], v[222:223], v[18:19], v[190:191] op_sel_hi:[1,0,1]
    v_pk_mul_f32 v[184:185], v[184:185], v[18:19] op_sel:[0,1] op_sel_hi:[1,1]
    v_pk_mul_f32 v[186:187], v[186:187], v[18:19] op_sel:[0,1] op_sel_hi:[1,1]
    v_pk_mul_f32 v[188:189], v[188:189], v[18:19] op_sel:[0,1] op_sel_hi:[1,1]
    v_pk_mul_f32 v[190:191], v[190:191], v[18:19] op_sel:[0,1] op_sel_hi:[1,1]
    v_cvt_pk_bf16_f32 v92, v184, v185
    v_cvt_pk_bf16_f32 v93, v186, v187
    v_cvt_pk_bf16_f32 v94, v188, v189
    v_cvt_pk_bf16_f32 v95, v190, v191
    v_mov_b32 v58, s61
    v_cndmask_b32 v56, v58, v86, s[58:59]
    v_cndmask_b32 v57, v58, v87, s[58:59]
    ds_write_b64 v7, v[92:93] offset:4096
    ds_write_b64 v8, v[94:95] offset:4096
    ds_write_b64 v9, v[56:57] offset:4096
    v_pk_fma_f32 v[144:145], v[192:193], v[18:19], v[144:145] op_sel_hi:[1,0,1]
    v_pk_fma_f32 v[146:147], v[194:195], v[18:19], v[146:147] op_sel_hi:[1,0,1]
    v_pk_fma_f32 v[148:149], v[196:197], v[18:19], v[148:149] op_sel_hi:[1,0,1]
    v_pk_fma_f32 v[150:151], v[198:199], v[18:19], v[150:151] op_sel_hi:[1,0,1]
    v_cvt_pk_bf16_f32 v80, v144, v145
    v_cvt_pk_bf16_f32 v81, v146, v147
    v_cvt_pk_bf16_f32 v82, v148, v149
    v_cvt_pk_bf16_f32 v83, v150, v151
    ds_read_b64_tr_b16 v[160:161], v48 offset:0
    ds_read_b64_tr_b16 v[162:163], v49 offset:512
    ds_read_b64_tr_b16 v[164:165], v50 offset:0
    ds_read_b64_tr_b16 v[166:167], v51 offset:512
    ds_read_b64_tr_b16 v[168:169], v52 offset:0
    ds_read_b64_tr_b16 v[170:171], v53 offset:512
    ds_read_b64_tr_b16 v[172:173], v48 offset:2048
    ds_read_b64_tr_b16 v[174:175], v49 offset:2560
    ds_read_b64_tr_b16 v[176:177], v50 offset:2048
    ds_read_b64_tr_b16 v[178:179], v51 offset:2560
    ds_read_b64_tr_b16 v[180:181], v52 offset:2048
    ds_read_b64_tr_b16 v[182:183], v53 offset:2560
    v_max3_f32 v212, v112, v113, v114
    v_min3_f32 v213, v112, v113, v114
    v_max3_f32 v212, v212, v115, v116
    v_min3_f32 v213, v213, v115, v116
    v_max3_f32 v212, v212, v117, v118
    v_min3_f32 v213, v213, v117, v118
    v_max3_f32 v212, v212, v119, v120
    v_min3_f32 v213, v213, v119, v120
    v_max_f32 v214, v212, v121
    v_min_f32 v215, v213, v121
    v_max_f32 v212, v212, v121
    v_min_f32 v213, v213, v121
    s_nop 0
    v_permlane32_swap_b32 v212, v214
    v_permlane32_swap_b32 v213, v215
    v_max_f32 v212, v212, v214
    v_min_f32 v213, v213, v215
    v_pk_mul_f32 v[212:213], v[212:213], v[244:245] op_sel:[0,1] op_sel_hi:[1,1]
    v_pk_fma_f32 v[192:193], v[112:113], v[244:245], v[212:213] op_sel:[0,1,0] op_sel_hi:[1,1,0] neg_lo:[0,0,1] neg_hi:[0,0,1]
    v_pk_fma_f32 v[202:203], v[112:113], v[244:245], v[212:213] op_sel:[0,1,1] op_sel_hi:[1,1,1] neg_lo:[1,0,0] neg_hi:[1,0,0]
    v_pk_fma_f32 v[194:195], v[114:115], v[244:245], v[212:213] op_sel:[0,1,0] op_sel_hi:[1,1,0] neg_lo:[0,0,1] neg_hi:[0,0,1]
    v_pk_fma_f32 v[204:205], v[114:115], v[244:245], v[212:213] op_sel:[0,1,1] op_sel_hi:[1,1,1] neg_lo:[1,0,0] neg_hi:[1,0,0]
    v_pk_fma_f32 v[196:197], v[116:117], v[244:245], v[212:213] op_sel:[0,1,0] op_sel_hi:[1,1,0] neg_lo:[0,0,1] neg_hi:[0,0,1]
    v_pk_fma_f32 v[206:207], v[116:117], v[244:245], v[212:213] op_sel:[0,1,1] op_sel_hi:[1,1,1] neg_lo:[1,0,0] neg_hi:[1,0,0]
    v_pk_fma_f32 v[198:199], v[118:119], v[244:245], v[212:213] op_sel:[0,1,0] op_sel_hi:[1,1,0] neg_lo:[0,0,1] neg_hi:[0,0,1]
    v_pk_fma_f32 v[208:209], v[118:119], v[244:245], v[212:213] op_sel:[0,1,1] op_sel_hi:[1,1,1] neg_lo:[1,0,0] neg_hi:[1,0,0]
    v_pk_fma_f32 v[200:201], v[120:121], v[244:245], v[212:213] op_sel:[0,1,0] op_sel_hi:[1,1,0] neg_lo:[0,0,1] neg_hi:[0,0,1]
    v_pk_fma_f32 v[210:211], v[120:121], v[244:245], v[212:213] op_sel:[0,1,1] op_sel_hi:[1,1,1] neg_lo:[1,0,0] neg_hi:[1,0,0]
    v_exp_f32 v192, v192
    v_exp_f32 v193, v193
    v_exp_f32 v194, v194
    s_waitcnt lgkmcnt(6)
    v_mfma_f32_32x32x16_bf16 v[96:111], v[160:163], v[168:171], 0
    v_mfma_f32_32x32x16_bf16 v[22:37], v[164:167], v[168:171], 0
    s_waitcnt lgkmcnt(0)
    v_mfma_f32_32x32x16_bf16 v[96:111], v[172:175], v[180:183], v[96:111]
    v_mfma_f32_32x32x16_bf16 v[22:37], v[176:179], v[180:183], v[22:37]
    v_exp_f32 v195, v195
    v_exp_f32 v196, v196
    v_exp_f32 v197, v197
    v_exp_f32 v198, v198
    v_exp_f32 v199, v199
    v_exp_f32 v200, v200
    v_exp_f32 v201, v201
    v_exp_f32 v202, v202
    v_exp_f32 v203, v203
    v_exp_f32 v204, v204
    v_exp_f32 v205, v205
    v_exp_f32 v206, v206
    v_exp_f32 v207, v207
    v_exp_f32 v208, v208
    v_mfma_f32_32x32x16_bf16 v[128:143], v[224:227], v[64:67], 0
    v_mfma_f32_32x32x16_bf16 v[128:143], v[228:231], v[68:71], v[128:143]
    v_exp_f32 v209, v209
    v_exp_f32 v210, v210
    v_exp_f32 v211, v211
    v_pk_add_f32 v[216:217], v[192:193], v[194:195]
    v_pk_add_f32 v[218:219], v[202:203], v[204:205]
    v_pk_add_f32 v[216:217], v[216:217], v[196:197]
    v_pk_add_f32 v[218:219], v[218:219], v[206:207]
    v_pk_add_f32 v[216:217], v[216:217], v[198:199]
    v_pk_add_f32 v[218:219], v[218:219], v[208:209]
    v_pk_add_f32 v[216:217], v[216:217], v[200:201]
    v_mfma_f32_32x32x16_bf16 v[144:159], v[224:227], v[80:83], 0
    v_mfma_f32_32x32x16_bf16 v[144:159], v[228:231], v[84:87], v[144:159]
    v_pk_add_f32 v[218:219], v[218:219], v[210:211]
    v_pk_add_f32 v[216:217], v[216:217], v[216:217] op_sel:[0,1] op_sel_hi:[1,0]
    v_pk_add_f32 v[218:219], v[218:219], v[218:219] op_sel:[0,1] op_sel_hi:[1,0]
    s_nop 0
    v_permlane32_swap_b32 v216, v217
    v_permlane32_swap_b32 v218, v219
    v_add_f32 v216, v216, v217
    s_waitcnt vmcnt(0)
    s_mov_b64 exec, 1
    buffer_store_dword v254, off, s[4:7], s28 sc1
    s_mov_b64 exec, -1
    v_add_f32 v218, v218, v219
    v_rcp_f32 v216, v216
    v_rcp_f32 v218, v218
    v_pk_mul_f32 v[192:193], v[192:193], v[216:217] op_sel_hi:[1,0]
    v_pk_mul_f32 v[202:203], v[202:203], v[218:219] op_sel_hi:[1,0]
    v_pk_mul_f32 v[194:195], v[194:195], v[216:217] op_sel_hi:[1,0]
    v_pk_mul_f32 v[204:205], v[204:205], v[218:219] op_sel_hi:[1,0]
    v_pk_mul_f32 v[196:197], v[196:197], v[216:217] op_sel_hi:[1,0]
    v_pk_mul_f32 v[206:207], v[206:207], v[218:219] op_sel_hi:[1,0]
    v_pk_mul_f32 v[198:199], v[198:199], v[216:217] op_sel_hi:[1,0]
    v_pk_mul_f32 v[208:209], v[208:209], v[218:219] op_sel_hi:[1,0]
    v_pk_mul_f32 v[200:201], v[200:201], v[216:217] op_sel_hi:[1,0]
    v_pk_mul_f32 v[210:211], v[210:211], v[218:219] op_sel_hi:[1,0]
    v_cvt_pk_bf16_f32 v112, v192, v193
    v_cvt_pk_bf16_f32 v113, v194, v195
    v_cvt_pk_bf16_f32 v114, v196, v197
    v_cvt_pk_bf16_f32 v115, v198, v199
    v_cvt_pk_bf16_f32 v116, v200, v201
    v_cvt_pk_bf16_f32 v117, v202, v203
    v_cvt_pk_bf16_f32 v118, v204, v205
    v_cvt_pk_bf16_f32 v119, v206, v207
    v_cvt_pk_bf16_f32 v120, v208, v209
    v_cvt_pk_bf16_f32 v121, v210, v211
    ds_write_b64 v2, v[112:113] offset:4096
    ds_write_b64 v3, v[114:115] offset:4096
    ds_write_b64 v4, v[116:117] offset:4096
    ds_write_b64 v5, v[118:119] offset:4096
    ds_write_b64 v6, v[120:121] offset:4096
    ds_read_b64_tr_b16 v[160:161], v48 offset:4096
    ds_read_b64_tr_b16 v[162:163], v49 offset:4608
    ds_read_b64_tr_b16 v[164:165], v50 offset:4096
    ds_read_b64_tr_b16 v[166:167], v51 offset:4608
    ds_read_b64_tr_b16 v[168:169], v52 offset:4096
    ds_read_b64_tr_b16 v[170:171], v53 offset:4608
    ds_read_b64_tr_b16 v[172:173], v48 offset:6144
    ds_read_b64_tr_b16 v[174:175], v49 offset:6656
    ds_read_b64_tr_b16 v[176:177], v50 offset:6144
    ds_read_b64_tr_b16 v[178:179], v51 offset:6656
    ds_read_b64_tr_b16 v[180:181], v52 offset:6144
    ds_read_b64_tr_b16 v[182:183], v53 offset:6656
    s_waitcnt lgkmcnt(6)
    v_mfma_f32_32x32x16_bf16 v[96:111], v[160:163], v[168:171], v[96:111]
    v_mfma_f32_32x32x16_bf16 v[22:37], v[164:167], v[168:171], v[22:37]
    s_waitcnt lgkmcnt(0)
    v_mfma_f32_32x32x16_bf16 v[96:111], v[172:175], v[180:183], v[96:111]
    v_mfma_f32_32x32x16_bf16 v[22:37], v[176:179], v[180:183], v[22:37]
    s_nop 10
    ds_write_b128 v20, v[96:99] offset:8192
    ds_write_b128 v20, v[100:103] offset:9216
    ds_write_b128 v20, v[104:107] offset:10240
    ds_write_b128 v20, v[108:111] offset:11264
    ds_write_b128 v20, v[22:25] offset:12288
    s_waitcnt lgkmcnt(0)
    s_barrier
    ds_read_b128 v[24:27], v63 offset:8192
    ds_read_b128 v[28:31], v63 offset:24576
    ds_read_b128 v[32:35], v63 offset:40960
    ds_read_b128 v[36:39], v63 offset:57344
    ds_read_b128 v[40:43], v252 offset:12288
    ds_read_b128 v[44:47], v252 offset:28672
    ds_read_b128 v[48:51], v252 offset:45056
    ds_read_b128 v[52:55], v252 offset:61440
    s_waitcnt lgkmcnt(4)
    v_pk_add_f32 v[24:25], v[24:25], v[28:29]
    v_pk_add_f32 v[32:33], v[32:33], v[36:37]
    v_pk_add_f32 v[26:27], v[26:27], v[30:31]
    v_pk_add_f32 v[34:35], v[34:35], v[38:39]
    v_pk_add_f32 v[24:25], v[24:25], v[32:33]
    v_pk_add_f32 v[26:27], v[26:27], v[34:35]
    buffer_store_dwordx4 v[24:27], v62, s[4:7], s29 offen sc1
    s_waitcnt lgkmcnt(0)
    v_pk_add_f32 v[40:41], v[40:41], v[44:45]
    v_pk_add_f32 v[48:49], v[48:49], v[52:53]
    v_pk_add_f32 v[42:43], v[42:43], v[46:47]
    v_pk_add_f32 v[50:51], v[50:51], v[54:55]
    v_pk_add_f32 v[40:41], v[40:41], v[48:49]
    v_pk_add_f32 v[42:43], v[42:43], v[50:51]
    s_mov_b64 exec, s[82:83]
    buffer_store_dwordx4 v[40:43], v60, s[4:7], s30 offen sc1
    s_mov_b64 exec, -1
    v_max3_f32 v180, v128, v129, v130
    v_min3_f32 v181, v128, v129, v130
    v_max3_f32 v212, v144, v145, v146
    v_min3_f32 v213, v144, v145, v146
    v_max3_f32 v180, v180, v131, v132
    v_min3_f32 v181, v181, v131, v132
    ds_write_b128 v247, a[88:91] offset:0
    v_max3_f32 v212, v212, v147, v148
    v_min3_f32 v213, v213, v147, v148
    v_max3_f32 v180, v180, v133, v134
    v_min3_f32 v181, v181, v133, v134
    v_max3_f32 v212, v212, v149, v150
    v_min3_f32 v213, v213, v149, v150
    ds_write_b128 v247, a[92:95] offset:1024
    v_max3_f32 v180, v180, v135, v136
    v_min3_f32 v181, v181, v135, v136
    v_max3_f32 v212, v212, v151, v152
    v_min3_f32 v213, v213, v151, v152
    v_max_f32 v182, v180, v137
    v_min_f32 v183, v181, v137
    ds_write_b128 v247, a[96:99] offset:2048
    v_max_f32 v214, v212, v153
    v_min_f32 v215, v213, v153
    v_max_f32 v180, v180, v137
    v_min_f32 v181, v181, v137
    v_max_f32 v212, v212, v153
    v_min_f32 v213, v213, v153
    ds_write_b128 v247, a[100:103] offset:3072
    v_permlane32_swap_b32 v180, v182
    v_permlane32_swap_b32 v181, v183
    v_permlane32_swap_b32 v212, v214
    v_permlane32_swap_b32 v213, v215
    v_max_f32 v180, v180, v182
    v_min_f32 v181, v181, v183
    ds_write_b128 v247, a[104:107] offset:4096
    v_max_f32 v212, v212, v214
    v_min_f32 v213, v213, v215
    v_pk_mul_f32 v[180:181], v[180:181], v[244:245] op_sel:[0,0] op_sel_hi:[1,0]
    v_pk_fma_f32 v[160:161], v[128:129], v[244:245], v[180:181] op_sel:[0,0,0] op_sel_hi:[1,0,0] neg_lo:[0,0,1] neg_hi:[0,0,1]
    v_pk_mul_f32 v[212:213], v[212:213], v[244:245] op_sel:[0,1] op_sel_hi:[1,1]
    v_pk_fma_f32 v[192:193], v[144:145], v[244:245], v[212:213] op_sel:[0,1,0] op_sel_hi:[1,1,0] neg_lo:[0,0,1] neg_hi:[0,0,1]
    ds_write_b128 v247, a[108:111] offset:5120
    v_pk_fma_f32 v[170:171], v[128:129], v[244:245], v[180:181] op_sel:[0,0,1] op_sel_hi:[1,0,1] neg_lo:[1,0,0] neg_hi:[1,0,0]
    v_pk_fma_f32 v[162:163], v[130:131], v[244:245], v[180:181] op_sel:[0,0,0] op_sel_hi:[1,0,0] neg_lo:[0,0,1] neg_hi:[0,0,1]
    v_pk_fma_f32 v[202:203], v[144:145], v[244:245], v[212:213] op_sel:[0,1,1] op_sel_hi:[1,1,1] neg_lo:[1,0,0] neg_hi:[1,0,0]
    v_pk_fma_f32 v[194:195], v[146:147], v[244:245], v[212:213] op_sel:[0,1,0] op_sel_hi:[1,1,0] neg_lo:[0,0,1] neg_hi:[0,0,1]
    v_pk_fma_f32 v[172:173], v[130:131], v[244:245], v[180:181] op_sel:[0,0,1] op_sel_hi:[1,0,1] neg_lo:[1,0,0] neg_hi:[1,0,0]
    v_pk_fma_f32 v[164:165], v[132:133], v[244:245], v[180:181] op_sel:[0,0,0] op_sel_hi:[1,0,0] neg_lo:[0,0,1] neg_hi:[0,0,1]
    ds_read_b64_tr_b16 a[112:113], v10 offset:0
    ds_read_b64_tr_b16 a[114:115], v10 offset:768
    ds_read_b64_tr_b16 a[116:117], v11 offset:0
    ds_read_b64_tr_b16 a[118:119], v11 offset:768
    ds_read_b64_tr_b16 a[120:121], v12 offset:0
    ds_read_b64_tr_b16 a[122:123], v12 offset:768
    ds_read_b64_tr_b16 a[124:125], v13 offset:0
    ds_read_b64_tr_b16 a[126:127], v13 offset:768
    ds_read_b64_tr_b16 a[128:129], v14 offset:0
    ds_read_b64_tr_b16 a[130:131], v14 offset:768
    ds_read_b64_tr_b16 a[132:133], v15 offset:0
    ds_read_b64_tr_b16 a[134:135], v15 offset:768
    v_pk_fma_f32 v[204:205], v[146:147], v[244:245], v[212:213] op_sel:[0,1,1] op_sel_hi:[1,1,1] neg_lo:[1,0,0] neg_hi:[1,0,0]
    v_pk_fma_f32 v[196:197], v[148:149], v[244:245], v[212:213] op_sel:[0,1,0] op_sel_hi:[1,1,0] neg_lo:[0,0,1] neg_hi:[0,0,1]
    v_pk_fma_f32 v[174:175], v[132:133], v[244:245], v[180:181] op_sel:[0,0,1] op_sel_hi:[1,0,1] neg_lo:[1,0,0] neg_hi:[1,0,0]
    v_pk_fma_f32 v[166:167], v[134:135], v[244:245], v[180:181] op_sel:[0,0,0] op_sel_hi:[1,0,0] neg_lo:[0,0,1] neg_hi:[0,0,1]
    v_pk_fma_f32 v[206:207], v[148:149], v[244:245], v[212:213] op_sel:[0,1,1] op_sel_hi:[1,1,1] neg_lo:[1,0,0] neg_hi:[1,0,0]
    v_pk_fma_f32 v[198:199], v[150:151], v[244:245], v[212:213] op_sel:[0,1,0] op_sel_hi:[1,1,0] neg_lo:[0,0,1] neg_hi:[0,0,1]
    v_pk_fma_f32 v[176:177], v[134:135], v[244:245], v[180:181] op_sel:[0,0,1] op_sel_hi:[1,0,1] neg_lo:[1,0,0] neg_hi:[1,0,0]
    v_pk_fma_f32 v[168:169], v[136:137], v[244:245], v[180:181] op_sel:[0,0,0] op_sel_hi:[1,0,0] neg_lo:[0,0,1] neg_hi:[0,0,1]
    v_pk_fma_f32 v[208:209], v[150:151], v[244:245], v[212:213] op_sel:[0,1,1] op_sel_hi:[1,1,1] neg_lo:[1,0,0] neg_hi:[1,0,0]
    v_pk_fma_f32 v[200:201], v[152:153], v[244:245], v[212:213] op_sel:[0,1,0] op_sel_hi:[1,1,0] neg_lo:[0,0,1] neg_hi:[0,0,1]
    v_pk_fma_f32 v[178:179], v[136:137], v[244:245], v[180:181] op_sel:[0,0,1] op_sel_hi:[1,0,1] neg_lo:[1,0,0] neg_hi:[1,0,0]
    v_exp_f32 v160, v160
    v_pk_fma_f32 v[210:211], v[152:153], v[244:245], v[212:213] op_sel:[0,1,1] op_sel_hi:[1,1,1] neg_lo:[1,0,0] neg_hi:[1,0,0]
    v_exp_f32 v192, v192
    v_exp_f32 v161, v161
    v_exp_f32 v162, v162
    v_exp_f32 v193, v193
    v_exp_f32 v194, v194
    s_mul_i32 s48, s24, 0
    s_add_u32 s48, s48, s25
    s_and_b32 s48, s48, 3
    s_lshr_b32 s80, s26, 1
    s_and_b32 s81, s26, 1
    s_mul_i32 s81, s81, 12288
    s_mul_i32 s49, s80, 25600
    s_add_u32 s49, s49, s81
    s_sub_u32 s80, s80, s48
    s_and_b32 s80, s80, 3
    s_mul_i32 s46, s80, 25600
    s_xor_b32 s80, s80, 2
    s_mul_i32 s47, s80, 25600
    s_mul_i32 s80, s25, 102400
    s_add_u32 s80, s80, s81
    s_add_u32 s46, s46, s80
    s_add_u32 s47, s47, s80
    s_waitcnt vmcnt(0)
    s_barrier
    s_cmp_lg_u32 s26, 0
    s_cbranch_scc1 L_sig_7
    s_mov_b64 exec, 1
    buffer_store_dword v254, off, s[4:7], s27 sc1
    s_mov_b64 exec, -1
L_sig_7:
    s_waitcnt lgkmcnt(0)
    v_exp_f32 v163, v163
    v_exp_f32 v164, v164
    v_exp_f32 v195, v195
    v_exp_f32 v196, v196
    buffer_store_dwordx4 a[112:115], v252, s[4:7], s34 offen offset:0 sc1
    v_exp_f32 v165, v165
    v_exp_f32 v166, v166
    v_exp_f32 v197, v197
    v_exp_f32 v198, v198
    buffer_store_dwordx4 a[116:119], v252, s[4:7], s34 offen offset:1024 sc1
    v_exp_f32 v167, v167
    v_exp_f32 v168, v168
    v_exp_f32 v199, v199
    v_exp_f32 v200, v200
    buffer_store_dwordx4 a[120:123], v252, s[4:7], s34 offen offset:2048 sc1
    v_exp_f32 v169, v169
    v_exp_f32 v170, v170
    v_exp_f32 v201, v201
    v_exp_f32 v202, v202
    buffer_store_dwordx4 a[124:127], v252, s[4:7], s35 offen offset:0 sc1
    v_exp_f32 v171, v171
    v_exp_f32 v172, v172
    v_exp_f32 v203, v203
    v_exp_f32 v204, v204
    buffer_store_dwordx4 a[128:131], v252, s[4:7], s35 offen offset:1024 sc1
    v_exp_f32 v173, v173
    v_exp_f32 v174, v174
    v_exp_f32 v205, v205
    v_exp_f32 v206, v206
    buffer_store_dwordx4 a[132:135], v246, s[4:7], s35 offen offset:2048 sc1
    v_exp_f32 v175, v175
    v_exp_f32 v176, v176
    v_exp_f32 v207, v207
    v_exp_f32 v208, v208
    v_exp_f32 v177, v177
    v_exp_f32 v178, v178
    v_exp_f32 v209, v209
    v_exp_f32 v210, v210
    v_exp_f32 v179, v179
    v_pk_add_f32 v[184:185], v[160:161], v[162:163]
    v_exp_f32 v211, v211
    v_pk_add_f32 v[216:217], v[192:193], v[194:195]
    v_pk_add_f32 v[186:187], v[170:171], v[172:173]
    v_pk_add_f32 v[184:185], v[184:185], v[164:165]
    v_pk_add_f32 v[218:219], v[202:203], v[204:205]
    v_pk_add_f32 v[216:217], v[216:217], v[196:197]
    v_pk_add_f32 v[186:187], v[186:187], v[174:175]
    v_pk_add_f32 v[184:185], v[184:185], v[166:167]
    v_pk_add_f32 v[218:219], v[218:219], v[206:207]
    v_pk_add_f32 v[216:217], v[216:217], v[198:199]
    v_pk_add_f32 v[186:187], v[186:187], v[176:177]
    v_pk_add_f32 v[184:185], v[184:185], v[168:169]
    v_pk_add_f32 v[218:219], v[218:219], v[208:209]
    v_pk_add_f32 v[216:217], v[216:217], v[200:201]
    v_pk_add_f32 v[186:187], v[186:187], v[178:179]
    v_pk_add_f32 v[184:185], v[184:185], v[184:185] op_sel:[0,1] op_sel_hi:[1,0]
    v_and_b32 v19, 31, v1
    v_lshlrev_b32 v19, 2, v19
    s_lshl_b32 s98, s25, 7
    s_add_u32 s98, s98, 0x1d400
    s_mov_b32 s16, s50
    s_mov_b32 s17, s51
    s_mov_b32 s18, 0x280000
    s_mov_b32 s19, 0x00020000
    v_and_b32 v80, 15, v1
    v_lshrrev_b32 v81, 4, v1
    v_and_b32 v82, 1, v81
    v_lshrrev_b32 v83, 5, v1
    s_lshl_b32 s84, s24, 2
    s_add_u32 s84, s84, s26
    s_mul_i32 s43, s84, 20480
    s_mul_i32 s85, s25, 160
    s_add_u32 s85, s85, s43
    v_mul_u32_u24 v84, 1280, v80
    v_mul_u32_u24 v85, 40, v81
    v_add3_u32 v84, v84, v85, s85
    v_lshl_add_u32 v2, v82, 3, v84
    v_xor_b32 v85, 1, v82
    v_lshl_add_u32 v3, v85, 5, v84
    buffer_load_dwordx4 v[22:25], v2, s[8:11], 0 offen
    buffer_load_dwordx4 v[26:29], v2, s[8:11], 0 offen offset:16
    buffer_load_dwordx2 v[30:31], v3, s[8:11], 0 offen
    v_pk_add_f32 v[218:219], v[218:219], v[210:211]
    v_pk_add_f32 v[216:217], v[216:217], v[216:217] op_sel:[0,1] op_sel_hi:[1,0]
    v_pk_add_f32 v[186:187], v[186:187], v[186:187] op_sel:[0,1] op_sel_hi:[1,0]
    v_permlane32_swap_b32 v184, v185
    v_pk_add_f32 v[218:219], v[218:219], v[218:219] op_sel:[0,1] op_sel_hi:[1,0]
    v_permlane32_swap_b32 v216, v217
    v_permlane32_swap_b32 v186, v187
    v_add_f32 v184, v184, v185
    v_permlane32_swap_b32 v218, v219
    v_add_f32 v216, v216, v217
    v_add_f32 v186, v186, v187
    v_rcp_f32 v184, v184
    v_add_f32 v218, v218, v219
    v_rcp_f32 v216, v216
    v_rcp_f32 v186, v186
    v_pk_mul_f32 v[160:161], v[160:161], v[184:185] op_sel_hi:[1,0]
    v_rcp_f32 v218, v218
    v_pk_mul_f32 v[192:193], v[192:193], v[216:217] op_sel_hi:[1,0]
    v_pk_mul_f32 v[170:171], v[170:171], v[186:187] op_sel_hi:[1,0]
    v_pk_mul_f32 v[162:163], v[162:163], v[184:185] op_sel_hi:[1,0]
    buffer_load_dword v58, v59, s[4:7], s88 offen sc1
    s_buffer_load_dwordx2 s[64:65], s[4:7], s62 glc
    v_pk_mul_f32 v[202:203], v[202:203], v[218:219] op_sel_hi:[1,0]
    v_pk_mul_f32 v[194:195], v[194:195], v[216:217] op_sel_hi:[1,0]
    v_pk_mul_f32 v[172:173], v[172:173], v[186:187] op_sel_hi:[1,0]
    v_pk_mul_f32 v[164:165], v[164:165], v[184:185] op_sel_hi:[1,0]
    v_pk_mul_f32 v[204:205], v[204:205], v[218:219] op_sel_hi:[1,0]
    v_pk_mul_f32 v[196:197], v[196:197], v[216:217] op_sel_hi:[1,0]
    v_pk_mul_f32 v[174:175], v[174:175], v[186:187] op_sel_hi:[1,0]
    v_pk_mul_f32 v[166:167], v[166:167], v[184:185] op_sel_hi:[1,0]
    v_pk_mul_f32 v[206:207], v[206:207], v[218:219] op_sel_hi:[1,0]
    v_pk_mul_f32 v[198:199], v[198:199], v[216:217] op_sel_hi:[1,0]
    v_pk_mul_f32 v[176:177], v[176:177], v[186:187] op_sel_hi:[1,0]
    v_pk_mul_f32 v[168:169], v[168:169], v[184:185] op_sel_hi:[1,0]
    v_pk_mul_f32 v[208:209], v[208:209], v[218:219] op_sel_hi:[1,0]
    v_pk_mul_f32 v[200:201], v[200:201], v[216:217] op_sel_hi:[1,0]
    v_pk_mul_f32 v[178:179], v[178:179], v[186:187] op_sel_hi:[1,0]
    v_cvt_pk_bf16_f32 v96, v160, v161
    v_pk_mul_f32 v[210:211], v[210:211], v[218:219] op_sel_hi:[1,0]
    v_cvt_pk_bf16_f32 v108, v192, v193
    v_cvt_pk_bf16_f32 v97, v162, v163
    v_cvt_pk_bf16_f32 v98, v164, v165
    v_cvt_pk_bf16_f32 v109, v194, v195
    v_cvt_pk_bf16_f32 v110, v196, v197
    v_cvt_pk_bf16_f32 v99, v166, v167
    v_cvt_pk_bf16_f32 v100, v168, v169
    v_cvt_pk_bf16_f32 v111, v198, v199
    v_cvt_pk_bf16_f32 v112, v200, v201
    v_cvt_pk_bf16_f32 v101, v170, v171
    v_cvt_pk_bf16_f32 v102, v172, v173
    v_cvt_pk_bf16_f32 v113, v202, v203
    v_cvt_pk_bf16_f32 v114, v204, v205
    v_cvt_pk_bf16_f32 v103, v174, v175
    v_cvt_pk_bf16_f32 v104, v176, v177
    v_cvt_pk_bf16_f32 v115, v206, v207
    v_cvt_pk_bf16_f32 v116, v208, v209
    v_cvt_pk_bf16_f32 v105, v178, v179
    v_cvt_pk_bf16_f32 v117, v210, v211
    v_mov_b32 v106, 0
    v_mov_b32 v107, 0
    v_mov_b32 v118, 0
    v_mov_b32 v119, 0
    s_lshr_b32 s80, s26, 1
    s_lshl_b32 s80, s80, 10
    s_and_b32 s81, s26, 1
    s_lshl_b32 s81, s81, 3
    s_add_u32 s80, s80, s81
    s_add_u32 s80, s80, 153600
    v_add_u32 v20, s80, v252
    v_add_u32 v21, 153600, v252
    s_lshl_b32 s29, s41, 11
    s_lshl_b32 s30, s40, 2
    s_add_u32 s29, s29, s30
    s_lshr_b32 s30, s40, 3
    s_mul_i32 s30, s30, 96
    s_add_u32 s29, s29, s30
    s_add_u32 s29, s29, 0x9000
    v_lshlrev_b32 v66, 9, v1
    v_and_b32 v64, 15, v1
    s_lshl_b32 s80, s26, 8
    v_lshl_add_u32 v64, v64, 4, s80
    v_lshrrev_b32 v67, 4, v1
    v_mul_u32_u24 v67, 5120, v67
    v_add_u32 v67, v67, v64
    v_add_u32 v67, 4096, v67
    v_and_b32 v65, 0x180, v64
    v_cmp_eq_u32 vcc, 0x180, v65
    v_mov_b32 v65, v65
    s_nop 0
    v_cndmask_b32 v67, v67, v61, vcc
    v_add_u32 v64, 155648, v64
    s_lshl_b32 s97, s24, 2
    s_add_u32 s97, s97, s98
    s_add_u32 s97, s97, 0x0
    s_mov_b32 s60, 0
    s_branch L_pc_10
L_poll_9:
    s_buffer_load_dwordx2 s[64:65], s[4:7], s62 glc
    s_add_u32 s60, s60, 1
    s_cmp_gt_u32 s60, 400000
    s_cbranch_scc1 L_end
L_pc_10:
    s_waitcnt lgkmcnt(0)
    s_xor_b64 s[64:65], s[64:65], s[56:57]
    s_cbranch_scc1 L_poll_9
L_p1_8:
    s_waitcnt vmcnt(4)
    s_barrier
    s_cmp_lg_u32 s26, 0
    s_cbranch_scc1 L_sig_11
    s_mov_b64 exec, 1
    buffer_store_dword v254, off, s[4:7], s97 sc1
    s_mov_b64 exec, -1
L_sig_11:
    buffer_load_dwordx4 v[128:131], v62, s[4:7], s31 offen sc1
    buffer_load_dwordx4 v[192:195], v67, s[4:7], s31 offen sc1
    s_add_u32 s31, s31, 5120
    buffer_load_dwordx4 v[132:135], v62, s[4:7], s31 offen sc1
    s_add_u32 s31, s31, 5120
    buffer_load_dwordx4 v[136:139], v62, s[4:7], s31 offen sc1
    s_add_u32 s31, s31, 5120
    buffer_load_dwordx4 v[140:143], v62, s[4:7], s31 offen sc1
    s_add_u32 s31, s31, 5120
    buffer_load_dwordx4 v[144:147], v62, s[4:7], s31 offen sc1
    buffer_load_dwordx4 v[196:199], v67, s[4:7], s31 offen sc1
    s_add_u32 s31, s31, 5120
    buffer_load_dwordx4 v[148:151], v62, s[4:7], s31 offen sc1
    s_add_u32 s31, s31, 5120
    buffer_load_dwordx4 v[152:155], v62, s[4:7], s31 offen sc1
    s_add_u32 s31, s31, 5120
    buffer_load_dwordx4 v[156:159], v62, s[4:7], s31 offen sc1
    s_add_u32 s31, s98, 0x0
    s_waitcnt vmcnt(10)
    v_cmp_ne_u32 vcc, s56, v58
    s_cbranch_vccz L_vc_12
    s_mov_b32 s60, 0
L_vs_13:
    buffer_load_dword v58, v59, s[4:7], s88 offen sc1
    s_add_u32 s60, s60, 1
    s_cmp_gt_u32 s60, 400000
    s_cbranch_scc1 L_end
    s_waitcnt vmcnt(0)
    v_cmp_ne_u32 vcc, s56, v58
    s_cbranch_vccnz L_vs_13
L_vc_12:
    s_mul_i32 s85, s25, 2560
    v_mul_u32_u24 v84, 1280, v83
    v_add_u32 v84, s85, v84
    v_lshl_add_u32 v85, v82, 3, v84
    s_add_u32 m0, s49, 0
    s_add_u32 s96, s46, 0x14e0000
    buffer_load_dwordx4 v252, s[4:7], s96 offen offset:0 sc1 lds
    v_add_u32 v85, 512, v85
    v_mul_u32_u24 v86, 768, v82
    v_add_u32 v84, v84, v86
    v_lshl_add_u32 v4, v80, 4, v84
    buffer_load_dwordx4 v252, s[4:7], s96 offen offset:1024 sc1 lds
    v_lshl_add_u32 v5, v80, 4, v85
    s_lshr_b32 s85, s25, 2
    s_add_u32 s85, s85, 1
    s_sub_u32 s86, 0, s85
    s_bitcmp1_b32 s25, 1
    s_cselect_b32 s85, s86, s85
    s_cselect_b32 s87, -1, 1
    s_lshl_b32 s86, s84, 4
    s_add_u32 s85, s85, s86
    v_add_u32 v86, s85, v80
    buffer_load_dwordx4 v252, s[4:7], s96 offen offset:2048 sc1 lds
    v_lshrrev_b32 v87, 4, v86
    v_mul_u32_u24 v87, 20480, v87
    v_cmp_gt_u32 vcc, 0x800, v86
    v_and_b32 v86, 15, v86
    buffer_load_dwordx4 v252, s[4:7], s96 offen offset:3072 sc1 lds
    v_lshl_add_u32 v86, v86, 4, v87
    v_mov_b32 v87, 0x40000000
    v_cndmask_b32 v86, v87, v86, vcc
    v_add_u32 v6, v84, v86
    s_add_u32 m0, s49, 4096
    s_add_u32 s96, s46, 0x14e1000
    buffer_load_dwordx4 v252, s[4:7], s96 offen offset:0 sc1 lds
    v_add_u32 v7, v85, v86
    v_lshlrev_b32 v84, 8, v81
    s_lshl_b32 s38, s24, 9
    s_lshr_b32 s85, s25, 1
    s_mul_i32 s85, s85, 120
    s_lshl_b32 s42, s25, 2
    s_add_u32 s85, s85, s42
    s_add_u32 s39, s38, s85
    s_add_u32 s87, s87, s24
    s_and_b32 s87, s87, 31
    s_lshl_b32 s87, s87, 9
    s_add_u32 s42, s87, s85
    s_add_u32 s42, s42, 0x11008
    s_lshl_b32 s85, s26, 7
    s_add_u32 s38, s38, s85
    s_lshl_b32 s45, s24, 12
    s_lshl_b32 s85, s26, 7
    s_add_u32 s45, s45, s85
    s_lshl_b32 s85, s25, 9
    s_add_u32 s44, s45, s85
    v_lshlrev_b32 v18, 10, v81
    buffer_load_dwordx4 v252, s[4:7], s96 offen offset:1024 sc1 lds
    v_lshl_add_u32 v18, v80, 3, v18
    s_mul_i32 s85, s25, 245760
    s_mul_i32 s87, s26, 61440
    s_add_u32 s85, s85, s87
    s_add_u32 s80, s48, 0
    s_and_b32 s80, s80, 3
    s_mul_i32 s20, s80, 3072
    s_add_u32 s20, s20, s85
    s_add_u32 s80, s26, s25
    s_add_u32 s80, s80, 0
    s_and_b32 s80, s80, 3
    s_mul_i32 s12, s80, 5120
    s_add_u32 s12, s12, s43
    s_lshr_b32 s81, s80, 1
    s_add_u32 s81, s81, 1
    s_sub_u32 s87, 0, s81
    s_bitcmp1_b32 s80, 0
    s_cselect_b32 s81, s81, s87
    s_add_u32 s87, s81, 16
    s_add_u32 s81, s81, s86
    v_add_u32 v86, s81, v80
    buffer_load_dwordx4 v252, s[4:7], s96 offen offset:2048 sc1 lds
    s_waitcnt vmcnt(7)
    v_pk_add_f32 v[192:193], v[192:193], v[196:197]
    v_pk_add_f32 v[194:195], v[194:195], v[198:199]
    v_mov_b32 v196, v192
    v_mov_b32 v197, v193
    v_mov_b32 v198, v194
    v_mov_b32 v199, v195
    v_pk_add_f32 v[128:129], v[128:129], v[132:133]
    v_pk_add_f32 v[130:131], v[130:131], v[134:135]
    v_pk_add_f32 v[136:137], v[136:137], v[140:141]
    v_pk_add_f32 v[138:139], v[138:139], v[142:143]
    v_permlane16_swap_b32 v192, v196
    v_permlane16_swap_b32 v193, v197
    v_permlane16_swap_b32 v194, v198
    v_permlane16_swap_b32 v195, v199
    v_pk_add_f32 v[144:145], v[144:145], v[148:149]
    v_pk_add_f32 v[146:147], v[146:147], v[150:151]
    v_pk_add_f32 v[192:193], v[192:193], v[196:197]
    v_pk_add_f32 v[194:195], v[194:195], v[198:199]
    v_mov_b32 v196, v192
    v_mov_b32 v197, v193
    v_mov_b32 v198, v194
    v_mov_b32 v199, v195
    v_pk_add_f32 v[152:153], v[152:153], v[156:157]
    v_pk_add_f32 v[154:155], v[154:155], v[158:159]
    v_pk_add_f32 v[128:129], v[128:129], v[136:137]
    v_pk_add_f32 v[130:131], v[130:131], v[138:139]
    v_permlane32_swap_b32 v192, v196
    v_permlane32_swap_b32 v193, v197
    v_permlane32_swap_b32 v194, v198
    v_permlane32_swap_b32 v195, v199
    v_pk_add_f32 v[144:145], v[144:145], v[152:153]
    v_pk_add_f32 v[146:147], v[146:147], v[154:155]
    v_pk_add_f32 v[192:193], v[192:193], v[196:197]
    v_pk_add_f32 v[194:195], v[194:195], v[198:199]
    v_pk_add_f32 v[128:129], v[128:129], v[144:145]
    v_pk_add_f32 v[130:131], v[130:131], v[146:147]
    v_cvt_pk_bf16_f32 v192, v192, v193
    v_cvt_pk_bf16_f32 v193, v194, v195
    v_mov_b32 v194, 0
    v_mov_b32 v195, 0
    v_cvt_pk_bf16_f32 v128, v128, v129
    v_cvt_pk_bf16_f32 v129, v130, v131
    ds_write_b128 v64, v[192:195]
    ds_write_b64 v20, v[128:129]
    buffer_load_dwordx4 v252, s[4:7], s96 offen offset:3072 sc1 lds
    s_waitcnt lgkmcnt(0)
    s_barrier
    ds_read_b128 v[68:71], v21 offset:0
    ds_read_b128 v[72:75], v21 offset:1024
    ds_read_b128 v[76:79], v21 offset:2048
    s_add_u32 m0, s49, 8192
    s_add_u32 s96, s46, 0x14e2000
    buffer_load_dwordx4 v252, s[4:7], s96 offen offset:0 sc1 lds
    s_waitcnt lgkmcnt(2)
    v_mfma_f32_32x32x16_bf16 v[128:143], v[68:71], v[96:99], 0
    s_waitcnt lgkmcnt(1)
    v_mfma_f32_32x32x16_bf16 v[128:143], v[72:75], v[100:103], v[128:143]
    s_waitcnt lgkmcnt(0)
    v_mfma_f32_32x32x16_bf16 v[128:143], v[76:79], v[104:107], v[128:143]
    v_mfma_f32_32x32x16_bf16 v[144:159], v[68:71], v[108:111], 0
    v_mfma_f32_32x32x16_bf16 v[144:159], v[72:75], v[112:115], v[144:159]
    v_mfma_f32_32x32x16_bf16 v[144:159], v[76:79], v[116:119], v[144:159]
    buffer_load_dwordx4 v252, s[4:7], s96 offen offset:1024 sc1 lds
    buffer_load_dwordx4 v252, s[4:7], s96 offen offset:2048 sc1 lds
    s_nop 6
    v_mov_b32 v140, v136
    v_mov_b32 v141, v136
    s_nop 1
    v_permlane32_swap_b32 v141, v140
    v_add_f32 v140, 0x358637bd, v140
    v_rcp_f32 v140, v140
    s_nop 0
    v_pk_mul_f32 v[128:129], v[128:129], v[140:141] op_sel_hi:[1,0]
    v_pk_mul_f32 v[130:131], v[130:131], v[140:141] op_sel_hi:[1,0]
    v_pk_mul_f32 v[132:133], v[132:133], v[140:141] op_sel_hi:[1,0]
    v_pk_mul_f32 v[134:135], v[134:135], v[140:141] op_sel_hi:[1,0]
    v_pk_mul_f32 v[136:137], v[136:137], v[140:141] op_sel_hi:[1,0]
    v_pk_mul_f32 v[138:139], v[138:139], v[140:141] op_sel_hi:[1,0]
    v_cvt_pk_bf16_f32 v128, v128, v129
    v_cvt_pk_bf16_f32 v129, v130, v131
    v_cvt_pk_bf16_f32 v130, v132, v133
    v_cvt_pk_bf16_f32 v131, v134, v135
    v_cvt_pk_bf16_f32 v132, v136, v137
    v_cvt_pk_bf16_f32 v133, v138, v139
    buffer_store_dwordx4 v[128:131], v248, s[4:7], s36 offen sc1
    s_mov_b32 exec_hi, 0
    buffer_store_dwordx2 v[132:133], v249, s[4:7], s36 offen sc1
    s_mov_b64 exec, -1
    v_mov_b32 v156, v152
    v_mov_b32 v157, v152
    s_nop 1
    v_permlane32_swap_b32 v157, v156
    v_add_f32 v156, 0x358637bd, v156
    v_rcp_f32 v156, v156
    s_nop 0
    v_pk_mul_f32 v[144:145], v[144:145], v[156:157] op_sel_hi:[1,0]
    v_pk_mul_f32 v[146:147], v[146:147], v[156:157] op_sel_hi:[1,0]
    v_pk_mul_f32 v[148:149], v[148:149], v[156:157] op_sel_hi:[1,0]
    v_pk_mul_f32 v[150:151], v[150:151], v[156:157] op_sel_hi:[1,0]
    v_pk_mul_f32 v[152:153], v[152:153], v[156:157] op_sel_hi:[1,0]
    v_pk_mul_f32 v[154:155], v[154:155], v[156:157] op_sel_hi:[1,0]
    v_cvt_pk_bf16_f32 v144, v144, v145
    v_cvt_pk_bf16_f32 v145, v146, v147
    v_cvt_pk_bf16_f32 v146, v148, v149
    v_cvt_pk_bf16_f32 v147, v150, v151
    v_cvt_pk_bf16_f32 v148, v152, v153
    v_cvt_pk_bf16_f32 v149, v154, v155
    buffer_store_dwordx4 v[144:147], v248, s[4:7], s37 offen sc1
    s_mov_b32 exec_hi, 0
    buffer_store_dwordx2 v[148:149], v249, s[4:7], s37 offen sc1
    s_mov_b64 exec, -1
    buffer_load_dwordx4 v252, s[4:7], s96 offen offset:3072 sc1 lds
    v_add_u32 v85, s87, v80
    v_cmp_gt_u32 vcc, 0x800, v86
    v_lshrrev_b32 v86, 4, v85
    v_mul_u32_u24 v86, 20480, v86
    v_and_b32 v85, 15, v85
    v_lshl_add_u32 v85, v85, 4, v84
    v_add_u32 v85, v85, v86
    v_cndmask_b32 v8, v87, v85, vcc
    s_add_u32 s80, s48, 1
    s_and_b32 s80, s80, 3
    s_mul_i32 s21, s80, 3072
    s_add_u32 s21, s21, s85
    s_add_u32 s80, s26, s25
    s_add_u32 s80, s80, 1
    s_and_b32 s80, s80, 3
    s_mul_i32 s13, s80, 5120
    s_add_u32 s13, s13, s43
    s_lshr_b32 s81, s80, 1
    s_add_u32 s81, s81, 1
    s_sub_u32 s87, 0, s81
    s_bitcmp1_b32 s80, 0
    s_cselect_b32 s81, s81, s87
    s_add_u32 s87, s81, 16
    s_add_u32 s81, s81, s86
    v_add_u32 v86, s81, v80
    s_add_u32 m0, s49, 12288
    s_add_u32 s96, s46, 0x14e3000
    buffer_load_dwordx4 v252, s[4:7], s96 offen offset:0 sc1 lds
    v_add_u32 v85, s87, v80
    v_cmp_gt_u32 vcc, 0x800, v86
    v_lshrrev_b32 v86, 4, v85
    v_mul_u32_u24 v86, 20480, v86
    v_and_b32 v85, 15, v85
    v_lshl_add_u32 v85, v85, 4, v84
    v_add_u32 v85, v85, v86
    v_cndmask_b32 v9, v87, v85, vcc
    s_add_u32 s80, s48, 2
    s_and_b32 s80, s80, 3
    s_mul_i32 s22, s80, 3072
    s_add_u32 s22, s22, s85
    s_add_u32 s80, s26, s25
    s_add_u32 s80, s80, 2
    s_and_b32 s80, s80, 3
    s_mul_i32 s14, s80, 5120
    s_add_u32 s14, s14, s43
    s_lshr_b32 s81, s80, 1
    s_add_u32 s81, s81, 1
    s_sub_u32 s87, 0, s81
    s_bitcmp1_b32 s80, 0
    s_cselect_b32 s81, s81, s87
    s_add_u32 s87, s81, 16
    s_add_u32 s81, s81, s86
    v_add_u32 v86, s81, v80
    s_add_u32 m0, s49, 51200
    s_add_u32 s96, s47, 0x14e0000
    buffer_load_dwordx4 v252, s[4:7], s96 offen offset:0 sc1 lds
    v_add_u32 v85, s87, v80
    v_cmp_gt_u32 vcc, 0x800, v86
    v_lshrrev_b32 v86, 4, v85
    v_mul_u32_u24 v86, 20480, v86
    v_and_b32 v85, 15, v85
    v_lshl_add_u32 v85, v85, 4, v84
    v_add_u32 v85, v85, v86
    v_cndmask_b32 v10, v87, v85, vcc
    s_add_u32 s80, s48, 3
    s_and_b32 s80, s80, 3
    s_mul_i32 s23, s80, 3072
    s_add_u32 s23, s23, s85
    s_add_u32 s80, s26, s25
    s_add_u32 s80, s80, 3
    s_and_b32 s80, s80, 3
    s_mul_i32 s15, s80, 5120
    s_add_u32 s15, s15, s43
    s_lshr_b32 s81, s80, 1
    s_add_u32 s81, s81, 1
    s_sub_u32 s87, 0, s81
    s_bitcmp1_b32 s80, 0
    s_cselect_b32 s81, s81, s87
    s_add_u32 s87, s81, 16
    s_add_u32 s81, s81, s86
    v_add_u32 v86, s81, v80
    buffer_load_dwordx4 v252, s[4:7], s96 offen offset:1024 sc1 lds
    v_add_u32 v85, s87, v80
    v_cmp_gt_u32 vcc, 0x800, v86
    v_lshrrev_b32 v86, 4, v85
    v_mul_u32_u24 v86, 20480, v86
    v_and_b32 v85, 15, v85
    v_lshl_add_u32 v85, v85, 4, v84
    v_add_u32 v85, v85, v86
    v_cndmask_b32 v11, v87, v85, vcc
    s_add_u32 s80, s26, s25
    s_add_u32 s80, s80, s48
    s_add_u32 s80, s80, 0
    s_and_b32 s80, s80, 3
    s_add_u32 s80, s80, 0
    s_sub_u32 s81, s80, 6
    s_cmp_ge_u32 s80, 6
    s_cselect_b32 s80, s81, s80
    s_mul_i32 s80, s80, 25600
    v_add_u32 v14, s80, v252
    buffer_load_dwordx4 v252, s[4:7], s96 offen offset:2048 sc1 lds
    s_add_u32 s80, s26, s25
    s_add_u32 s80, s80, s48
    s_add_u32 s80, s80, 1
    s_and_b32 s80, s80, 3
    s_add_u32 s80, s80, 0
    s_sub_u32 s81, s80, 6
    s_cmp_ge_u32 s80, 6
    s_cselect_b32 s80, s81, s80
    s_mul_i32 s80, s80, 25600
    v_add_u32 v15, s80, v252
    buffer_load_dwordx4 v252, s[4:7], s96 offen offset:3072 sc1 lds
    s_add_u32 s80, s26, s25
    s_add_u32 s80, s80, s48
    s_add_u32 s80, s80, 2
    s_and_b32 s80, s80, 3
    s_add_u32 s80, s80, 0
    s_sub_u32 s81, s80, 6
    s_cmp_ge_u32 s80, 6
    s_cselect_b32 s80, s81, s80
    s_mul_i32 s80, s80, 25600
    v_add_u32 v16, s80, v252
    s_add_u32 m0, s49, 55296
    s_add_u32 s96, s47, 0x14e1000
    buffer_load_dwordx4 v252, s[4:7], s96 offen offset:0 sc1 lds
    s_add_u32 s80, s26, s25
    s_add_u32 s80, s80, s48
    s_add_u32 s80, s80, 3
    s_and_b32 s80, s80, 3
    s_add_u32 s80, s80, 0
    s_sub_u32 s81, s80, 6
    s_cmp_ge_u32 s80, 6
    s_cselect_b32 s80, s81, s80
    s_mul_i32 s80, s80, 25600
    v_add_u32 v17, s80, v252
    buffer_load_dwordx4 v252, s[4:7], s96 offen offset:1024 sc1 lds
    buffer_load_dwordx4 v252, s[4:7], s96 offen offset:2048 sc1 lds
    buffer_load_dwordx4 v252, s[4:7], s96 offen offset:3072 sc1 lds
    s_waitcnt vmcnt(10)
    s_barrier
    s_cmp_lg_u32 s26, 0
    s_cbranch_scc1 L_sig_14
    s_mov_b64 exec, 15
    buffer_store_dword v254, v66, s[4:7], s29 offen sc1
    s_mov_b64 exec, -1
L_sig_14:
    s_add_u32 m0, s49, 59392
    s_add_u32 s96, s47, 0x14e2000
    buffer_load_dwordx4 v252, s[4:7], s96 offen offset:0 sc1 lds
    buffer_load_dwordx4 v252, s[4:7], s96 offen offset:1024 sc1 lds
    buffer_load_dwordx4 v252, s[4:7], s96 offen offset:2048 sc1 lds
    buffer_load_dwordx4 v252, s[4:7], s96 offen offset:3072 sc1 lds
    s_add_u32 m0, s49, 63488
    s_add_u32 s96, s47, 0x14e3000
    buffer_load_dwordx4 v252, s[4:7], s96 offen offset:0 sc1 lds
    v_lshlrev_b32 v42, 16, v22
    v_and_b32 v43, 0xffff0000, v22
    v_lshlrev_b32 v44, 16, v23
    v_and_b32 v45, 0xffff0000, v23
    v_lshlrev_b32 v46, 16, v24
    v_and_b32 v47, 0xffff0000, v24
    v_lshlrev_b32 v48, 16, v25
    v_and_b32 v49, 0xffff0000, v25
    v_lshlrev_b32 v50, 16, v26
    v_and_b32 v51, 0xffff0000, v26
    v_lshlrev_b32 v52, 16, v27
    v_and_b32 v53, 0xffff0000, v27
    v_lshlrev_b32 v54, 16, v28
    v_and_b32 v55, 0xffff0000, v28
    v_lshlrev_b32 v56, 16, v29
    v_and_b32 v57, 0xffff0000, v29
    v_lshlrev_b32 v58, 16, v30
    v_and_b32 v59, 0xffff0000, v30
    v_lshlrev_b32 v60, 16, v31
    v_and_b32 v61, 0xffff0000, v31
    buffer_load_dword v20, v19, s[4:7], s31 offen sc1
    s_waitcnt vmcnt(1)
    s_barrier
    s_add_u32 s97, s38, 0x9000
    s_buffer_load_dwordx8 s[64:71], s[4:7], s97 glc
    ds_read_b128 v[144:147], v14 offset:0
    ds_read_b128 v[148:151], v14 offset:1024
    ds_read_b128 v[152:155], v14 offset:2048
    ds_read_b128 v[156:159], v14 offset:3072
    s_add_u32 m0, s49, 102400
    s_add_u32 s96, s46, 0x15a8000
    buffer_load_dwordx4 v252, s[4:7], s96 offen offset:0 sc1 lds
    ds_read_b128 v[160:163], v14 offset:4096
    ds_read_b128 v[164:167], v14 offset:5120
    ds_read_b128 v[168:171], v14 offset:6144
    ds_read_b128 v[172:175], v14 offset:7168
    buffer_load_dwordx4 v252, s[4:7], s96 offen offset:1024 sc1 lds
    ds_read_b128 v[176:179], v14 offset:8192
    ds_read_b128 v[180:183], v14 offset:9216
    ds_read_b128 v[184:187], v14 offset:10240
    ds_read_b128 v[188:191], v14 offset:11264
    buffer_load_dwordx4 v252, s[4:7], s96 offen offset:2048 sc1 lds
    ds_read_b128 v[192:195], v14 offset:12288
    ds_read_b128 v[196:199], v14 offset:13312
    ds_read_b128 v[200:203], v14 offset:14336
    ds_read_b128 v[204:207], v14 offset:15360
    buffer_load_dwordx4 v252, s[4:7], s96 offen offset:3072 sc1 lds
    ds_read_b128 v[208:211], v14 offset:16384
    ds_read_b128 v[212:215], v14 offset:17408
    ds_read_b128 v[216:219], v14 offset:18432
    ds_read_b128 v[220:223], v14 offset:19456
    s_add_u32 m0, s49, 106496
    s_add_u32 s96, s46, 0x15a9000
    buffer_load_dwordx4 v252, s[4:7], s96 offen offset:0 sc1 lds
    ds_read_b128 v[224:227], v14 offset:20480
    ds_read_b128 v[228:231], v14 offset:21504
    ds_read_b128 v[232:235], v14 offset:22528
    ds_read_b128 v[236:239], v14 offset:23552
    buffer_load_dwordx4 v252, s[4:7], s96 offen offset:1024 sc1 lds
    ds_read_b128 v[240:243], v14 offset:24576
    buffer_load_dwordx4 v252, s[4:7], s96 offen offset:2048 sc1 lds
    buffer_load_dwordx4 v252, s[4:7], s96 offen offset:3072 sc1 lds
    s_add_u32 m0, s49, 110592
    s_add_u32 s96, s46, 0x15aa000
    buffer_load_dwordx4 v252, s[4:7], s96 offen offset:0 sc1 lds
    buffer_load_dwordx4 v252, s[4:7], s96 offen offset:1024 sc1 lds
    s_mov_b32 s60, 0
    s_branch L_pc_17
L_poll_16:
    s_buffer_load_dwordx8 s[64:71], s[4:7], s97 glc
    s_add_u32 s60, s60, 1
    s_cmp_gt_u32 s60, 400000
    s_cbranch_scc1 L_end
L_pc_17:
    s_waitcnt lgkmcnt(0)
    s_xor_b64 s[64:65], s[64:65], s[56:57]
    s_xor_b64 s[66:67], s[66:67], s[56:57]
    s_or_b64 s[64:65], s[64:65], s[66:67]
    s_xor_b64 s[68:69], s[68:69], s[56:57]
    s_or_b64 s[64:65], s[64:65], s[68:69]
    s_xor_b64 s[70:71], s[70:71], s[56:57]
    s_or_b64 s[64:65], s[64:65], s[70:71]
    s_cbranch_scc1 L_poll_16
L_p1_15:
    s_barrier
    s_add_u32 s27, s12, 0x4e0000
    buffer_load_dwordx4 v[64:67], v252, s[4:7], s27 offen offset:0 sc1
    buffer_load_dwordx4 v[68:71], v252, s[4:7], s27 offen offset:1024 sc1
    buffer_load_dwordx4 v[72:75], v252, s[4:7], s27 offen offset:2048 sc1
    buffer_load_dwordx4 v[76:79], v252, s[4:7], s27 offen offset:3072 sc1
    s_add_u32 s27, s12, 0x4e1000
    buffer_load_dwordx2 v[80:81], v253, s[4:7], s27 offen sc1
    buffer_load_dwordx2 v[82:83], v253, s[4:7], s27 offen offset:512 sc1
    s_add_u32 s27, s13, 0x4e0000
    buffer_load_dwordx4 v[84:87], v252, s[4:7], s27 offen offset:0 sc1
    buffer_load_dwordx4 v[88:91], v252, s[4:7], s27 offen offset:1024 sc1
    buffer_load_dwordx4 v[92:95], v252, s[4:7], s27 offen offset:2048 sc1
    buffer_load_dwordx4 v[96:99], v252, s[4:7], s27 offen offset:3072 sc1
    s_add_u32 s27, s13, 0x4e1000
    buffer_load_dwordx2 v[100:101], v253, s[4:7], s27 offen sc1
    buffer_load_dwordx2 v[102:103], v253, s[4:7], s27 offen offset:512 sc1
    s_add_u32 s27, s14, 0x4e0000
    buffer_load_dwordx4 v[104:107], v252, s[4:7], s27 offen offset:0 sc1
    s_waitcnt vmcnt(12) lgkmcnt(15)
    v_mfma_f32_16x16x32_bf16 v[42:45], v[144:147], v[64:67], v[42:45]
    v_mfma_f32_16x16x32_bf16 v[46:49], v[148:151], v[64:67], v[46:49]
    ds_read_b128 v[144:147], v15 offset:0
    v_mfma_f32_16x16x32_bf16 v[50:53], v[152:155], v[64:67], v[50:53]
    ds_read_b128 v[148:151], v15 offset:1024
    buffer_load_dwordx4 v[108:111], v252, s[4:7], s27 offen offset:1024 sc1
    v_mfma_f32_16x16x32_bf16 v[54:57], v[156:159], v[64:67], v[54:57]
    ds_read_b128 v[152:155], v15 offset:2048
    v_mfma_f32_16x16x32_bf16 v[58:61], v[160:163], v[64:67], v[58:61]
    ds_read_b128 v[156:159], v15 offset:3072
    s_waitcnt vmcnt(12)
    v_mfma_f32_16x16x32_bf16 v[42:45], v[164:167], v[68:71], v[42:45]
    ds_read_b128 v[160:163], v15 offset:4096
    v_mfma_f32_16x16x32_bf16 v[46:49], v[168:171], v[68:71], v[46:49]
    ds_read_b128 v[164:167], v15 offset:5120
    buffer_load_dwordx4 v[112:115], v252, s[4:7], s27 offen offset:2048 sc1
    v_mfma_f32_16x16x32_bf16 v[50:53], v[172:175], v[68:71], v[50:53]
    ds_read_b128 v[168:171], v15 offset:6144
    v_mfma_f32_16x16x32_bf16 v[54:57], v[176:179], v[68:71], v[54:57]
    ds_read_b128 v[172:175], v15 offset:7168
    v_mfma_f32_16x16x32_bf16 v[58:61], v[180:183], v[68:71], v[58:61]
    ds_read_b128 v[176:179], v15 offset:8192
    s_waitcnt vmcnt(12) lgkmcnt(15)
    v_mfma_f32_16x16x32_bf16 v[42:45], v[184:187], v[72:75], v[42:45]
    ds_read_b128 v[180:183], v15 offset:9216
    buffer_load_dwordx4 v[116:119], v252, s[4:7], s27 offen offset:3072 sc1
    v_mfma_f32_16x16x32_bf16 v[46:49], v[188:191], v[72:75], v[46:49]
    ds_read_b128 v[184:187], v15 offset:10240
    v_mfma_f32_16x16x32_bf16 v[50:53], v[192:195], v[72:75], v[50:53]
    ds_read_b128 v[188:191], v15 offset:11264
    v_mfma_f32_16x16x32_bf16 v[54:57], v[196:199], v[72:75], v[54:57]
    ds_read_b128 v[192:195], v15 offset:12288
    v_mfma_f32_16x16x32_bf16 v[58:61], v[200:203], v[72:75], v[58:61]
    ds_read_b128 v[196:199], v15 offset:13312
    s_add_u32 s27, s14, 0x4e1000
    buffer_load_dwordx2 v[120:121], v253, s[4:7], s27 offen sc1
    buffer_load_dwordx2 v[122:123], v253, s[4:7], s27 offen offset:512 sc1
    s_waitcnt vmcnt(14) lgkmcnt(15)
    v_mfma_f32_16x16x32_bf16 v[42:45], v[204:207], v[76:79], v[42:45]
    ds_read_b128 v[200:203], v15 offset:14336
    v_mfma_f32_16x16x32_bf16 v[46:49], v[208:211], v[76:79], v[46:49]
    ds_read_b128 v[204:207], v15 offset:15360
    v_mfma_f32_16x16x32_bf16 v[50:53], v[212:215], v[76:79], v[50:53]
    ds_read_b128 v[208:211], v15 offset:16384
    v_mfma_f32_16x16x32_bf16 v[54:57], v[216:219], v[76:79], v[54:57]
    ds_read_b128 v[212:215], v15 offset:17408
    s_add_u32 s27, s15, 0x4e0000
    buffer_load_dwordx4 v[124:127], v252, s[4:7], s27 offen offset:0 sc1
    v_mfma_f32_16x16x32_bf16 v[58:61], v[220:223], v[76:79], v[58:61]
    ds_read_b128 v[216:219], v15 offset:18432
    s_waitcnt vmcnt(13) lgkmcnt(15)
    v_mfma_f32_16x16x32_bf16 v[42:45], v[224:227], v[80:83], v[42:45]
    ds_read_b128 v[220:223], v15 offset:19456
    v_mfma_f32_16x16x32_bf16 v[46:49], v[228:231], v[80:83], v[46:49]
    ds_read_b128 v[224:227], v15 offset:20480
    v_mfma_f32_16x16x32_bf16 v[50:53], v[232:235], v[80:83], v[50:53]
    ds_read_b128 v[228:231], v15 offset:21504
    buffer_load_dwordx4 v[128:131], v252, s[4:7], s27 offen offset:1024 sc1
    v_mfma_f32_16x16x32_bf16 v[54:57], v[236:239], v[80:83], v[54:57]
    ds_read_b128 v[232:235], v15 offset:22528
    v_mfma_f32_16x16x32_bf16 v[58:61], v[240:243], v[80:83], v[58:61]
    ds_read_b128 v[236:239], v15 offset:23552
    s_waitcnt vmcnt(13) lgkmcnt(15)
    v_mfma_f32_16x16x32_bf16 v[42:45], v[144:147], v[84:87], v[42:45]
    ds_read_b128 v[240:243], v15 offset:24576
    v_mfma_f32_16x16x32_bf16 v[46:49], v[148:151], v[84:87], v[46:49]
    ds_read_b128 v[144:147], v16 offset:0
    buffer_load_dwordx4 v[132:135], v252, s[4:7], s27 offen offset:2048 sc1
    v_mfma_f32_16x16x32_bf16 v[50:53], v[152:155], v[84:87], v[50:53]
    ds_read_b128 v[148:151], v16 offset:1024
    v_mfma_f32_16x16x32_bf16 v[54:57], v[156:159], v[84:87], v[54:57]
    ds_read_b128 v[152:155], v16 offset:2048
    v_mfma_f32_16x16x32_bf16 v[58:61], v[160:163], v[84:87], v[58:61]
    ds_read_b128 v[156:159], v16 offset:3072
    s_waitcnt vmcnt(13) lgkmcnt(15)
    v_mfma_f32_16x16x32_bf16 v[42:45], v[164:167], v[88:91], v[42:45]
    ds_read_b128 v[160:163], v16 offset:4096
    buffer_load_dwordx4 v[136:139], v252, s[4:7], s27 offen offset:3072 sc1
    v_mfma_f32_16x16x32_bf16 v[46:49], v[168:171], v[88:91], v[46:49]
    ds_read_b128 v[164:167], v16 offset:5120
    v_mfma_f32_16x16x32_bf16 v[50:53], v[172:175], v[88:91], v[50:53]
    ds_read_b128 v[168:171], v16 offset:6144
    v_mfma_f32_16x16x32_bf16 v[54:57], v[176:179], v[88:91], v[54:57]
    ds_read_b128 v[172:175], v16 offset:7168
    v_mfma_f32_16x16x32_bf16 v[58:61], v[180:183], v[88:91], v[58:61]
    ds_read_b128 v[176:179], v16 offset:8192
    s_add_u32 s27, s15, 0x4e1000
    buffer_load_dwordx2 v[140:141], v253, s[4:7], s27 offen sc1
    buffer_load_dwordx2 v[142:143], v253, s[4:7], s27 offen offset:512 sc1
    s_waitcnt vmcnt(15) lgkmcnt(15)
    v_mfma_f32_16x16x32_bf16 v[42:45], v[184:187], v[92:95], v[42:45]
    ds_read_b128 v[180:183], v16 offset:9216
    v_mfma_f32_16x16x32_bf16 v[46:49], v[188:191], v[92:95], v[46:49]
    ds_read_b128 v[184:187], v16 offset:10240
    v_mfma_f32_16x16x32_bf16 v[50:53], v[192:195], v[92:95], v[50:53]
    ds_read_b128 v[188:191], v16 offset:11264
    v_mfma_f32_16x16x32_bf16 v[54:57], v[196:199], v[92:95], v[54:57]
    ds_read_b128 v[192:195], v16 offset:15360
    buffer_load_dwordx4 v252, s[4:7], s96 offen offset:2048 sc1 lds
    v_mfma_f32_16x16x32_bf16 v[58:61], v[200:203], v[92:95], v[58:61]
    ds_read_b128 v[196:199], v16 offset:16384
    s_waitcnt vmcnt(15) lgkmcnt(15)
    v_mfma_f32_16x16x32_bf16 v[42:45], v[204:207], v[96:99], v[42:45]
    ds_read_b128 v[200:203], v16 offset:20480
    v_mfma_f32_16x16x32_bf16 v[46:49], v[208:211], v[96:99], v[46:49]
    ds_read_b128 v[204:207], v16 offset:21504
    v_mfma_f32_16x16x32_bf16 v[50:53], v[212:215], v[96:99], v[50:53]
    ds_read_b128 v[208:211], v17 offset:0
    buffer_load_dwordx4 v252, s[4:7], s96 offen offset:3072 sc1 lds
    v_mfma_f32_16x16x32_bf16 v[54:57], v[216:219], v[96:99], v[54:57]
    ds_read_b128 v[212:215], v17 offset:1024
    v_mfma_f32_16x16x32_bf16 v[58:61], v[220:223], v[96:99], v[58:61]
    ds_read_b128 v[216:219], v17 offset:5120
    s_waitcnt vmcnt(14) lgkmcnt(15)
    v_mfma_f32_16x16x32_bf16 v[42:45], v[224:227], v[100:103], v[42:45]
    ds_read_b128 v[220:223], v17 offset:6144
    v_mfma_f32_16x16x32_bf16 v[46:49], v[228:231], v[100:103], v[46:49]
    ds_read_b128 v[224:227], v17 offset:10240
    s_add_u32 m0, s49, 114688
    s_add_u32 s96, s46, 0x15ab000
    buffer_load_dwordx4 v252, s[4:7], s96 offen offset:0 sc1 lds
    v_mfma_f32_16x16x32_bf16 v[50:53], v[232:235], v[100:103], v[50:53]
    ds_read_b128 v[228:231], v17 offset:11264
    v_mfma_f32_16x16x32_bf16 v[54:57], v[236:239], v[100:103], v[54:57]
    ds_read_b128 v[232:235], v17 offset:15360
    v_mfma_f32_16x16x32_bf16 v[58:61], v[240:243], v[100:103], v[58:61]
    ds_read_b128 v[236:239], v17 offset:16384
    s_waitcnt vmcnt(14) lgkmcnt(15)
    v_mfma_f32_16x16x32_bf16 v[42:45], v[144:147], v[104:107], v[42:45]
    ds_read_b128 v[240:243], v17 offset:20480
    s_add_u32 s96, s47, 0x15a8000
    buffer_load_dwordx4 a[204:207], v252, s[4:7], s96 offen offset:0 sc1
    v_mfma_f32_16x16x32_bf16 v[46:49], v[148:151], v[104:107], v[46:49]
    ds_read_b128 v[144:147], v17 offset:21504
    v_mfma_f32_16x16x32_bf16 v[50:53], v[152:155], v[104:107], v[50:53]
    ds_read_b128 v[148:151], v16 offset:14336
    v_mfma_f32_16x16x32_bf16 v[54:57], v[156:159], v[104:107], v[54:57]
    ds_read_b128 v[152:155], v16 offset:19456
    v_mfma_f32_16x16x32_bf16 v[58:61], v[160:163], v[104:107], v[58:61]
    ds_read_b128 v[156:159], v16 offset:24576
    buffer_load_dwordx4 a[208:211], v252, s[4:7], s96 offen offset:1024 sc1
    s_waitcnt vmcnt(15) lgkmcnt(15)
    v_mfma_f32_16x16x32_bf16 v[42:45], v[164:167], v[108:111], v[42:45]
    ds_read_b128 v[160:163], v17 offset:4096
    v_mfma_f32_16x16x32_bf16 v[46:49], v[168:171], v[108:111], v[46:49]
    ds_read_b128 v[164:167], v17 offset:9216
    v_mfma_f32_16x16x32_bf16 v[50:53], v[172:175], v[108:111], v[50:53]
    ds_read_b128 v[168:171], v17 offset:14336
    v_mfma_f32_16x16x32_bf16 v[54:57], v[176:179], v[108:111], v[54:57]
    ds_read_b128 v[172:175], v17 offset:19456
    buffer_load_dwordx4 a[212:215], v252, s[4:7], s96 offen offset:2048 sc1
    v_mfma_f32_16x16x32_bf16 v[58:61], v[180:183], v[108:111], v[58:61]
    ds_read_b128 v[176:179], v17 offset:24576
    s_waitcnt vmcnt(15) lgkmcnt(15)
    v_mfma_f32_16x16x32_bf16 v[42:45], v[184:187], v[112:115], v[42:45]
    ds_read_b128 v[180:183], v16 offset:12288
    v_mfma_f32_16x16x32_bf16 v[46:49], v[188:191], v[112:115], v[46:49]
    ds_read_b128 v[184:187], v16 offset:13312
    s_waitcnt vmcnt(14)
    v_mfma_f32_16x16x32_bf16 v[42:45], v[192:195], v[116:119], v[42:45]
    ds_read_b128 v[188:191], v16 offset:17408
    buffer_load_dwordx4 a[216:219], v252, s[4:7], s96 offen offset:3072 sc1
    v_mfma_f32_16x16x32_bf16 v[46:49], v[196:199], v[116:119], v[46:49]
    ds_read_b128 v[192:195], v16 offset:18432
    s_waitcnt vmcnt(13)
    v_mfma_f32_16x16x32_bf16 v[42:45], v[200:203], v[120:123], v[42:45]
    ds_read_b128 v[196:199], v16 offset:22528
    s_waitcnt lgkmcnt(15)
    v_mfma_f32_16x16x32_bf16 v[46:49], v[204:207], v[120:123], v[46:49]
    ds_read_b128 v[200:203], v16 offset:23552
    s_waitcnt vmcnt(12)
    v_mfma_f32_16x16x32_bf16 v[42:45], v[208:211], v[124:127], v[42:45]
    ds_read_b128 v[204:207], v17 offset:2048
    s_add_u32 s96, s47, 0x15a9000
    buffer_load_dwordx4 a[220:223], v252, s[4:7], s96 offen offset:0 sc1
    v_mfma_f32_16x16x32_bf16 v[46:49], v[212:215], v[124:127], v[46:49]
    ds_read_b128 v[208:211], v17 offset:3072
    s_waitcnt vmcnt(12)
    v_mfma_f32_16x16x32_bf16 v[42:45], v[216:219], v[128:131], v[42:45]
    ds_read_b128 v[212:215], v17 offset:7168
    v_mfma_f32_16x16x32_bf16 v[46:49], v[220:223], v[128:131], v[46:49]
    ds_read_b128 v[216:219], v17 offset:8192
    s_waitcnt vmcnt(11) lgkmcnt(15)
    v_mfma_f32_16x16x32_bf16 v[42:45], v[224:227], v[132:135], v[42:45]
    ds_read_b128 v[220:223], v17 offset:12288
    buffer_load_dwordx4 a[224:227], v252, s[4:7], s96 offen offset:1024 sc1
    v_mfma_f32_16x16x32_bf16 v[46:49], v[228:231], v[132:135], v[46:49]
    ds_read_b128 v[224:227], v17 offset:13312
    s_waitcnt vmcnt(11)
    v_mfma_f32_16x16x32_bf16 v[42:45], v[232:235], v[136:139], v[42:45]
    ds_read_b128 v[228:231], v17 offset:17408
    v_mfma_f32_16x16x32_bf16 v[46:49], v[236:239], v[136:139], v[46:49]
    ds_read_b128 v[232:235], v17 offset:18432
    s_waitcnt vmcnt(9)
    v_mfma_f32_16x16x32_bf16 v[42:45], v[240:243], v[140:143], v[42:45]
    ds_read_b128 v[236:239], v17 offset:22528
    buffer_load_dwordx4 a[228:231], v252, s[4:7], s96 offen offset:2048 sc1
    s_waitcnt lgkmcnt(15)
    v_mfma_f32_16x16x32_bf16 v[46:49], v[144:147], v[140:143], v[46:49]
    ds_read_b128 v[240:243], v17 offset:23552
    v_mfma_f32_16x16x32_bf16 v[58:61], v[148:151], v[112:115], v[58:61]
    v_mfma_f32_16x16x32_bf16 v[58:61], v[152:155], v[116:119], v[58:61]
    v_mfma_f32_16x16x32_bf16 v[58:61], v[156:159], v[120:123], v[58:61]
    buffer_load_dwordx4 a[232:235], v252, s[4:7], s96 offen offset:3072 sc1
    v_mfma_f32_16x16x32_bf16 v[58:61], v[160:163], v[124:127], v[58:61]
    v_cvt_pk_bf16_f32 v22, v42, v43
    v_cvt_pk_bf16_f32 v23, v44, v45
    v_cvt_pk_bf16_f32 v24, v46, v47
    s_waitcnt lgkmcnt(15)
    v_mfma_f32_16x16x32_bf16 v[58:61], v[164:167], v[128:131], v[58:61]
    v_cvt_pk_bf16_f32 v25, v48, v49
    s_add_u32 s28, s43, 0x760000
    buffer_store_dwordx4 v[22:25], v4, s[4:7], s28 offen offset:0 sc1
    v_mfma_f32_16x16x32_bf16 v[58:61], v[168:171], v[132:135], v[58:61]
    v_mfma_f32_16x16x32_bf16 v[58:61], v[172:175], v[136:139], v[58:61]
    s_add_u32 s96, s47, 0x15aa000
    buffer_load_dwordx4 a[236:239], v252, s[4:7], s96 offen offset:0 sc1
    v_mfma_f32_16x16x32_bf16 v[58:61], v[176:179], v[140:143], v[58:61]
    v_mfma_f32_16x16x32_bf16 v[50:53], v[180:183], v[112:115], v[50:53]
    s_waitcnt lgkmcnt(0)
    s_barrier
    v_mfma_f32_16x16x32_bf16 v[54:57], v[184:187], v[112:115], v[54:57]
    v_mfma_f32_16x16x32_bf16 v[50:53], v[188:191], v[116:119], v[50:53]
    buffer_load_dwordx4 a[240:243], v252, s[4:7], s96 offen offset:1024 sc1
    v_mfma_f32_16x16x32_bf16 v[54:57], v[192:195], v[116:119], v[54:57]
    s_nop 0
    v_cvt_pk_bf16_f32 v30, v58, v59
    v_cvt_pk_bf16_f32 v31, v60, v61
    s_add_u32 s28, s43, 0x760000
    buffer_store_dwordx2 v[30:31], v5, s[4:7], s28 offen sc1
    v_mfma_f32_16x16x32_bf16 v[50:53], v[196:199], v[120:123], v[50:53]
    v_mfma_f32_16x16x32_bf16 v[54:57], v[200:203], v[120:123], v[54:57]
    v_mfma_f32_16x16x32_bf16 v[50:53], v[204:207], v[124:127], v[50:53]
    buffer_load_dwordx4 a[244:247], v252, s[4:7], s96 offen offset:2048 sc1
    v_mfma_f32_16x16x32_bf16 v[54:57], v[208:211], v[124:127], v[54:57]
    v_mfma_f32_16x16x32_bf16 v[50:53], v[212:215], v[128:131], v[50:53]
    v_mfma_f32_16x16x32_bf16 v[54:57], v[216:219], v[128:131], v[54:57]
    v_mfma_f32_16x16x32_bf16 v[50:53], v[220:223], v[132:135], v[50:53]
    buffer_load_dwordx4 a[248:251], v252, s[4:7], s96 offen offset:3072 sc1
    v_mfma_f32_16x16x32_bf16 v[54:57], v[224:227], v[132:135], v[54:57]
    v_mfma_f32_16x16x32_bf16 v[50:53], v[228:231], v[136:139], v[50:53]
    v_mfma_f32_16x16x32_bf16 v[54:57], v[232:235], v[136:139], v[54:57]
    v_mfma_f32_16x16x32_bf16 v[50:53], v[236:239], v[140:143], v[50:53]
    s_add_u32 s96, s47, 0x15ab000
    buffer_load_dwordx4 a[252:255], v252, s[4:7], s96 offen offset:0 sc1
    v_mfma_f32_16x16x32_bf16 v[54:57], v[240:243], v[140:143], v[54:57]
    s_nop 4
    v_cvt_pk_bf16_f32 v26, v50, v51
    v_cvt_pk_bf16_f32 v27, v52, v53
    s_nop 0
    v_cvt_pk_bf16_f32 v28, v54, v55
    v_cvt_pk_bf16_f32 v29, v56, v57
    s_add_u32 s28, s43, 0x760000
    buffer_store_dwordx4 v[26:29], v4, s[4:7], s28 offen offset:256 sc1
    v_mov_b32 v244, 0
    v_mov_b32 v245, 0
    v_dot2c_f32_bf16 v244, s61, v22
    v_dot2c_f32_bf16 v245, v22, v22
    v_dot2c_f32_bf16 v244, s61, v23
    v_dot2c_f32_bf16 v245, v23, v23
    v_dot2c_f32_bf16 v244, s61, v24
    v_dot2c_f32_bf16 v245, v24, v24
    v_dot2c_f32_bf16 v244, s61, v25
    v_dot2c_f32_bf16 v245, v25, v25
    v_dot2c_f32_bf16 v244, s61, v26
    v_dot2c_f32_bf16 v245, v26, v26
    v_dot2c_f32_bf16 v244, s61, v27
    v_dot2c_f32_bf16 v245, v27, v27
    v_dot2c_f32_bf16 v244, s61, v28
    v_dot2c_f32_bf16 v245, v28, v28
    v_dot2c_f32_bf16 v244, s61, v29
    v_dot2c_f32_bf16 v245, v29, v29
    v_dot2c_f32_bf16 v244, s61, v30
    v_dot2c_f32_bf16 v245, v30, v30
    v_dot2c_f32_bf16 v244, s61, v31
    v_dot2c_f32_bf16 v245, v31, v31
    s_nop 1
    v_mov_b32 v246, v244
    v_mov_b32 v247, v245
    s_nop 0
    v_permlane16_swap_b32 v244, v246
    v_permlane16_swap_b32 v245, v247
    v_add_f32 v244, v244, v246
    v_add_f32 v245, v245, v247
    v_mov_b32 v246, v244
    v_mov_b32 v247, v245
    s_nop 0
    v_permlane32_swap_b32 v244, v246
    v_permlane32_swap_b32 v245, v247
    v_add_f32 v244, v244, v246
    v_add_f32 v245, v245, v247
    s_add_u32 s28, s44, 0x28000
    s_mov_b64 exec, 0xffff
    buffer_store_dwordx2 v[244:245], v253, s[4:7], s28 offen sc1
    s_mov_b64 exec, -1
    v_cmp_ne_u32 vcc, s56, v20
    s_cbranch_vccz L_vc_18
    s_mov_b32 s60, 0
L_vs_19:
    buffer_load_dword v20, v19, s[4:7], s31 offen sc1
    s_add_u32 s60, s60, 1
    s_cmp_gt_u32 s60, 400000
    s_cbranch_scc1 L_end
    s_waitcnt vmcnt(0)
    v_cmp_ne_u32 vcc, s56, v20
    s_cbranch_vccnz L_vs_19
L_vc_18:
    s_add_u32 s29, s39, 0xd000
    s_add_u32 s80, s49, 0
    v_add_u32 v20, s80, v252
    s_waitcnt vmcnt(2)
    ds_write_b128 v20, a[204:207] offset:0
    s_add_u32 s99, s20, 0x1738000
    buffer_load_dwordx4 a[0:3], v252, s[4:7], s99 offen offset:0 sc1
    ds_write_b128 v20, a[208:211] offset:1024
    ds_write_b128 v20, a[212:215] offset:2048
    buffer_load_dwordx4 a[4:7], v252, s[4:7], s99 offen offset:1024 sc1
    s_add_u32 s80, s26, s25
    s_add_u32 s80, s80, s48
    s_add_u32 s80, s80, 0
    s_and_b32 s80, s80, 3
    s_add_u32 s80, s80, 4
    s_sub_u32 s81, s80, 6
    s_cmp_ge_u32 s80, 6
    s_cselect_b32 s80, s81, s80
    s_mul_i32 s80, s80, 25600
    v_add_u32 v14, s80, v252
    ds_write_b128 v20, a[216:219] offset:3072
    ds_write_b128 v20, a[220:223] offset:4096
    buffer_load_dwordx4 a[8:11], v252, s[4:7], s99 offen offset:2048 sc1
    ds_write_b128 v20, a[224:227] offset:5120
    s_add_u32 s80, s26, s25
    s_add_u32 s80, s80, s48
    s_add_u32 s80, s80, 1
    s_and_b32 s80, s80, 3
    s_add_u32 s80, s80, 4
    s_sub_u32 s81, s80, 6
    s_cmp_ge_u32 s80, 6
    s_cselect_b32 s80, s81, s80
    s_mul_i32 s80, s80, 25600
    v_add_u32 v15, s80, v252
    ds_write_b128 v20, a[228:231] offset:6144
    s_add_u32 s99, s21, 0x1738000
    buffer_load_dwordx4 a[12:15], v252, s[4:7], s99 offen offset:0 sc1
    ds_write_b128 v20, a[232:235] offset:7168
    ds_write_b128 v20, a[236:239] offset:8192
    buffer_load_dwordx4 a[16:19], v252, s[4:7], s99 offen offset:1024 sc1
    s_add_u32 s80, s26, s25
    s_add_u32 s80, s80, s48
    s_add_u32 s80, s80, 2
    s_and_b32 s80, s80, 3
    s_add_u32 s80, s80, 4
    s_sub_u32 s81, s80, 6
    s_cmp_ge_u32 s80, 6
    s_cselect_b32 s80, s81, s80
    s_mul_i32 s80, s80, 25600
    v_add_u32 v16, s80, v252
    ds_write_b128 v20, a[240:243] offset:9216
    ds_write_b128 v20, a[244:247] offset:10240
    buffer_load_dwordx4 a[20:23], v252, s[4:7], s99 offen offset:2048 sc1
    ds_write_b128 v20, a[248:251] offset:11264
    s_add_u32 s80, s26, s25
    s_add_u32 s80, s80, s48
    s_add_u32 s80, s80, 3
    s_and_b32 s80, s80, 3
    s_add_u32 s80, s80, 4
    s_sub_u32 s81, s80, 6
    s_cmp_ge_u32 s80, 6
    s_cselect_b32 s80, s81, s80
    s_mul_i32 s80, s80, 25600
    v_add_u32 v17, s80, v252
    ds_write_b128 v20, a[252:255] offset:12288
    s_waitcnt lgkmcnt(0)
    s_waitcnt vmcnt(6)
    s_barrier
    s_cmp_lg_u32 s26, 0
    s_cbranch_scc1 L_sig_20
    s_mov_b64 exec, 1
    buffer_store_dword v254, off, s[4:7], s29 sc1
    s_mov_b64 exec, -1
L_sig_20:
    ds_read_b128 v[144:147], v14 offset:0
    ds_read_b128 v[148:151], v14 offset:1024
    ds_read_b128 v[152:155], v14 offset:2048
    ds_read_b128 v[156:159], v14 offset:3072
    s_add_u32 m0, s49, 51200
    s_add_u32 s96, s46, 0x1670000
    buffer_load_dwordx4 v252, s[4:7], s96 offen offset:0 sc1 lds
    ds_read_b128 v[160:163], v14 offset:4096
    ds_read_b128 v[164:167], v14 offset:5120
    ds_read_b128 v[168:171], v14 offset:6144
    ds_read_b128 v[172:175], v14 offset:7168
    buffer_load_dwordx4 v252, s[4:7], s96 offen offset:1024 sc1 lds
    ds_read_b128 v[176:179], v14 offset:8192
    ds_read_b128 v[180:183], v14 offset:9216
    ds_read_b128 v[184:187], v14 offset:10240
    ds_read_b128 v[188:191], v14 offset:11264
    buffer_load_dwordx4 v252, s[4:7], s96 offen offset:2048 sc1 lds
    ds_read_b128 v[192:195], v14 offset:12288
    ds_read_b128 v[196:199], v14 offset:13312
    ds_read_b128 v[200:203], v14 offset:14336
    ds_read_b128 v[204:207], v14 offset:15360
    buffer_load_dwordx4 v252, s[4:7], s96 offen offset:3072 sc1 lds
    ds_read_b128 v[208:211], v14 offset:16384
    ds_read_b128 v[212:215], v14 offset:17408
    ds_read_b128 v[216:219], v14 offset:18432
    ds_read_b128 v[220:223], v14 offset:19456
    s_add_u32 m0, s49, 55296
    s_add_u32 s96, s46, 0x1671000
    buffer_load_dwordx4 v252, s[4:7], s96 offen offset:0 sc1 lds
    ds_read_b128 v[224:227], v14 offset:20480
    ds_read_b128 v[228:231], v14 offset:21504
    ds_read_b128 v[232:235], v14 offset:22528
    ds_read_b128 v[236:239], v14 offset:23552
    buffer_load_dwordx4 v252, s[4:7], s96 offen offset:1024 sc1 lds
    ds_read_b128 v[240:243], v14 offset:24576
    v_mov_b32 v64, s61
    v_mov_b32 v65, s61
    v_mov_b32 v66, s61
    v_mov_b32 v67, s61
    s_waitcnt lgkmcnt(15)
    s_nop 0
    v_mfma_f32_16x16x32_bf16 v[42:45], v[64:67], v[144:147], 0
    v_mfma_f32_16x16x32_bf16 v[46:49], v[64:67], v[148:151], 0
    v_mfma_f32_16x16x32_bf16 v[50:53], v[64:67], v[152:155], 0
    v_mfma_f32_16x16x32_bf16 v[54:57], v[64:67], v[156:159], 0
    v_mfma_f32_16x16x32_bf16 v[58:61], v[64:67], v[160:163], 0
    buffer_load_dwordx4 v252, s[4:7], s96 offen offset:2048 sc1 lds
    v_mfma_f32_16x16x32_bf16 v[42:45], v[64:67], v[164:167], v[42:45]
    v_mfma_f32_16x16x32_bf16 v[46:49], v[64:67], v[168:171], v[46:49]
    v_mfma_f32_16x16x32_bf16 v[50:53], v[64:67], v[172:175], v[50:53]
    v_mfma_f32_16x16x32_bf16 v[54:57], v[64:67], v[176:179], v[54:57]
    v_mfma_f32_16x16x32_bf16 v[58:61], v[64:67], v[180:183], v[58:61]
    buffer_load_dwordx4 v252, s[4:7], s96 offen offset:3072 sc1 lds
    s_waitcnt lgkmcnt(10)
    v_mfma_f32_16x16x32_bf16 v[42:45], v[64:67], v[184:187], v[42:45]
    v_mfma_f32_16x16x32_bf16 v[46:49], v[64:67], v[188:191], v[46:49]
    v_mfma_f32_16x16x32_bf16 v[50:53], v[64:67], v[192:195], v[50:53]
    v_mfma_f32_16x16x32_bf16 v[54:57], v[64:67], v[196:199], v[54:57]
    v_mfma_f32_16x16x32_bf16 v[58:61], v[64:67], v[200:203], v[58:61]
    s_add_u32 m0, s49, 59392
    s_add_u32 s96, s46, 0x1672000
    buffer_load_dwordx4 v252, s[4:7], s96 offen offset:0 sc1 lds
    s_waitcnt lgkmcnt(5)
    v_mfma_f32_16x16x32_bf16 v[42:45], v[64:67], v[204:207], v[42:45]
    v_mfma_f32_16x16x32_bf16 v[46:49], v[64:67], v[208:211], v[46:49]
    v_mfma_f32_16x16x32_bf16 v[50:53], v[64:67], v[212:215], v[50:53]
    v_mfma_f32_16x16x32_bf16 v[54:57], v[64:67], v[216:219], v[54:57]
    v_mfma_f32_16x16x32_bf16 v[58:61], v[64:67], v[220:223], v[58:61]
    buffer_load_dwordx4 v252, s[4:7], s96 offen offset:1024 sc1 lds
    s_waitcnt lgkmcnt(0)
    s_add_u32 s97, s38, 0xd000
    s_buffer_load_dwordx2 s[64:65], s[4:7], s97 glc
    v_mfma_f32_16x16x32_bf16 v[42:45], v[64:67], v[224:227], v[42:45]
    v_mfma_f32_16x16x32_bf16 v[46:49], v[64:67], v[228:231], v[46:49]
    v_mfma_f32_16x16x32_bf16 v[50:53], v[64:67], v[232:235], v[50:53]
    v_mfma_f32_16x16x32_bf16 v[54:57], v[64:67], v[236:239], v[54:57]
    v_mfma_f32_16x16x32_bf16 v[58:61], v[64:67], v[240:243], v[58:61]
    buffer_load_dwordx4 v252, s[4:7], s96 offen offset:2048 sc1 lds
    s_lshl_b32 s80, s26, 2
    s_add_u32 s80, s80, 156672
    v_and_b32 v20, 15, v1
    v_lshlrev_b32 v20, 4, v20
    v_add_u32 v21, 156672, v20
    v_add_u32 v20, s80, v20
    s_mov_b64 s[82:83], 0xffff
    v_cvt_pk_bf16_f32 v32, v42, v42
    v_lshlrev_b32 v37, 16, v32
    v_sub_f32 v37, v42, v37
    v_cvt_pk_bf16_f32 v32, v42, v37
    v_cvt_pk_bf16_f32 v33, v46, v46
    v_lshlrev_b32 v38, 16, v33
    v_sub_f32 v38, v46, v38
    v_cvt_pk_bf16_f32 v33, v46, v38
    v_cvt_pk_bf16_f32 v34, v50, v50
    v_lshlrev_b32 v39, 16, v34
    v_sub_f32 v39, v50, v39
    v_cvt_pk_bf16_f32 v34, v50, v39
    v_cvt_pk_bf16_f32 v35, v54, v54
    v_lshlrev_b32 v40, 16, v35
    v_sub_f32 v40, v54, v40
    v_cvt_pk_bf16_f32 v35, v54, v40
    v_cvt_pk_bf16_f32 v36, v58, v58
    v_lshlrev_b32 v41, 16, v36
    v_sub_f32 v41, v58, v41
    v_cvt_pk_bf16_f32 v36, v58, v41
    ds_write_b32 v20, v32 offset:0
    ds_write_b32 v20, v33 offset:256
    ds_write_b32 v20, v34 offset:512
    ds_write_b32 v20, v35 offset:768
    ds_write_b32 v20, v36 offset:1024
    buffer_load_dwordx4 v252, s[4:7], s96 offen offset:3072 sc1 lds
    s_add_u32 m0, s49, 63488
    s_add_u32 s96, s46, 0x1673000
    buffer_load_dwordx4 v252, s[4:7], s96 offen offset:0 sc1 lds
    s_add_u32 s96, s47, 0x1670000
    buffer_load_dwordx4 a[204:207], v252, s[4:7], s96 offen offset:0 sc1
    s_waitcnt lgkmcnt(0)
    s_mov_b32 s60, 0
    s_branch L_pc_23
L_poll_22:
    s_buffer_load_dwordx2 s[64:65], s[4:7], s97 glc
    s_add_u32 s60, s60, 1
    s_cmp_gt_u32 s60, 400000
    s_cbranch_scc1 L_end
L_pc_23:
    s_waitcnt lgkmcnt(0)
    s_xor_b64 s[64:65], s[64:65], s[56:57]
    s_cbranch_scc1 L_poll_22
L_p1_21:
    s_barrier
    s_add_u32 s27, s12, 0x760000
    buffer_load_dwordx4 v[64:67], v252, s[4:7], s27 offen offset:0 sc1
    buffer_load_dwordx4 v[68:71], v252, s[4:7], s27 offen offset:1024 sc1
    buffer_load_dwordx4 v[72:75], v252, s[4:7], s27 offen offset:2048 sc1
    buffer_load_dwordx4 v[76:79], v252, s[4:7], s27 offen offset:3072 sc1
    s_add_u32 s27, s12, 0x761000
    buffer_load_dwordx4 v[80:83], v252, s[4:7], s27 offen offset:0 sc1
    s_add_u32 s28, s45, 0x28000
    buffer_load_dwordx2 v[244:245], v18, s[4:7], s28 offen sc1
    buffer_load_dwordx2 v[246:247], v18, s[4:7], s28 offen offset:512 sc1
    s_add_u32 s27, s13, 0x760000
    buffer_load_dwordx4 v[84:87], v252, s[4:7], s27 offen offset:0 sc1
    buffer_load_dwordx4 v[88:91], v252, s[4:7], s27 offen offset:1024 sc1
    buffer_load_dwordx4 v[92:95], v252, s[4:7], s27 offen offset:2048 sc1
    buffer_load_dwordx4 v[96:99], v252, s[4:7], s27 offen offset:3072 sc1
    s_add_u32 s27, s13, 0x761000
    buffer_load_dwordx4 v[100:103], v252, s[4:7], s27 offen offset:0 sc1
    s_waitcnt vmcnt(11)
    v_mfma_f32_16x16x32_bf16 v[42:45], v[144:147], v[64:67], 0
    v_mfma_f32_16x16x32_bf16 v[46:49], v[148:151], v[64:67], 0
    ds_read_b128 v[144:147], v15 offset:0
    v_mfma_f32_16x16x32_bf16 v[50:53], v[152:155], v[64:67], 0
    ds_read_b128 v[148:151], v15 offset:1024
    s_add_u32 s27, s14, 0x760000
    buffer_load_dwordx4 v[104:107], v252, s[4:7], s27 offen offset:0 sc1
    v_mfma_f32_16x16x32_bf16 v[54:57], v[156:159], v[64:67], 0
    ds_read_b128 v[152:155], v15 offset:2048
    v_mfma_f32_16x16x32_bf16 v[58:61], v[160:163], v[64:67], 0
    ds_read_b128 v[156:159], v15 offset:3072
    s_waitcnt vmcnt(11)
    v_mfma_f32_16x16x32_bf16 v[42:45], v[164:167], v[68:71], v[42:45]
    ds_read_b128 v[160:163], v15 offset:4096
    v_mfma_f32_16x16x32_bf16 v[46:49], v[168:171], v[68:71], v[46:49]
    ds_read_b128 v[164:167], v15 offset:5120
    buffer_load_dwordx4 v[108:111], v252, s[4:7], s27 offen offset:1024 sc1
    v_mfma_f32_16x16x32_bf16 v[50:53], v[172:175], v[68:71], v[50:53]
    ds_read_b128 v[168:171], v15 offset:6144
    v_mfma_f32_16x16x32_bf16 v[54:57], v[176:179], v[68:71], v[54:57]
    ds_read_b128 v[172:175], v15 offset:7168
    v_mfma_f32_16x16x32_bf16 v[58:61], v[180:183], v[68:71], v[58:61]
    ds_read_b128 v[176:179], v15 offset:8192
    s_waitcnt vmcnt(11)
    v_mfma_f32_16x16x32_bf16 v[42:45], v[184:187], v[72:75], v[42:45]
    ds_read_b128 v[180:183], v15 offset:9216
    buffer_load_dwordx4 v[112:115], v252, s[4:7], s27 offen offset:2048 sc1
    v_mfma_f32_16x16x32_bf16 v[46:49], v[188:191], v[72:75], v[46:49]
    ds_read_b128 v[184:187], v15 offset:10240
    v_mfma_f32_16x16x32_bf16 v[50:53], v[192:195], v[72:75], v[50:53]
    ds_read_b128 v[188:191], v15 offset:11264
    s_waitcnt vmcnt(8)
    v_add_f32 v244, v244, v246
    v_mfma_f32_16x16x32_bf16 v[54:57], v[196:199], v[72:75], v[54:57]
    ds_read_b128 v[192:195], v15 offset:12288
    v_add_f32 v245, v245, v247
    v_mov_b32 v246, v244
    v_mfma_f32_16x16x32_bf16 v[58:61], v[200:203], v[72:75], v[58:61]
    ds_read_b128 v[196:199], v15 offset:13312
    buffer_load_dwordx4 v[116:119], v252, s[4:7], s27 offen offset:3072 sc1
    v_mfma_f32_16x16x32_bf16 v[42:45], v[204:207], v[76:79], v[42:45]
    ds_read_b128 v[200:203], v15 offset:14336
    v_mov_b32 v247, v245
    v_permlane16_swap_b32 v244, v246
    v_mfma_f32_16x16x32_bf16 v[46:49], v[208:211], v[76:79], v[46:49]
    ds_read_b128 v[204:207], v15 offset:15360
    v_permlane16_swap_b32 v245, v247
    v_add_f32 v244, v244, v246
    v_mfma_f32_16x16x32_bf16 v[50:53], v[212:215], v[76:79], v[50:53]
    ds_read_b128 v[208:211], v15 offset:16384
    v_add_f32 v245, v245, v247
    v_mov_b32 v246, v244
    v_mfma_f32_16x16x32_bf16 v[54:57], v[216:219], v[76:79], v[54:57]
    ds_read_b128 v[212:215], v15 offset:17408
    s_add_u32 s27, s14, 0x761000
    buffer_load_dwordx4 v[120:123], v252, s[4:7], s27 offen offset:0 sc1
    v_mfma_f32_16x16x32_bf16 v[58:61], v[220:223], v[76:79], v[58:61]
    ds_read_b128 v[216:219], v15 offset:18432
    v_mov_b32 v247, v245
    v_permlane32_swap_b32 v244, v246
    v_mfma_f32_16x16x32_bf16 v[42:45], v[224:227], v[80:83], v[42:45]
    ds_read_b128 v[220:223], v15 offset:19456
    v_permlane32_swap_b32 v245, v247
    v_add_f32 v244, v244, v246
    v_mfma_f32_16x16x32_bf16 v[46:49], v[228:231], v[80:83], v[46:49]
    ds_read_b128 v[224:227], v15 offset:20480
    v_add_f32 v245, v245, v247
    v_mul_f32 v12, -0.0015625, v244
    v_mfma_f32_16x16x32_bf16 v[50:53], v[232:235], v[80:83], v[50:53]
    ds_read_b128 v[228:231], v15 offset:21504
    s_add_u32 s27, s15, 0x760000
    buffer_load_dwordx4 v[124:127], v252, s[4:7], s27 offen offset:0 sc1
    v_mfma_f32_16x16x32_bf16 v[54:57], v[236:239], v[80:83], v[54:57]
    ds_read_b128 v[232:235], v15 offset:22528
    v_mul_f32 v245, 0.0015625, v245
    v_fma_f32 v246, -v12, v12, v245
    v_mfma_f32_16x16x32_bf16 v[58:61], v[240:243], v[80:83], v[58:61]
    ds_read_b128 v[236:239], v15 offset:23552
    v_max_f32 v246, 0, v246
    v_add_f32 v247, 0x3727c5ac, v246
    s_waitcnt vmcnt(10) lgkmcnt(15)
    v_mfma_f32_16x16x32_bf16 v[42:45], v[144:147], v[84:87], v[42:45]
    ds_read_b128 v[240:243], v15 offset:24576
    v_rsq_f32 v13, v247
    v_mfma_f32_16x16x32_bf16 v[46:49], v[148:151], v[84:87], v[46:49]
    ds_read_b128 v[144:147], v16 offset:0
    buffer_load_dwordx4 v[128:131], v252, s[4:7], s27 offen offset:1024 sc1
    v_mfma_f32_16x16x32_bf16 v[50:53], v[152:155], v[84:87], v[50:53]
    ds_read_b128 v[148:151], v16 offset:1024
    v_cvt_pk_bf16_f32 v32, v12, v12
    v_lshlrev_b32 v36, 16, v32
    v_mfma_f32_16x16x32_bf16 v[54:57], v[156:159], v[84:87], v[54:57]
    ds_read_b128 v[152:155], v16 offset:2048
    v_sub_f32 v36, v12, v36
    v_cvt_pk_bf16_f32 v36, v36, v36
    v_mfma_f32_16x16x32_bf16 v[58:61], v[160:163], v[84:87], v[58:61]
    ds_read_b128 v[156:159], v16 offset:3072
    v_cndmask_b32 v32, v36, v32, s[82:83]
    v_cndmask_b32 v32, v32, 0, s[58:59]
    s_waitcnt vmcnt(10) lgkmcnt(15)
    v_mfma_f32_16x16x32_bf16 v[42:45], v[164:167], v[88:91], v[42:45]
    ds_read_b128 v[160:163], v16 offset:4096
    buffer_load_dwordx4 v[132:135], v252, s[4:7], s27 offen offset:2048 sc1
    ds_read_b128 v[64:67], v21 offset:0
    ds_read_b128 v[68:71], v21 offset:256
    ds_read_b128 v[72:75], v21 offset:512
    ds_read_b128 v[76:79], v21 offset:768
    ds_read_b128 v[80:83], v21 offset:1024
    v_mfma_f32_16x16x32_bf16 v[46:49], v[168:171], v[88:91], v[46:49]
    ds_read_b128 v[164:167], v16 offset:5120
    v_mul_f32 v247, v13, v13
    v_mov_b32 v33, v32
    v_mfma_f32_16x16x32_bf16 v[50:53], v[172:175], v[88:91], v[50:53]
    ds_read_b128 v[168:171], v16 offset:6144
    v_mul_f32 v246, v246, v247
    v_mov_b32 v34, v32
    v_mfma_f32_16x16x32_bf16 v[54:57], v[176:179], v[88:91], v[54:57]
    ds_read_b128 v[172:175], v16 offset:7168
    v_add_f32 v246, 0x3727c5ac, v246
    v_rsq_f32 v246, v246
    v_mfma_f32_16x16x32_bf16 v[58:61], v[180:183], v[88:91], v[58:61]
    ds_read_b128 v[176:179], v16 offset:8192
    buffer_load_dwordx4 v[136:139], v252, s[4:7], s27 offen offset:3072 sc1
    s_waitcnt vmcnt(11) lgkmcnt(15)
    v_mfma_f32_16x16x32_bf16 v[42:45], v[184:187], v[92:95], v[42:45]
    ds_read_b128 v[180:183], v16 offset:9216
    v_mov_b32 v35, v32
    v_mfma_f32_16x16x32_bf16 v[46:49], v[188:191], v[92:95], v[46:49]
    ds_read_b128 v[184:187], v16 offset:10240
    v_mul_f32 v246, v246, v13
    v_mul_f32 v247, v246, v246
    v_mfma_f32_16x16x32_bf16 v[50:53], v[192:195], v[92:95], v[50:53]
    ds_read_b128 v[188:191], v16 offset:11264
    v_rcp_f32 v248, v246
    v_mfma_f32_16x16x32_bf16 v[54:57], v[196:199], v[92:95], v[54:57]
    ds_read_b128 v[192:195], v16 offset:15360
    s_add_u32 s27, s15, 0x761000
    buffer_load_dwordx4 v[140:143], v252, s[4:7], s27 offen offset:0 sc1
    v_mfma_f32_16x16x32_bf16 v[58:61], v[200:203], v[92:95], v[58:61]
    ds_read_b128 v[196:199], v16 offset:16384
    v_mul_f32 v63, -2.302208198, v246
    v_mul_f32 v247, v247, v246
    s_waitcnt vmcnt(11)
    v_mfma_f32_16x16x32_bf16 v[42:45], v[204:207], v[96:99], v[42:45]
    ds_read_b128 v[200:203], v16 offset:20480
    v_mul_f32 v62, -0.10294323957357, v247
    v_mfma_f32_16x16x32_bf16 v[46:49], v[208:211], v[96:99], v[46:49]
    ds_read_b128 v[204:207], v16 offset:21504
    v_mfma_f32_16x16x32_bf16 v[50:53], v[212:215], v[96:99], v[50:53]
    ds_read_b128 v[208:211], v17 offset:0
    buffer_load_dwordx4 a[208:211], v252, s[4:7], s96 offen offset:1024 sc1
    v_mfma_f32_16x16x32_bf16 v[54:57], v[216:219], v[96:99], v[54:57]
    ds_read_b128 v[212:215], v17 offset:1024
    v_mfma_f32_16x16x32_bf16 v[58:61], v[220:223], v[96:99], v[58:61]
    ds_read_b128 v[216:219], v17 offset:5120
    s_waitcnt vmcnt(11) lgkmcnt(15)
    v_mfma_f32_16x16x32_bf16 v[42:45], v[224:227], v[100:103], v[42:45]
    ds_read_b128 v[220:223], v17 offset:6144
    v_mfma_f32_16x16x32_bf16 v[46:49], v[228:231], v[100:103], v[46:49]
    ds_read_b128 v[224:227], v17 offset:10240
    buffer_load_dwordx4 a[212:215], v252, s[4:7], s96 offen offset:2048 sc1
    v_mfma_f32_16x16x32_bf16 v[50:53], v[232:235], v[100:103], v[50:53]
    ds_read_b128 v[228:231], v17 offset:11264
    v_mfma_f32_16x16x32_bf16 v[54:57], v[236:239], v[100:103], v[54:57]
    ds_read_b128 v[232:235], v17 offset:15360
    v_mfma_f32_16x16x32_bf16 v[58:61], v[240:243], v[100:103], v[58:61]
    ds_read_b128 v[236:239], v17 offset:16384
    s_waitcnt vmcnt(11)
    v_mfma_f32_16x16x32_bf16 v[42:45], v[144:147], v[104:107], v[42:45]
    ds_read_b128 v[240:243], v17 offset:20480
    buffer_load_dwordx4 a[216:219], v252, s[4:7], s96 offen offset:3072 sc1
    v_mfma_f32_16x16x32_bf16 v[46:49], v[148:151], v[104:107], v[46:49]
    ds_read_b128 v[144:147], v17 offset:21504
    v_mfma_f32_16x16x32_bf16 v[50:53], v[152:155], v[104:107], v[50:53]
    ds_read_b128 v[148:151], v16 offset:14336
    v_mfma_f32_16x16x32_bf16 v[54:57], v[156:159], v[104:107], v[54:57]
    ds_read_b128 v[152:155], v16 offset:19456
    v_mfma_f32_16x16x32_bf16 v[58:61], v[160:163], v[104:107], v[58:61]
    ds_read_b128 v[156:159], v16 offset:24576
    s_add_u32 s96, s47, 0x1671000
    buffer_load_dwordx4 a[220:223], v252, s[4:7], s96 offen offset:0 sc1
    s_waitcnt vmcnt(12) lgkmcnt(15)
    v_mfma_f32_16x16x32_bf16 v[42:45], v[164:167], v[108:111], v[42:45]
    ds_read_b128 v[160:163], v17 offset:4096
    v_mfma_f32_16x16x32_bf16 v[46:49], v[168:171], v[108:111], v[46:49]
    ds_read_b128 v[164:167], v17 offset:9216
    v_mfma_f32_16x16x32_bf16 v[50:53], v[172:175], v[108:111], v[50:53]
    ds_read_b128 v[168:171], v17 offset:14336
    v_mfma_f32_16x16x32_bf16 v[54:57], v[176:179], v[108:111], v[54:57]
    ds_read_b128 v[172:175], v17 offset:19456
    buffer_load_dwordx4 a[224:227], v252, s[4:7], s96 offen offset:1024 sc1
    v_mfma_f32_16x16x32_bf16 v[58:61], v[180:183], v[108:111], v[58:61]
    ds_read_b128 v[176:179], v17 offset:24576
    s_waitcnt vmcnt(12) lgkmcnt(15)
    v_mfma_f32_16x16x32_bf16 v[42:45], v[184:187], v[112:115], v[42:45]
    ds_read_b128 v[180:183], v16 offset:12288
    v_mfma_f32_16x16x32_bf16 v[46:49], v[188:191], v[112:115], v[46:49]
    ds_read_b128 v[184:187], v16 offset:13312
    s_waitcnt vmcnt(11)
    v_mfma_f32_16x16x32_bf16 v[42:45], v[192:195], v[116:119], v[42:45]
    ds_read_b128 v[188:191], v16 offset:17408
    buffer_load_dwordx4 a[228:231], v252, s[4:7], s96 offen offset:2048 sc1
    v_mfma_f32_16x16x32_bf16 v[46:49], v[196:199], v[116:119], v[46:49]
    ds_read_b128 v[192:195], v16 offset:18432
    s_waitcnt vmcnt(11)
    v_mfma_f32_16x16x32_bf16 v[42:45], v[200:203], v[120:123], v[42:45]
    ds_read_b128 v[196:199], v16 offset:22528
    v_mfma_f32_16x16x32_bf16 v[42:45], v[64:67], v[32:35], v[42:45]
    v_mfma_f32_16x16x32_bf16 v[46:49], v[68:71], v[32:35], v[46:49]
    v_mfma_f32_16x16x32_bf16 v[50:53], v[72:75], v[32:35], v[50:53]
    v_mfma_f32_16x16x32_bf16 v[54:57], v[76:79], v[32:35], v[54:57]
    v_mfma_f32_16x16x32_bf16 v[58:61], v[80:83], v[32:35], v[58:61]
    s_waitcnt lgkmcnt(15)
    v_mfma_f32_16x16x32_bf16 v[46:49], v[204:207], v[120:123], v[46:49]
    ds_read_b128 v[200:203], v16 offset:23552
    s_waitcnt vmcnt(10)
    v_mfma_f32_16x16x32_bf16 v[42:45], v[208:211], v[124:127], v[42:45]
    ds_read_b128 v[204:207], v17 offset:2048
    buffer_load_dwordx4 a[232:235], v252, s[4:7], s96 offen offset:3072 sc1
    v_mfma_f32_16x16x32_bf16 v[46:49], v[212:215], v[124:127], v[46:49]
    ds_read_b128 v[208:211], v17 offset:3072
    s_waitcnt vmcnt(10)
    v_mfma_f32_16x16x32_bf16 v[42:45], v[216:219], v[128:131], v[42:45]
    ds_read_b128 v[212:215], v17 offset:7168
    v_mfma_f32_16x16x32_bf16 v[46:49], v[220:223], v[128:131], v[46:49]
    ds_read_b128 v[216:219], v17 offset:8192
    s_waitcnt vmcnt(9) lgkmcnt(15)
    v_mfma_f32_16x16x32_bf16 v[42:45], v[224:227], v[132:135], v[42:45]
    ds_read_b128 v[220:223], v17 offset:12288
    s_add_u32 s96, s47, 0x1672000
    buffer_load_dwordx4 a[236:239], v252, s[4:7], s96 offen offset:0 sc1
    v_mfma_f32_16x16x32_bf16 v[46:49], v[228:231], v[132:135], v[46:49]
    ds_read_b128 v[224:227], v17 offset:13312
    s_waitcnt vmcnt(9)
    v_mfma_f32_16x16x32_bf16 v[42:45], v[232:235], v[136:139], v[42:45]
    ds_read_b128 v[228:231], v17 offset:17408
    v_mfma_f32_16x16x32_bf16 v[46:49], v[236:239], v[136:139], v[46:49]
    ds_read_b128 v[232:235], v17 offset:18432
    s_waitcnt vmcnt(8)
    v_mfma_f32_16x16x32_bf16 v[42:45], v[240:243], v[140:143], v[42:45]
    ds_read_b128 v[236:239], v17 offset:22528
    buffer_load_dwordx4 a[240:243], v252, s[4:7], s96 offen offset:1024 sc1
    s_waitcnt lgkmcnt(15)
    v_mfma_f32_16x16x32_bf16 v[46:49], v[144:147], v[140:143], v[46:49]
    ds_read_b128 v[240:243], v17 offset:23552
    v_mfma_f32_16x16x32_bf16 v[58:61], v[148:151], v[112:115], v[58:61]
    v_mfma_f32_16x16x32_bf16 v[58:61], v[152:155], v[116:119], v[58:61]
    v_mfma_f32_16x16x32_bf16 v[58:61], v[156:159], v[120:123], v[58:61]
    buffer_load_dwordx4 a[244:247], v252, s[4:7], s96 offen offset:2048 sc1
    v_mfma_f32_16x16x32_bf16 v[58:61], v[160:163], v[124:127], v[58:61]
    v_mul_f32 v84, v42, v42
    v_mul_f32 v85, v43, v43
    v_mul_f32 v86, v44, v44
    s_waitcnt lgkmcnt(15)
    v_mfma_f32_16x16x32_bf16 v[58:61], v[164:167], v[128:131], v[58:61]
    v_mul_f32 v87, v45, v45
    v_mul_f32 v88, v46, v46
    v_mul_f32 v89, v47, v47
    v_mfma_f32_16x16x32_bf16 v[58:61], v[168:171], v[132:135], v[58:61]
    v_mul_f32 v90, v48, v48
    v_mul_f32 v91, v49, v49
    v_fma_f32 v84, v84, v62, v63
    v_mfma_f32_16x16x32_bf16 v[58:61], v[172:175], v[136:139], v[58:61]
    buffer_load_dwordx4 a[248:251], v252, s[4:7], s96 offen offset:3072 sc1
    v_mfma_f32_16x16x32_bf16 v[58:61], v[176:179], v[140:143], v[58:61]
    v_fma_f32 v85, v85, v62, v63
    v_fma_f32 v86, v86, v62, v63
    v_fma_f32 v87, v87, v62, v63
    v_mfma_f32_16x16x32_bf16 v[50:53], v[180:183], v[112:115], v[50:53]
    v_fma_f32 v88, v88, v62, v63
    v_fma_f32 v89, v89, v62, v63
    v_fma_f32 v90, v90, v62, v63
    s_waitcnt lgkmcnt(0)
    s_barrier
    v_mfma_f32_16x16x32_bf16 v[54:57], v[184:187], v[112:115], v[54:57]
    v_fma_f32 v91, v91, v62, v63
    v_mul_f32 v84, v84, v42
    v_mul_f32 v85, v85, v43
    v_mfma_f32_16x16x32_bf16 v[50:53], v[188:191], v[116:119], v[50:53]
    s_add_u32 s96, s47, 0x1673000
    buffer_load_dwordx4 a[252:255], v252, s[4:7], s96 offen offset:0 sc1
    v_mfma_f32_16x16x32_bf16 v[54:57], v[192:195], v[116:119], v[54:57]
    v_mul_f32 v86, v86, v44
    v_mul_f32 v87, v87, v45
    v_mul_f32 v88, v88, v46
    v_mfma_f32_16x16x32_bf16 v[50:53], v[196:199], v[120:123], v[50:53]
    v_mul_f32 v89, v89, v47
    v_mul_f32 v90, v90, v48
    v_mul_f32 v91, v91, v49
    v_mfma_f32_16x16x32_bf16 v[54:57], v[200:203], v[120:123], v[54:57]
    v_exp_f32 v84, v84
    v_exp_f32 v85, v85
    v_mfma_f32_16x16x32_bf16 v[50:53], v[204:207], v[124:127], v[50:53]
    s_add_u32 s99, s22, 0x1738000
    buffer_load_dwordx4 a[24:27], v252, s[4:7], s99 offen offset:0 sc1
    v_mfma_f32_16x16x32_bf16 v[54:57], v[208:211], v[124:127], v[54:57]
    v_exp_f32 v86, v86
    v_mfma_f32_16x16x32_bf16 v[50:53], v[212:215], v[128:131], v[50:53]
    v_exp_f32 v87, v87
    v_exp_f32 v88, v88
    v_mfma_f32_16x16x32_bf16 v[54:57], v[216:219], v[128:131], v[54:57]
    v_exp_f32 v89, v89
    v_mfma_f32_16x16x32_bf16 v[50:53], v[220:223], v[132:135], v[50:53]
    buffer_load_dwordx4 a[28:31], v252, s[4:7], s99 offen offset:1024 sc1
    v_mfma_f32_16x16x32_bf16 v[54:57], v[224:227], v[132:135], v[54:57]
    v_exp_f32 v90, v90
    v_exp_f32 v91, v91
    v_mfma_f32_16x16x32_bf16 v[50:53], v[228:231], v[136:139], v[50:53]
    v_fma_f32 v84, v84, v248, v248
    v_fma_f32 v85, v85, v248, v248
    v_mfma_f32_16x16x32_bf16 v[54:57], v[232:235], v[136:139], v[54:57]
    v_fma_f32 v86, v86, v248, v248
    v_fma_f32 v87, v87, v248, v248
    v_fma_f32 v88, v88, v248, v248
    v_mfma_f32_16x16x32_bf16 v[50:53], v[236:239], v[140:143], v[50:53]
    buffer_load_dwordx4 a[32:35], v252, s[4:7], s99 offen offset:2048 sc1
    v_mfma_f32_16x16x32_bf16 v[54:57], v[240:243], v[140:143], v[54:57]
    v_fma_f32 v89, v89, v248, v248
    v_fma_f32 v90, v90, v248, v248
    v_fma_f32 v91, v91, v248, v248
    v_rcp_f32 v84, v84
    v_rcp_f32 v85, v85
    v_rcp_f32 v86, v86
    v_rcp_f32 v87, v87
    v_rcp_f32 v88, v88
    v_rcp_f32 v89, v89
    v_rcp_f32 v90, v90
    v_rcp_f32 v91, v91
    v_mul_f32 v42, v42, v84
    v_mul_f32 v43, v43, v85
    v_mul_f32 v44, v44, v86
    v_mul_f32 v45, v45, v87
    v_mul_f32 v46, v46, v88
    v_mul_f32 v47, v47, v89
    v_mul_f32 v48, v48, v90
    v_mul_f32 v49, v49, v91
    v_cvt_pk_bf16_f32 v92, v42, v43
    v_cvt_pk_bf16_f32 v93, v44, v45
    v_cvt_pk_bf16_f32 v94, v46, v47
    v_cvt_pk_bf16_f32 v95, v48, v49
    s_add_u32 s28, s43, 0x9e0000
    buffer_store_dwordx4 v[92:95], v4, s[4:7], s28 offen offset:0 sc1
    v_mul_f32 v84, v58, v58
    v_mul_f32 v85, v59, v59
    v_mul_f32 v86, v60, v60
    v_mul_f32 v87, v61, v61
    v_fma_f32 v84, v84, v62, v63
    v_fma_f32 v85, v85, v62, v63
    v_fma_f32 v86, v86, v62, v63
    v_fma_f32 v87, v87, v62, v63
    v_mul_f32 v84, v84, v58
    v_mul_f32 v85, v85, v59
    v_mul_f32 v86, v86, v60
    v_mul_f32 v87, v87, v61
    v_exp_f32 v84, v84
    v_exp_f32 v85, v85
    v_exp_f32 v86, v86
    v_exp_f32 v87, v87
    v_fma_f32 v84, v84, v248, v248
    v_fma_f32 v85, v85, v248, v248
    v_fma_f32 v86, v86, v248, v248
    v_fma_f32 v87, v87, v248, v248
    v_rcp_f32 v84, v84
    v_rcp_f32 v85, v85
    v_rcp_f32 v86, v86
    v_rcp_f32 v87, v87
    v_mul_f32 v58, v58, v84
    v_mul_f32 v59, v59, v85
    v_mul_f32 v60, v60, v86
    v_mul_f32 v61, v61, v87
    v_cvt_pk_bf16_f32 v100, v58, v59
    v_cvt_pk_bf16_f32 v101, v60, v61
    s_add_u32 s28, s43, 0x9e0000
    buffer_store_dwordx2 v[100:101], v5, s[4:7], s28 offen sc1
    v_pk_mul_f32 v[84:85], v[50:51], v[50:51]
    v_pk_mul_f32 v[86:87], v[52:53], v[52:53]
    v_pk_mul_f32 v[88:89], v[54:55], v[54:55]
    v_pk_mul_f32 v[90:91], v[56:57], v[56:57]
    v_pk_fma_f32 v[84:85], v[84:85], v[62:63], v[62:63] op_sel:[0,0,1] op_sel_hi:[1,0,1]
    v_pk_fma_f32 v[86:87], v[86:87], v[62:63], v[62:63] op_sel:[0,0,1] op_sel_hi:[1,0,1]
    v_pk_fma_f32 v[88:89], v[88:89], v[62:63], v[62:63] op_sel:[0,0,1] op_sel_hi:[1,0,1]
    v_pk_fma_f32 v[90:91], v[90:91], v[62:63], v[62:63] op_sel:[0,0,1] op_sel_hi:[1,0,1]
    v_pk_mul_f32 v[84:85], v[84:85], v[50:51]
    v_pk_mul_f32 v[86:87], v[86:87], v[52:53]
    v_pk_mul_f32 v[88:89], v[88:89], v[54:55]
    v_pk_mul_f32 v[90:91], v[90:91], v[56:57]
    v_exp_f32 v84, v84
    v_exp_f32 v85, v85
    v_exp_f32 v86, v86
    v_exp_f32 v87, v87
    v_exp_f32 v88, v88
    v_exp_f32 v89, v89
    v_exp_f32 v90, v90
    v_exp_f32 v91, v91
    v_pk_fma_f32 v[84:85], v[84:85], v[248:249], v[248:249] op_sel_hi:[1,0,0]
    v_pk_fma_f32 v[86:87], v[86:87], v[248:249], v[248:249] op_sel_hi:[1,0,0]
    v_pk_fma_f32 v[88:89], v[88:89], v[248:249], v[248:249] op_sel_hi:[1,0,0]
    v_pk_fma_f32 v[90:91], v[90:91], v[248:249], v[248:249] op_sel_hi:[1,0,0]
    v_rcp_f32 v84, v84
    v_rcp_f32 v85, v85
    v_rcp_f32 v86, v86
    v_rcp_f32 v87, v87
    v_rcp_f32 v88, v88
    v_rcp_f32 v89, v89
    v_rcp_f32 v90, v90
    v_rcp_f32 v91, v91
    v_pk_mul_f32 v[50:51], v[50:51], v[84:85]
    v_pk_mul_f32 v[52:53], v[52:53], v[86:87]
    v_pk_mul_f32 v[54:55], v[54:55], v[88:89]
    v_pk_mul_f32 v[56:57], v[56:57], v[90:91]
    v_cvt_pk_bf16_f32 v96, v50, v51
    v_cvt_pk_bf16_f32 v97, v52, v53
    v_cvt_pk_bf16_f32 v98, v54, v55
    v_cvt_pk_bf16_f32 v99, v56, v57
    s_add_u32 s28, s43, 0x9e0000
    buffer_store_dwordx4 v[96:99], v4, s[4:7], s28 offen offset:256 sc1
    s_add_u32 s29, s39, 0x11000
    s_add_u32 s80, s49, 102400
    v_add_u32 v20, s80, v252
    s_waitcnt vmcnt(6)
    ds_write_b128 v20, a[204:207] offset:0
    s_add_u32 s99, s23, 0x1738000
    buffer_load_dwordx4 a[36:39], v252, s[4:7], s99 offen offset:0 sc1
    ds_write_b128 v20, a[208:211] offset:1024
    ds_write_b128 v20, a[212:215] offset:2048
    buffer_load_dwordx4 a[40:43], v252, s[4:7], s99 offen offset:1024 sc1
    s_add_u32 s80, s26, s25
    s_add_u32 s80, s80, s48
    s_add_u32 s80, s80, 0
    s_and_b32 s80, s80, 3
    s_add_u32 s80, s80, 2
    s_sub_u32 s81, s80, 6
    s_cmp_ge_u32 s80, 6
    s_cselect_b32 s80, s81, s80
    s_mul_i32 s80, s80, 25600
    v_add_u32 v14, s80, v252
    ds_write_b128 v20, a[216:219] offset:3072
    ds_write_b128 v20, a[220:223] offset:4096
    buffer_load_dwordx4 a[44:47], v252, s[4:7], s99 offen offset:2048 sc1
    ds_write_b128 v20, a[224:227] offset:5120
    s_add_u32 s80, s26, s25
    s_add_u32 s80, s80, s48
    s_add_u32 s80, s80, 1
    s_and_b32 s80, s80, 3
    s_add_u32 s80, s80, 2
    s_sub_u32 s81, s80, 6
    s_cmp_ge_u32 s80, 6
    s_cselect_b32 s80, s81, s80
    s_mul_i32 s80, s80, 25600
    v_add_u32 v15, s80, v252
    ds_write_b128 v20, a[228:231] offset:6144
    s_add_u32 s99, s20, 0x173b000
    buffer_load_dwordx4 a[48:51], v252, s[4:7], s99 offen offset:0 sc1
    ds_write_b128 v20, a[232:235] offset:7168
    ds_write_b128 v20, a[236:239] offset:8192
    buffer_load_dwordx4 a[52:55], v252, s[4:7], s99 offen offset:1024 sc1
    s_add_u32 s80, s26, s25
    s_add_u32 s80, s80, s48
    s_add_u32 s80, s80, 2
    s_and_b32 s80, s80, 3
    s_add_u32 s80, s80, 2
    s_sub_u32 s81, s80, 6
    s_cmp_ge_u32 s80, 6
    s_cselect_b32 s80, s81, s80
    s_mul_i32 s80, s80, 25600
    v_add_u32 v16, s80, v252
    ds_write_b128 v20, a[240:243] offset:9216
    ds_write_b128 v20, a[244:247] offset:10240
    buffer_load_dwordx4 a[56:59], v252, s[4:7], s99 offen offset:2048 sc1
    ds_write_b128 v20, a[248:251] offset:11264
    s_add_u32 s80, s26, s25
    s_add_u32 s80, s80, s48
    s_add_u32 s80, s80, 3
    s_and_b32 s80, s80, 3
    s_add_u32 s80, s80, 2
    s_sub_u32 s81, s80, 6
    s_cmp_ge_u32 s80, 6
    s_cselect_b32 s80, s81, s80
    s_mul_i32 s80, s80, 25600
    v_add_u32 v17, s80, v252
    ds_write_b128 v20, a[252:255] offset:12288
    s_waitcnt lgkmcnt(0)
    s_waitcnt vmcnt(6)
    s_barrier
    s_cmp_lg_u32 s26, 0
    s_cbranch_scc1 L_sig_24
    s_mov_b64 exec, 1
    buffer_store_dword v254, off, s[4:7], s29 sc1
    buffer_store_dword v254, off, s[4:7], s42 sc1
    s_mov_b64 exec, -1
L_sig_24:
    s_getpc_b64 s[80:81]
L_pc_25:
    s_lshr_b32 s27, s2, 3
    s_lshl_b32 s27, s27, 2
    s_add_u32 s27, s27, s26
    s_lshl_b32 s27, s27, 8
    v_lshl_add_u32 v0, v1, 2, s27
    v_min_u32 v0, L_codeend-L_pc_25-4, v0
    global_load_dword v0, v0, s[80:81]
    ds_read_b128 v[144:147], v14 offset:0
    ds_read_b128 v[148:151], v14 offset:1024
    ds_read_b128 v[152:155], v14 offset:2048
    ds_read_b128 v[156:159], v14 offset:3072
    s_add_u32 s99, s21, 0x173b000
    buffer_load_dwordx4 a[60:63], v252, s[4:7], s99 offen offset:0 sc1
    ds_read_b128 v[160:163], v14 offset:4096
    ds_read_b128 v[164:167], v14 offset:5120
    ds_read_b128 v[168:171], v14 offset:6144
    ds_read_b128 v[172:175], v14 offset:7168
    buffer_load_dwordx4 a[64:67], v252, s[4:7], s99 offen offset:1024 sc1
    ds_read_b128 v[176:179], v14 offset:8192
    ds_read_b128 v[180:183], v14 offset:9216
    ds_read_b128 v[184:187], v14 offset:10240
    ds_read_b128 v[188:191], v14 offset:11264
    buffer_load_dwordx4 a[68:71], v252, s[4:7], s99 offen offset:2048 sc1
    ds_read_b128 v[192:195], v14 offset:12288
    ds_read_b128 v[196:199], v14 offset:13312
    ds_read_b128 v[200:203], v14 offset:14336
    ds_read_b128 v[204:207], v14 offset:15360
    s_add_u32 s99, s22, 0x173b000
    buffer_load_dwordx4 a[72:75], v252, s[4:7], s99 offen offset:0 sc1
    ds_read_b128 v[208:211], v14 offset:16384
    ds_read_b128 v[212:215], v14 offset:17408
    ds_read_b128 v[216:219], v14 offset:18432
    ds_read_b128 v[220:223], v14 offset:19456
    buffer_load_dwordx4 a[76:79], v252, s[4:7], s99 offen offset:1024 sc1
    ds_read_b128 v[224:227], v14 offset:20480
    ds_read_b128 v[228:231], v14 offset:21504
    ds_read_b128 v[232:235], v14 offset:22528
    ds_read_b128 v[236:239], v14 offset:23552
    buffer_load_dwordx4 a[80:83], v252, s[4:7], s99 offen offset:2048 sc1
    ds_read_b128 v[240:243], v14 offset:24576
    v_lshlrev_b32 v42, 16, v22
    v_and_b32 v43, 0xffff0000, v22
    v_lshlrev_b32 v44, 16, v23
    v_and_b32 v45, 0xffff0000, v23
    v_lshlrev_b32 v46, 16, v24
    v_and_b32 v47, 0xffff0000, v24
    v_lshlrev_b32 v48, 16, v25
    v_and_b32 v49, 0xffff0000, v25
    s_add_u32 s99, s23, 0x173b000
    buffer_load_dwordx4 a[84:87], v252, s[4:7], s99 offen offset:0 sc1
    v_lshlrev_b32 v50, 16, v26
    v_and_b32 v51, 0xffff0000, v26
    v_lshlrev_b32 v52, 16, v27
    v_and_b32 v53, 0xffff0000, v27
    v_lshlrev_b32 v54, 16, v28
    v_and_b32 v55, 0xffff0000, v28
    v_lshlrev_b32 v56, 16, v29
    v_and_b32 v57, 0xffff0000, v29
    buffer_load_dwordx4 a[88:91], v252, s[4:7], s99 offen offset:1024 sc1
    v_lshlrev_b32 v58, 16, v30
    v_and_b32 v59, 0xffff0000, v30
    v_lshlrev_b32 v60, 16, v31
    v_and_b32 v61, 0xffff0000, v31
    v_pk_add_f32 v[42:43], v[42:43], v[12:13] op_sel_hi:[1,0]
    v_pk_add_f32 v[44:45], v[44:45], v[12:13] op_sel_hi:[1,0]
    v_pk_add_f32 v[46:47], v[46:47], v[12:13] op_sel_hi:[1,0]
    v_pk_add_f32 v[48:49], v[48:49], v[12:13] op_sel_hi:[1,0]
    buffer_load_dwordx4 a[92:95], v252, s[4:7], s99 offen offset:2048 sc1
    v_pk_add_f32 v[50:51], v[50:51], v[12:13] op_sel_hi:[1,0]
    v_pk_add_f32 v[52:53], v[52:53], v[12:13] op_sel_hi:[1,0]
    v_pk_add_f32 v[54:55], v[54:55], v[12:13] op_sel_hi:[1,0]
    v_pk_add_f32 v[56:57], v[56:57], v[12:13] op_sel_hi:[1,0]
    v_pk_add_f32 v[58:59], v[58:59], v[12:13] op_sel_hi:[1,0]
    v_pk_add_f32 v[60:61], v[60:61], v[12:13] op_sel_hi:[1,0]
    v_pk_mul_f32 v[42:43], v[42:43], v[12:13] op_sel:[0,1] op_sel_hi:[1,1]
    v_pk_mul_f32 v[44:45], v[44:45], v[12:13] op_sel:[0,1] op_sel_hi:[1,1]
    s_add_u32 s99, s20, 0x173e000
    buffer_load_dwordx4 a[96:99], v252, s[4:7], s99 offen offset:0 sc1
    v_pk_mul_f32 v[46:47], v[46:47], v[12:13] op_sel:[0,1] op_sel_hi:[1,1]
    v_pk_mul_f32 v[48:49], v[48:49], v[12:13] op_sel:[0,1] op_sel_hi:[1,1]
    v_pk_mul_f32 v[50:51], v[50:51], v[12:13] op_sel:[0,1] op_sel_hi:[1,1]
    v_pk_mul_f32 v[52:53], v[52:53], v[12:13] op_sel:[0,1] op_sel_hi:[1,1]
    v_pk_mul_f32 v[54:55], v[54:55], v[12:13] op_sel:[0,1] op_sel_hi:[1,1]
    v_pk_mul_f32 v[56:57], v[56:57], v[12:13] op_sel:[0,1] op_sel_hi:[1,1]
    v_pk_mul_f32 v[58:59], v[58:59], v[12:13] op_sel:[0,1] op_sel_hi:[1,1]
    v_pk_mul_f32 v[60:61], v[60:61], v[12:13] op_sel:[0,1] op_sel_hi:[1,1]
    buffer_load_dwordx4 a[100:103], v252, s[4:7], s99 offen offset:1024 sc1
    s_add_u32 s97, s38, 0x11000
    s_buffer_load_dwordx4 s[64:67], s[4:7], s97 glc
    buffer_load_dwordx4 a[104:107], v252, s[4:7], s99 offen offset:2048 sc1
    s_add_u32 s99, s21, 0x173e000
    buffer_load_dwordx4 a[108:111], v252, s[4:7], s99 offen offset:0 sc1
    buffer_load_dwordx4 a[112:115], v252, s[4:7], s99 offen offset:1024 sc1
    buffer_load_dwordx4 a[116:119], v252, s[4:7], s99 offen offset:2048 sc1
    s_add_u32 s99, s22, 0x173e000
    buffer_load_dwordx4 a[120:123], v252, s[4:7], s99 offen offset:0 sc1
    buffer_load_dwordx4 a[124:127], v252, s[4:7], s99 offen offset:1024 sc1
    s_mov_b32 s60, 0
    s_branch L_pc_28
L_poll_27:
    s_buffer_load_dwordx4 s[64:67], s[4:7], s97 glc
    s_add_u32 s60, s60, 1
    s_cmp_gt_u32 s60, 400000
    s_cbranch_scc1 L_end
L_pc_28:
    s_waitcnt lgkmcnt(0)
    s_xor_b64 s[64:65], s[64:65], s[56:57]
    s_xor_b64 s[66:67], s[66:67], s[56:57]
    s_or_b64 s[64:65], s[64:65], s[66:67]
    s_cbranch_scc1 L_poll_27
L_p1_26:
    s_barrier
    s_add_u32 s27, s12, 0x9db000
    buffer_load_dwordx4 v[64:67], v8, s[4:7], s27 offen offset:0 sc1
    buffer_load_dwordx4 v[68:71], v8, s[4:7], s27 offen offset:1024 sc1
    buffer_load_dwordx4 v[72:75], v8, s[4:7], s27 offen offset:2048 sc1
    buffer_load_dwordx4 v[76:79], v8, s[4:7], s27 offen offset:3072 sc1
    s_add_u32 s27, s12, 0x9dc000
    buffer_load_dwordx4 v[80:83], v8, s[4:7], s27 offen offset:0 sc1
    s_add_u32 s27, s13, 0x9db000
    buffer_load_dwordx4 v[84:87], v9, s[4:7], s27 offen offset:0 sc1
    buffer_load_dwordx4 v[88:91], v9, s[4:7], s27 offen offset:1024 sc1
    buffer_load_dwordx4 v[92:95], v9, s[4:7], s27 offen offset:2048 sc1
    s_waitcnt vmcnt(7) lgkmcnt(15)
    v_mfma_f32_16x16x32_bf16 v[42:45], v[144:147], v[64:67], v[42:45]
    v_mfma_f32_16x16x32_bf16 v[46:49], v[148:151], v[64:67], v[46:49]
    ds_read_b128 v[144:147], v15 offset:0
    v_mfma_f32_16x16x32_bf16 v[50:53], v[152:155], v[64:67], v[50:53]
    ds_read_b128 v[148:151], v15 offset:1024
    buffer_load_dwordx4 v[96:99], v9, s[4:7], s27 offen offset:3072 sc1
    v_mfma_f32_16x16x32_bf16 v[54:57], v[156:159], v[64:67], v[54:57]
    ds_read_b128 v[152:155], v15 offset:2048
    v_mfma_f32_16x16x32_bf16 v[58:61], v[160:163], v[64:67], v[58:61]
    ds_read_b128 v[156:159], v15 offset:3072
    s_waitcnt vmcnt(7)
    v_mfma_f32_16x16x32_bf16 v[42:45], v[164:167], v[68:71], v[42:45]
    ds_read_b128 v[160:163], v15 offset:4096
    v_mfma_f32_16x16x32_bf16 v[46:49], v[168:171], v[68:71], v[46:49]
    ds_read_b128 v[164:167], v15 offset:5120
    s_add_u32 s27, s13, 0x9dc000
    buffer_load_dwordx4 v[100:103], v9, s[4:7], s27 offen offset:0 sc1
    v_mfma_f32_16x16x32_bf16 v[50:53], v[172:175], v[68:71], v[50:53]
    ds_read_b128 v[168:171], v15 offset:6144
    v_mfma_f32_16x16x32_bf16 v[54:57], v[176:179], v[68:71], v[54:57]
    ds_read_b128 v[172:175], v15 offset:7168
    v_mfma_f32_16x16x32_bf16 v[58:61], v[180:183], v[68:71], v[58:61]
    ds_read_b128 v[176:179], v15 offset:8192
    s_waitcnt vmcnt(7) lgkmcnt(15)
    v_mfma_f32_16x16x32_bf16 v[42:45], v[184:187], v[72:75], v[42:45]
    ds_read_b128 v[180:183], v15 offset:9216
    s_add_u32 s27, s14, 0x9db000
    buffer_load_dwordx4 v[104:107], v10, s[4:7], s27 offen offset:0 sc1
    v_mfma_f32_16x16x32_bf16 v[46:49], v[188:191], v[72:75], v[46:49]
    ds_read_b128 v[184:187], v15 offset:10240
    v_mfma_f32_16x16x32_bf16 v[50:53], v[192:195], v[72:75], v[50:53]
    ds_read_b128 v[188:191], v15 offset:11264
    v_mfma_f32_16x16x32_bf16 v[54:57], v[196:199], v[72:75], v[54:57]
    ds_read_b128 v[192:195], v15 offset:12288
    v_mfma_f32_16x16x32_bf16 v[58:61], v[200:203], v[72:75], v[58:61]
    ds_read_b128 v[196:199], v15 offset:13312
    buffer_load_dwordx4 v[108:111], v10, s[4:7], s27 offen offset:1024 sc1
    s_waitcnt vmcnt(8) lgkmcnt(15)
    v_mfma_f32_16x16x32_bf16 v[42:45], v[204:207], v[76:79], v[42:45]
    ds_read_b128 v[200:203], v15 offset:14336
    v_mfma_f32_16x16x32_bf16 v[46:49], v[208:211], v[76:79], v[46:49]
    ds_read_b128 v[204:207], v15 offset:15360
    v_mfma_f32_16x16x32_bf16 v[50:53], v[212:215], v[76:79], v[50:53]
    ds_read_b128 v[208:211], v15 offset:16384
    v_mfma_f32_16x16x32_bf16 v[54:57], v[216:219], v[76:79], v[54:57]
    ds_read_b128 v[212:215], v15 offset:17408
    buffer_load_dwordx4 v[112:115], v10, s[4:7], s27 offen offset:2048 sc1
    v_mfma_f32_16x16x32_bf16 v[58:61], v[220:223], v[76:79], v[58:61]
    ds_read_b128 v[216:219], v15 offset:18432
    s_waitcnt vmcnt(8) lgkmcnt(15)
    v_mfma_f32_16x16x32_bf16 v[42:45], v[224:227], v[80:83], v[42:45]
    ds_read_b128 v[220:223], v15 offset:19456
    v_mfma_f32_16x16x32_bf16 v[46:49], v[228:231], v[80:83], v[46:49]
    ds_read_b128 v[224:227], v15 offset:20480
    v_mfma_f32_16x16x32_bf16 v[50:53], v[232:235], v[80:83], v[50:53]
    ds_read_b128 v[228:231], v15 offset:21504
    buffer_load_dwordx4 v[116:119], v10, s[4:7], s27 offen offset:3072 sc1
    v_mfma_f32_16x16x32_bf16 v[54:57], v[236:239], v[80:83], v[54:57]
    ds_read_b128 v[232:235], v15 offset:22528
    v_mfma_f32_16x16x32_bf16 v[58:61], v[240:243], v[80:83], v[58:61]
    ds_read_b128 v[236:239], v15 offset:23552
    s_waitcnt vmcnt(8) lgkmcnt(15)
    v_mfma_f32_16x16x32_bf16 v[42:45], v[144:147], v[84:87], v[42:45]
    ds_read_b128 v[240:243], v15 offset:24576
    v_mfma_f32_16x16x32_bf16 v[46:49], v[148:151], v[84:87], v[46:49]
    ds_read_b128 v[144:147], v16 offset:0
    s_add_u32 s27, s14, 0x9dc000
    buffer_load_dwordx4 v[120:123], v10, s[4:7], s27 offen offset:0 sc1
    v_mfma_f32_16x16x32_bf16 v[50:53], v[152:155], v[84:87], v[50:53]
    ds_read_b128 v[148:151], v16 offset:1024
    v_mfma_f32_16x16x32_bf16 v[54:57], v[156:159], v[84:87], v[54:57]
    ds_read_b128 v[152:155], v16 offset:2048
    v_mfma_f32_16x16x32_bf16 v[58:61], v[160:163], v[84:87], v[58:61]
    ds_read_b128 v[156:159], v16 offset:3072
    s_waitcnt vmcnt(8) lgkmcnt(15)
    v_mfma_f32_16x16x32_bf16 v[42:45], v[164:167], v[88:91], v[42:45]
    ds_read_b128 v[160:163], v16 offset:4096
    s_add_u32 s27, s15, 0x9db000
    buffer_load_dwordx4 v[124:127], v11, s[4:7], s27 offen offset:0 sc1
    v_mfma_f32_16x16x32_bf16 v[46:49], v[168:171], v[88:91], v[46:49]
    ds_read_b128 v[164:167], v16 offset:5120
    v_mfma_f32_16x16x32_bf16 v[50:53], v[172:175], v[88:91], v[50:53]
    ds_read_b128 v[168:171], v16 offset:6144
    v_mfma_f32_16x16x32_bf16 v[54:57], v[176:179], v[88:91], v[54:57]
    ds_read_b128 v[172:175], v16 offset:7168
    v_mfma_f32_16x16x32_bf16 v[58:61], v[180:183], v[88:91], v[58:61]
    ds_read_b128 v[176:179], v16 offset:8192
    buffer_load_dwordx4 v[128:131], v11, s[4:7], s27 offen offset:1024 sc1
    s_waitcnt vmcnt(9) lgkmcnt(15)
    v_mfma_f32_16x16x32_bf16 v[42:45], v[184:187], v[92:95], v[42:45]
    ds_read_b128 v[180:183], v16 offset:9216
    v_mfma_f32_16x16x32_bf16 v[46:49], v[188:191], v[92:95], v[46:49]
    ds_read_b128 v[184:187], v16 offset:10240
    v_mfma_f32_16x16x32_bf16 v[50:53], v[192:195], v[92:95], v[50:53]
    ds_read_b128 v[188:191], v16 offset:11264
    v_mfma_f32_16x16x32_bf16 v[54:57], v[196:199], v[92:95], v[54:57]
    ds_read_b128 v[192:195], v16 offset:15360
    buffer_load_dwordx4 v[132:135], v11, s[4:7], s27 offen offset:2048 sc1
    v_mfma_f32_16x16x32_bf16 v[58:61], v[200:203], v[92:95], v[58:61]
    ds_read_b128 v[196:199], v16 offset:16384
    s_waitcnt vmcnt(9) lgkmcnt(15)
    v_mfma_f32_16x16x32_bf16 v[42:45], v[204:207], v[96:99], v[42:45]
    ds_read_b128 v[200:203], v16 offset:20480
    v_mfma_f32_16x16x32_bf16 v[46:49], v[208:211], v[96:99], v[46:49]
    ds_read_b128 v[204:207], v16 offset:21504
    v_mfma_f32_16x16x32_bf16 v[50:53], v[212:215], v[96:99], v[50:53]
    ds_read_b128 v[208:211], v17 offset:0
    buffer_load_dwordx4 v[136:139], v11, s[4:7], s27 offen offset:3072 sc1
    v_mfma_f32_16x16x32_bf16 v[54:57], v[216:219], v[96:99], v[54:57]
    ds_read_b128 v[212:215], v17 offset:1024
    v_mfma_f32_16x16x32_bf16 v[58:61], v[220:223], v[96:99], v[58:61]
    ds_read_b128 v[216:219], v17 offset:5120
    s_waitcnt vmcnt(9) lgkmcnt(15)
    v_mfma_f32_16x16x32_bf16 v[42:45], v[224:227], v[100:103], v[42:45]
    ds_read_b128 v[220:223], v17 offset:6144
    v_mfma_f32_16x16x32_bf16 v[46:49], v[228:231], v[100:103], v[46:49]
    ds_read_b128 v[224:227], v17 offset:10240
    s_add_u32 s27, s15, 0x9dc000
    buffer_load_dwordx4 v[140:143], v11, s[4:7], s27 offen offset:0 sc1
    v_mfma_f32_16x16x32_bf16 v[50:53], v[232:235], v[100:103], v[50:53]
    ds_read_b128 v[228:231], v17 offset:11264
    v_mfma_f32_16x16x32_bf16 v[54:57], v[236:239], v[100:103], v[54:57]
    ds_read_b128 v[232:235], v17 offset:15360
    v_mfma_f32_16x16x32_bf16 v[58:61], v[240:243], v[100:103], v[58:61]
    ds_read_b128 v[236:239], v17 offset:16384
    s_waitcnt vmcnt(9) lgkmcnt(15)
    v_mfma_f32_16x16x32_bf16 v[42:45], v[144:147], v[104:107], v[42:45]
    ds_read_b128 v[240:243], v17 offset:20480
    buffer_load_dwordx4 a[128:131], v252, s[4:7], s99 offen offset:2048 sc1
    v_mfma_f32_16x16x32_bf16 v[46:49], v[148:151], v[104:107], v[46:49]
    ds_read_b128 v[144:147], v17 offset:21504
    v_mfma_f32_16x16x32_bf16 v[50:53], v[152:155], v[104:107], v[50:53]
    ds_read_b128 v[148:151], v16 offset:14336
    v_mfma_f32_16x16x32_bf16 v[54:57], v[156:159], v[104:107], v[54:57]
    ds_read_b128 v[152:155], v16 offset:19456
    v_mfma_f32_16x16x32_bf16 v[58:61], v[160:163], v[104:107], v[58:61]
    ds_read_b128 v[156:159], v16 offset:24576
    s_add_u32 s99, s23, 0x173e000
    buffer_load_dwordx4 a[132:135], v252, s[4:7], s99 offen offset:0 sc1
    s_waitcnt vmcnt(10) lgkmcnt(15)
    v_mfma_f32_16x16x32_bf16 v[42:45], v[164:167], v[108:111], v[42:45]
    ds_read_b128 v[160:163], v17 offset:4096
    v_mfma_f32_16x16x32_bf16 v[46:49], v[168:171], v[108:111], v[46:49]
    ds_read_b128 v[164:167], v17 offset:9216
    v_mfma_f32_16x16x32_bf16 v[50:53], v[172:175], v[108:111], v[50:53]
    ds_read_b128 v[168:171], v17 offset:14336
    v_mfma_f32_16x16x32_bf16 v[54:57], v[176:179], v[108:111], v[54:57]
    ds_read_b128 v[172:175], v17 offset:19456
    buffer_load_dwordx4 a[136:139], v252, s[4:7], s99 offen offset:1024 sc1
    v_mfma_f32_16x16x32_bf16 v[58:61], v[180:183], v[108:111], v[58:61]
    ds_read_b128 v[176:179], v17 offset:24576
    s_waitcnt vmcnt(10) lgkmcnt(15)
    v_mfma_f32_16x16x32_bf16 v[42:45], v[184:187], v[112:115], v[42:45]
    ds_read_b128 v[180:183], v16 offset:12288
    v_mfma_f32_16x16x32_bf16 v[46:49], v[188:191], v[112:115], v[46:49]
    ds_read_b128 v[184:187], v16 offset:13312
    s_waitcnt vmcnt(9)
    v_mfma_f32_16x16x32_bf16 v[42:45], v[192:195], v[116:119], v[42:45]
    ds_read_b128 v[188:191], v16 offset:17408
    buffer_load_dwordx4 a[140:143], v252, s[4:7], s99 offen offset:2048 sc1
    v_mfma_f32_16x16x32_bf16 v[46:49], v[196:199], v[116:119], v[46:49]
    ds_read_b128 v[192:195], v16 offset:18432
    s_waitcnt vmcnt(9)
    v_mfma_f32_16x16x32_bf16 v[42:45], v[200:203], v[120:123], v[42:45]
    ds_read_b128 v[196:199], v16 offset:22528
    s_waitcnt lgkmcnt(15)
    v_mfma_f32_16x16x32_bf16 v[46:49], v[204:207], v[120:123], v[46:49]
    ds_read_b128 v[200:203], v16 offset:23552
    s_waitcnt vmcnt(8)
    v_mfma_f32_16x16x32_bf16 v[42:45], v[208:211], v[124:127], v[42:45]
    ds_read_b128 v[204:207], v17 offset:2048
    s_add_u32 s99, s20, 0x1741000
    buffer_load_dwordx4 a[144:147], v252, s[4:7], s99 offen offset:0 sc1
    v_mfma_f32_16x16x32_bf16 v[46:49], v[212:215], v[124:127], v[46:49]
    ds_read_b128 v[208:211], v17 offset:3072
    s_waitcnt vmcnt(8)
    v_mfma_f32_16x16x32_bf16 v[42:45], v[216:219], v[128:131], v[42:45]
    ds_read_b128 v[212:215], v17 offset:7168
    v_mfma_f32_16x16x32_bf16 v[46:49], v[220:223], v[128:131], v[46:49]
    ds_read_b128 v[216:219], v17 offset:8192
    s_waitcnt vmcnt(7) lgkmcnt(15)
    v_mfma_f32_16x16x32_bf16 v[42:45], v[224:227], v[132:135], v[42:45]
    ds_read_b128 v[220:223], v17 offset:12288
    buffer_load_dwordx4 a[148:151], v252, s[4:7], s99 offen offset:1024 sc1
    v_mfma_f32_16x16x32_bf16 v[46:49], v[228:231], v[132:135], v[46:49]
    ds_read_b128 v[224:227], v17 offset:13312
    s_waitcnt vmcnt(7)
    v_mfma_f32_16x16x32_bf16 v[42:45], v[232:235], v[136:139], v[42:45]
    ds_read_b128 v[228:231], v17 offset:17408
    v_mfma_f32_16x16x32_bf16 v[46:49], v[236:239], v[136:139], v[46:49]
    ds_read_b128 v[232:235], v17 offset:18432
    s_waitcnt vmcnt(6)
    v_mfma_f32_16x16x32_bf16 v[42:45], v[240:243], v[140:143], v[42:45]
    ds_read_b128 v[236:239], v17 offset:22528
    buffer_load_dwordx4 a[152:155], v252, s[4:7], s99 offen offset:2048 sc1
    s_waitcnt lgkmcnt(15)
    v_mfma_f32_16x16x32_bf16 v[46:49], v[144:147], v[140:143], v[46:49]
    ds_read_b128 v[240:243], v17 offset:23552
    v_mfma_f32_16x16x32_bf16 v[58:61], v[148:151], v[112:115], v[58:61]
    v_mfma_f32_16x16x32_bf16 v[58:61], v[152:155], v[116:119], v[58:61]
    v_mfma_f32_16x16x32_bf16 v[58:61], v[156:159], v[120:123], v[58:61]
    s_add_u32 s99, s21, 0x1741000
    buffer_load_dwordx4 a[156:159], v252, s[4:7], s99 offen offset:0 sc1
    v_mfma_f32_16x16x32_bf16 v[58:61], v[160:163], v[124:127], v[58:61]
    v_cvt_pk_bf16_f32 v32, v42, v43
    v_cvt_pk_bf16_f32 v33, v44, v45
    v_cvt_pk_bf16_f32 v34, v46, v47
    s_waitcnt lgkmcnt(15)
    v_mfma_f32_16x16x32_bf16 v[58:61], v[164:167], v[128:131], v[58:61]
    v_cvt_pk_bf16_f32 v35, v48, v49
    s_add_u32 s28, s43, 0xc60000
    buffer_store_dwordx4 v[32:35], v4, s[4:7], s28 offen offset:0 sc1
    v_mfma_f32_16x16x32_bf16 v[58:61], v[168:171], v[132:135], v[58:61]
    v_mfma_f32_16x16x32_bf16 v[58:61], v[172:175], v[136:139], v[58:61]
    buffer_load_dwordx4 a[160:163], v252, s[4:7], s99 offen offset:1024 sc1
    v_mfma_f32_16x16x32_bf16 v[58:61], v[176:179], v[140:143], v[58:61]
    v_mfma_f32_16x16x32_bf16 v[50:53], v[180:183], v[112:115], v[50:53]
    s_waitcnt lgkmcnt(0)
    s_barrier
    v_mfma_f32_16x16x32_bf16 v[54:57], v[184:187], v[112:115], v[54:57]
    v_mfma_f32_16x16x32_bf16 v[50:53], v[188:191], v[116:119], v[50:53]
    buffer_load_dwordx4 a[164:167], v252, s[4:7], s99 offen offset:2048 sc1
    v_mfma_f32_16x16x32_bf16 v[54:57], v[192:195], v[116:119], v[54:57]
    s_nop 0
    v_cvt_pk_bf16_f32 v40, v58, v59
    v_cvt_pk_bf16_f32 v41, v60, v61
    s_add_u32 s28, s43, 0xc60000
    buffer_store_dwordx2 v[40:41], v5, s[4:7], s28 offen sc1
    v_mfma_f32_16x16x32_bf16 v[50:53], v[196:199], v[120:123], v[50:53]
    v_mfma_f32_16x16x32_bf16 v[54:57], v[200:203], v[120:123], v[54:57]
    v_mfma_f32_16x16x32_bf16 v[50:53], v[204:207], v[124:127], v[50:53]
    s_add_u32 s99, s22, 0x1741000
    buffer_load_dwordx4 a[168:171], v252, s[4:7], s99 offen offset:0 sc1
    v_mfma_f32_16x16x32_bf16 v[54:57], v[208:211], v[124:127], v[54:57]
    v_mfma_f32_16x16x32_bf16 v[50:53], v[212:215], v[128:131], v[50:53]
    v_mfma_f32_16x16x32_bf16 v[54:57], v[216:219], v[128:131], v[54:57]
    v_mfma_f32_16x16x32_bf16 v[50:53], v[220:223], v[132:135], v[50:53]
    buffer_load_dwordx4 a[172:175], v252, s[4:7], s99 offen offset:1024 sc1
    v_mfma_f32_16x16x32_bf16 v[54:57], v[224:227], v[132:135], v[54:57]
    v_mfma_f32_16x16x32_bf16 v[50:53], v[228:231], v[136:139], v[50:53]
    v_mfma_f32_16x16x32_bf16 v[54:57], v[232:235], v[136:139], v[54:57]
    v_mfma_f32_16x16x32_bf16 v[50:53], v[236:239], v[140:143], v[50:53]
    buffer_load_dwordx4 a[176:179], v252, s[4:7], s99 offen offset:2048 sc1
    v_mfma_f32_16x16x32_bf16 v[54:57], v[240:243], v[140:143], v[54:57]
    s_nop 5
    v_cvt_pk_bf16_f32 v36, v50, v51
    v_cvt_pk_bf16_f32 v37, v52, v53
    v_cvt_pk_bf16_f32 v38, v54, v55
    v_cvt_pk_bf16_f32 v39, v56, v57
    s_add_u32 s28, s43, 0xc60000
    buffer_store_dwordx4 v[36:39], v4, s[4:7], s28 offen offset:256 sc1
    v_mov_b32 v244, 0
    v_mov_b32 v245, 0
    v_dot2c_f32_bf16 v244, s61, v32
    v_dot2c_f32_bf16 v245, v32, v32
    v_dot2c_f32_bf16 v244, s61, v33
    v_dot2c_f32_bf16 v245, v33, v33
    v_dot2c_f32_bf16 v244, s61, v34
    v_dot2c_f32_bf16 v245, v34, v34
    v_dot2c_f32_bf16 v244, s61, v35
    v_dot2c_f32_bf16 v245, v35, v35
    v_dot2c_f32_bf16 v244, s61, v36
    v_dot2c_f32_bf16 v245, v36, v36
    v_dot2c_f32_bf16 v244, s61, v37
    v_dot2c_f32_bf16 v245, v37, v37
    v_dot2c_f32_bf16 v244, s61, v38
    v_dot2c_f32_bf16 v245, v38, v38
    v_dot2c_f32_bf16 v244, s61, v39
    v_dot2c_f32_bf16 v245, v39, v39
    v_dot2c_f32_bf16 v244, s61, v40
    v_dot2c_f32_bf16 v245, v40, v40
    v_dot2c_f32_bf16 v244, s61, v41
    v_dot2c_f32_bf16 v245, v41, v41
    s_nop 1
    v_mov_b32 v246, v244
    v_mov_b32 v247, v245
    s_nop 0
    v_permlane16_swap_b32 v244, v246
    v_permlane16_swap_b32 v245, v247
    v_add_f32 v244, v244, v246
    v_add_f32 v245, v245, v247
    v_mov_b32 v246, v244
    v_mov_b32 v247, v245
    s_nop 0
    v_permlane32_swap_b32 v244, v246
    v_permlane32_swap_b32 v245, v247
    v_add_f32 v244, v244, v246
    v_add_f32 v245, v245, v247
    s_add_u32 s28, s44, 0x48000
    s_mov_b64 exec, 0xffff
    buffer_store_dwordx2 v[244:245], v253, s[4:7], s28 offen sc1
    s_mov_b64 exec, -1
    s_mul_i32 s49, s26, 17408
    s_add_u32 s49, s49, 81920
    s_add_u32 s80, s48, 0
    s_and_b32 s80, s80, 3
    s_lshl_b32 s80, s80, 11
    s_add_u32 s34, s20, s80
    s_add_u32 s80, s48, 1
    s_and_b32 s80, s80, 3
    s_lshl_b32 s80, s80, 11
    s_add_u32 s35, s21, s80
    s_add_u32 s80, s48, 2
    s_and_b32 s80, s80, 3
    s_lshl_b32 s80, s80, 11
    s_add_u32 s36, s22, s80
    s_add_u32 s80, s48, 3
    s_and_b32 s80, s80, 3
    s_lshl_b32 s80, s80, 11
    s_add_u32 s37, s23, s80
    s_add_u32 s29, s39, 0x15000
    s_add_u32 s99, s23, 0x1741000
    buffer_load_dwordx4 a[180:183], v252, s[4:7], s99 offen offset:0 sc1
    buffer_load_dwordx4 a[184:187], v252, s[4:7], s99 offen offset:1024 sc1
    buffer_load_dwordx4 a[188:191], v252, s[4:7], s99 offen offset:2048 sc1
    s_add_u32 s99, s20, 0x1744000
    buffer_load_dwordx4 a[192:195], v252, s[4:7], s99 offen offset:0 sc1
    buffer_load_dwordx4 a[196:199], v252, s[4:7], s99 offen offset:1024 sc1
    buffer_load_dwordx4 a[200:203], v252, s[4:7], s99 offen offset:2048 sc1
    s_add_u32 s99, s21, 0x1744000
    buffer_load_dwordx4 a[204:207], v252, s[4:7], s99 offen offset:0 sc1
    buffer_load_dwordx4 a[208:211], v252, s[4:7], s99 offen offset:1024 sc1
    buffer_load_dwordx4 a[212:215], v252, s[4:7], s99 offen offset:2048 sc1
    s_add_u32 s99, s22, 0x1744000
    buffer_load_dwordx4 a[216:219], v252, s[4:7], s99 offen offset:0 sc1
    buffer_load_dwordx4 a[220:223], v252, s[4:7], s99 offen offset:1024 sc1
    s_waitcnt vmcnt(11)
    s_barrier
    s_cmp_lg_u32 s26, 0
    s_cbranch_scc1 L_sig_29
    s_mov_b64 exec, 1
    buffer_store_dword v254, off, s[4:7], s29 sc1
    s_mov_b64 exec, -1
L_sig_29:
    v_mov_b32 v248, s61
    v_mov_b32 v249, s61
    v_mov_b32 v250, s61
    v_mov_b32 v251, s61
    buffer_load_dwordx4 a[224:227], v252, s[4:7], s99 offen offset:2048 sc1
    s_nop 0
    v_mfma_f32_16x16x32_bf16 v[160:163], v[248:251], a[0:3], 0
    v_mfma_f32_16x16x32_bf16 v[164:167], v[248:251], a[4:7], 0
    v_mfma_f32_16x16x32_bf16 v[168:171], v[248:251], a[8:11], 0
    s_add_u32 s99, s23, 0x1744000
    buffer_load_dwordx4 a[228:231], v252, s[4:7], s99 offen offset:0 sc1
    v_mfma_f32_16x16x32_bf16 v[160:163], v[248:251], a[12:15], v[160:163]
    v_mfma_f32_16x16x32_bf16 v[164:167], v[248:251], a[16:19], v[164:167]
    v_mfma_f32_16x16x32_bf16 v[168:171], v[248:251], a[20:23], v[168:171]
    buffer_load_dwordx4 a[232:235], v252, s[4:7], s99 offen offset:1024 sc1
    v_mfma_f32_16x16x32_bf16 v[160:163], v[248:251], a[24:27], v[160:163]
    v_mfma_f32_16x16x32_bf16 v[164:167], v[248:251], a[28:31], v[164:167]
    v_mfma_f32_16x16x32_bf16 v[168:171], v[248:251], a[32:35], v[168:171]
    v_mfma_f32_16x16x32_bf16 v[160:163], v[248:251], a[36:39], v[160:163]
    v_mfma_f32_16x16x32_bf16 v[164:167], v[248:251], a[40:43], v[164:167]
    v_mfma_f32_16x16x32_bf16 v[168:171], v[248:251], a[44:47], v[168:171]
    buffer_load_dwordx4 a[236:239], v252, s[4:7], s99 offen offset:2048 sc1
    v_mfma_f32_16x16x32_bf16 v[160:163], v[248:251], a[48:51], v[160:163]
    v_mfma_f32_16x16x32_bf16 v[164:167], v[248:251], a[52:55], v[164:167]
    v_mfma_f32_16x16x32_bf16 v[168:171], v[248:251], a[56:59], v[168:171]
    s_add_u32 s99, s34, 0x1918000
    buffer_load_dwordx4 v[96:99], v252, s[4:7], s99 offen offset:0 sc1
    v_mfma_f32_16x16x32_bf16 v[160:163], v[248:251], a[60:63], v[160:163]
    v_mfma_f32_16x16x32_bf16 v[164:167], v[248:251], a[64:67], v[164:167]
    v_mfma_f32_16x16x32_bf16 v[168:171], v[248:251], a[68:71], v[168:171]
    buffer_load_dwordx4 v[100:103], v252, s[4:7], s99 offen offset:1024 sc1
    v_mfma_f32_16x16x32_bf16 v[160:163], v[248:251], a[72:75], v[160:163]
    v_mfma_f32_16x16x32_bf16 v[164:167], v[248:251], a[76:79], v[164:167]
    v_mfma_f32_16x16x32_bf16 v[168:171], v[248:251], a[80:83], v[168:171]
    v_mfma_f32_16x16x32_bf16 v[160:163], v[248:251], a[84:87], v[160:163]
    v_mfma_f32_16x16x32_bf16 v[164:167], v[248:251], a[88:91], v[164:167]
    v_mfma_f32_16x16x32_bf16 v[168:171], v[248:251], a[92:95], v[168:171]
    buffer_load_dwordx4 v[104:107], v252, s[4:7], s99 offen offset:2048 sc1
    v_mfma_f32_16x16x32_bf16 v[160:163], v[248:251], a[96:99], v[160:163]
    v_mfma_f32_16x16x32_bf16 v[164:167], v[248:251], a[100:103], v[164:167]
    v_mfma_f32_16x16x32_bf16 v[168:171], v[248:251], a[104:107], v[168:171]
    buffer_load_dwordx4 v[108:111], v252, s[4:7], s99 offen offset:3072 sc1
    v_mfma_f32_16x16x32_bf16 v[160:163], v[248:251], a[108:111], v[160:163]
    v_mfma_f32_16x16x32_bf16 v[164:167], v[248:251], a[112:115], v[164:167]
    v_mfma_f32_16x16x32_bf16 v[168:171], v[248:251], a[116:119], v[168:171]
    s_add_u32 s99, s34, 0x1919000
    buffer_load_dwordx4 v[112:115], v252, s[4:7], s99 offen offset:0 sc1
    v_mfma_f32_16x16x32_bf16 v[160:163], v[248:251], a[120:123], v[160:163]
    v_mfma_f32_16x16x32_bf16 v[164:167], v[248:251], a[124:127], v[164:167]
    v_mfma_f32_16x16x32_bf16 v[168:171], v[248:251], a[128:131], v[168:171]
    v_mfma_f32_16x16x32_bf16 v[160:163], v[248:251], a[132:135], v[160:163]
    v_mfma_f32_16x16x32_bf16 v[164:167], v[248:251], a[136:139], v[164:167]
    v_mfma_f32_16x16x32_bf16 v[168:171], v[248:251], a[140:143], v[168:171]
    s_add_u32 s99, s35, 0x1918000
    buffer_load_dwordx4 v[116:119], v252, s[4:7], s99 offen offset:0 sc1
    v_mfma_f32_16x16x32_bf16 v[160:163], v[248:251], a[144:147], v[160:163]
    v_mfma_f32_16x16x32_bf16 v[164:167], v[248:251], a[148:151], v[164:167]
    v_mfma_f32_16x16x32_bf16 v[168:171], v[248:251], a[152:155], v[168:171]
    buffer_load_dwordx4 v[120:123], v252, s[4:7], s99 offen offset:1024 sc1
    v_mfma_f32_16x16x32_bf16 v[160:163], v[248:251], a[156:159], v[160:163]
    v_mfma_f32_16x16x32_bf16 v[164:167], v[248:251], a[160:163], v[164:167]
    v_mfma_f32_16x16x32_bf16 v[168:171], v[248:251], a[164:167], v[168:171]
    buffer_load_dwordx4 v[124:127], v252, s[4:7], s99 offen offset:2048 sc1
    s_add_u32 s97, s38, 0x15000
    s_buffer_load_dwordx2 s[64:65], s[4:7], s97 glc
    v_mfma_f32_16x16x32_bf16 v[160:163], v[248:251], a[168:171], v[160:163]
    v_mfma_f32_16x16x32_bf16 v[164:167], v[248:251], a[172:175], v[164:167]
    v_mfma_f32_16x16x32_bf16 v[168:171], v[248:251], a[176:179], v[168:171]
    s_waitcnt vmcnt(20)
    v_mfma_f32_16x16x32_bf16 v[160:163], v[248:251], a[180:183], v[160:163]
    v_mfma_f32_16x16x32_bf16 v[164:167], v[248:251], a[184:187], v[164:167]
    v_mfma_f32_16x16x32_bf16 v[168:171], v[248:251], a[188:191], v[168:171]
    buffer_load_dwordx4 v[128:131], v252, s[4:7], s99 offen offset:3072 sc1
    s_waitcnt vmcnt(18)
    v_mfma_f32_16x16x32_bf16 v[160:163], v[248:251], a[192:195], v[160:163]
    v_mfma_f32_16x16x32_bf16 v[164:167], v[248:251], a[196:199], v[164:167]
    v_mfma_f32_16x16x32_bf16 v[168:171], v[248:251], a[200:203], v[168:171]
    s_add_u32 s99, s35, 0x1919000
    buffer_load_dwordx4 v[132:135], v252, s[4:7], s99 offen offset:0 sc1
    s_waitcnt vmcnt(16)
    v_mfma_f32_16x16x32_bf16 v[160:163], v[248:251], a[204:207], v[160:163]
    v_mfma_f32_16x16x32_bf16 v[164:167], v[248:251], a[208:211], v[164:167]
    v_mfma_f32_16x16x32_bf16 v[168:171], v[248:251], a[212:215], v[168:171]
    s_waitcnt vmcnt(13)
    v_mfma_f32_16x16x32_bf16 v[160:163], v[248:251], a[216:219], v[160:163]
    v_mfma_f32_16x16x32_bf16 v[164:167], v[248:251], a[220:223], v[164:167]
    v_mfma_f32_16x16x32_bf16 v[168:171], v[248:251], a[224:227], v[168:171]
    s_waitcnt vmcnt(10)
    v_mfma_f32_16x16x32_bf16 v[160:163], v[248:251], a[228:231], v[160:163]
    v_mfma_f32_16x16x32_bf16 v[164:167], v[248:251], a[232:235], v[164:167]
    v_mfma_f32_16x16x32_bf16 v[168:171], v[248:251], a[236:239], v[168:171]
    s_mul_i32 s27, s25, 6144
    s_mul_i32 s28, s26, 1536
    s_add_u32 s27, s27, s28
    v_and_b32 v246, 15, v1
    v_lshl_add_u32 v244, v246, 4, s27
    v_lshrrev_b32 v245, 5, v1
    v_mul_u32_u24 v245, 768, v245
    v_add_u32 v244, v244, v245
    v_bfe_u32 v245, v1, 4, 1
    v_lshl_add_u32 v6, v245, 9, v244
    v_lshl_add_u32 v7, v245, 3, v244
    v_add_u32 v7, 256, v7
    v_lshlrev_b32 v246, 3, v246
    v_add_u32 v9, 158720, v246
    s_lshl_b32 s27, s26, 7
    v_add_u32 v8, s27, v9
    v_add_u32 v21, 40960, v252
    s_mul_i32 s30, s24, 81920
    s_lshl_b32 s31, s26, 10
    s_add_u32 s30, s30, s31
    s_sub_u32 s62, s26, s48
    s_and_b32 s62, s62, 3
    s_lshl_b32 s62, s62, 10
    s_mul_i32 s31, s24, 196608
    s_add_u32 s31, s31, 0xee0000
    v_cvt_pk_bf16_f32 v42, v160, v160
    v_lshlrev_b32 v244, 16, v42
    v_sub_f32 v244, v160, v244
    v_cvt_pk_bf16_f32 v42, v160, v244
    v_mov_b32 v43, 0
    v_mov_b32 v44, 0
    v_mov_b32 v45, 0
    v_cvt_pk_bf16_f32 v46, v164, v164
    v_lshlrev_b32 v245, 16, v46
    v_sub_f32 v245, v164, v245
    v_cvt_pk_bf16_f32 v46, v164, v245
    v_mov_b32 v47, 0
    v_mov_b32 v48, 0
    v_mov_b32 v49, 0
    v_cvt_pk_bf16_f32 v50, v168, v168
    v_lshlrev_b32 v246, 16, v50
    v_sub_f32 v246, v168, v246
    v_cvt_pk_bf16_f32 v50, v168, v246
    v_mov_b32 v51, 0
    v_mov_b32 v52, 0
    v_mov_b32 v53, 0
    v_mov_b32 v209, 0
    v_mov_b32 v211, 0
    v_mov_b32 v213, 0
    v_mov_b32 v215, 0
    v_mov_b32 v216, 0
    v_mov_b32 v217, 0
    s_mul_i32 s80, s24, 196608
    s_mul_i32 s81, s26, 12288
    s_add_u32 s81, s81, s80
    s_add_u32 s81, s81, 0xee0000
    s_add_u32 s80, s48, 0
    s_and_b32 s80, s80, 3
    s_lshl_b32 s80, s80, 10
    s_add_u32 s20, s80, s81
    s_add_u32 s80, s48, 1
    s_and_b32 s80, s80, 3
    s_lshl_b32 s80, s80, 10
    s_add_u32 s21, s80, s81
    s_add_u32 s80, s48, 2
    s_and_b32 s80, s80, 3
    s_lshl_b32 s80, s80, 10
    s_add_u32 s22, s80, s81
    s_add_u32 s80, s48, 3
    s_and_b32 s80, s80, 3
    s_lshl_b32 s80, s80, 10
    s_add_u32 s23, s80, s81
    s_mul_i32 s80, s26, 5120
    v_add_u32 v14, s80, v252
    v_add_u32 v15, 40960, v14
    s_mul_i32 s80, s26, 20480
    v_add_u32 v16, s80, v252
    v_add_u32 v17, s49, v252
    s_mov_b32 s60, 0
    s_branch L_pc_32
L_poll_31:
    s_buffer_load_dwordx2 s[64:65], s[4:7], s97 glc
    s_add_u32 s60, s60, 1
    s_cmp_gt_u32 s60, 400000
    s_cbranch_scc1 L_end
L_pc_32:
    s_waitcnt lgkmcnt(0)
    s_xor_b64 s[64:65], s[64:65], s[56:57]
    s_cbranch_scc1 L_poll_31
L_p1_30:
    s_barrier
    s_mov_b64 s[82:83], 0xffff
    s_add_u32 m0, s62, 0
    s_add_u32 s27, s30, 0xc60000
    buffer_load_dwordx4 v252, s[4:7], s27 offen sc1 lds
    s_add_u32 m0, s62, 4096
    s_add_u32 s27, s30, 0xc61000
    buffer_load_dwordx4 v252, s[4:7], s27 offen sc1 lds
    s_add_u32 m0, s62, 8192
    s_add_u32 s27, s30, 0xc62000
    buffer_load_dwordx4 v252, s[4:7], s27 offen sc1 lds
    s_add_u32 m0, s62, 12288
    s_add_u32 s27, s30, 0xc63000
    buffer_load_dwordx4 v252, s[4:7], s27 offen sc1 lds
    s_add_u32 m0, s62, 16384
    s_add_u32 s27, s30, 0xc64000
    buffer_load_dwordx4 v252, s[4:7], s27 offen sc1 lds
    s_add_u32 s28, s45, 0x48000
    buffer_load_dwordx2 v[244:245], v18, s[4:7], s28 offen sc1
    buffer_load_dwordx2 v[246:247], v18, s[4:7], s28 offen offset:512 sc1
    s_add_u32 m0, s62, 20480
    s_add_u32 s27, s30, 0xc65000
    buffer_load_dwordx4 v252, s[4:7], s27 offen sc1 lds
    s_add_u32 m0, s62, 24576
    s_add_u32 s27, s30, 0xc66000
    buffer_load_dwordx4 v252, s[4:7], s27 offen sc1 lds
    s_add_u32 m0, s62, 28672
    s_add_u32 s27, s30, 0xc67000
    buffer_load_dwordx4 v252, s[4:7], s27 offen sc1 lds
    s_add_u32 m0, s62, 32768
    s_add_u32 s27, s30, 0xc68000
    buffer_load_dwordx4 v252, s[4:7], s27 offen sc1 lds
    s_add_u32 m0, s62, 36864
    s_add_u32 s27, s30, 0xc69000
    buffer_load_dwordx4 v252, s[4:7], s27 offen sc1 lds
    s_waitcnt vmcnt(7)
    s_barrier
    ds_read_b128 v[64:67], v252 offset:0
    ds_read_b128 v[68:71], v252 offset:1024
    ds_read_b128 v[72:75], v252 offset:2048
    ds_read_b128 v[76:79], v252 offset:3072
    ds_read_b128 v[80:83], v252 offset:4096
    s_waitcnt lgkmcnt(3)
    v_mfma_f32_16x16x32_bf16 v[160:163], a[0:3], v[64:67], 0
    ds_read_b128 v[84:87], v252 offset:5120
    s_waitcnt vmcnt(5)
    v_add_f32 v244, v244, v246
    v_mfma_f32_16x16x32_bf16 v[164:167], a[4:7], v[64:67], 0
    s_add_u32 m0, s62, 40960
    s_add_u32 s27, s30, 0xc6a000
    buffer_load_dwordx4 v252, s[4:7], s27 offen sc1 lds
    v_mfma_f32_16x16x32_bf16 v[168:171], a[8:11], v[64:67], 0
    v_add_f32 v245, v245, v247
    v_mov_b32 v246, v244
    v_mfma_f32_16x16x32_bf16 v[160:163], a[12:15], v[68:71], v[160:163]
    ds_read_b128 v[88:91], v252 offset:6144
    v_mov_b32 v247, v245
    v_permlane16_swap_b32 v244, v246
    v_mfma_f32_16x16x32_bf16 v[164:167], a[16:19], v[68:71], v[164:167]
    v_permlane16_swap_b32 v245, v247
    v_add_f32 v244, v244, v246
    v_mfma_f32_16x16x32_bf16 v[168:171], a[20:23], v[68:71], v[168:171]
    s_add_u32 m0, s62, 45056
    s_add_u32 s27, s30, 0xc6b000
    buffer_load_dwordx4 v252, s[4:7], s27 offen sc1 lds
    s_waitcnt lgkmcnt(3)
    v_mfma_f32_16x16x32_bf16 v[160:163], a[24:27], v[72:75], v[160:163]
    ds_read_b128 v[92:95], v252 offset:7168
    v_add_f32 v245, v245, v247
    v_mov_b32 v246, v244
    v_mfma_f32_16x16x32_bf16 v[164:167], a[28:31], v[72:75], v[164:167]
    v_mov_b32 v247, v245
    v_permlane32_swap_b32 v244, v246
    v_mfma_f32_16x16x32_bf16 v[168:171], a[32:35], v[72:75], v[168:171]
    v_permlane32_swap_b32 v245, v247
    v_add_f32 v244, v244, v246
    v_mfma_f32_16x16x32_bf16 v[160:163], a[36:39], v[76:79], v[160:163]
    ds_read_b128 v[64:67], v252 offset:8192
    s_add_u32 m0, s62, 49152
    s_add_u32 s27, s30, 0xc6c000
    buffer_load_dwordx4 v252, s[4:7], s27 offen sc1 lds
    v_mfma_f32_16x16x32_bf16 v[164:167], a[40:43], v[76:79], v[164:167]
    v_add_f32 v245, v245, v247
    v_mul_f32 v248, -0.0015625, v244
    v_mfma_f32_16x16x32_bf16 v[168:171], a[44:47], v[76:79], v[168:171]
    v_mul_f32 v245, 0.0015625, v245
    v_fma_f32 v249, -v248, v248, v245
    s_waitcnt lgkmcnt(3)
    v_mfma_f32_16x16x32_bf16 v[160:163], a[48:51], v[80:83], v[160:163]
    ds_read_b128 v[68:71], v252 offset:9216
    v_max_f32 v249, 0, v249
    v_add_f32 v249, 0x3727c5ac, v249
    v_mfma_f32_16x16x32_bf16 v[164:167], a[52:55], v[80:83], v[164:167]
    s_add_u32 m0, s62, 53248
    s_add_u32 s27, s30, 0xc6d000
    buffer_load_dwordx4 v252, s[4:7], s27 offen sc1 lds
    v_mfma_f32_16x16x32_bf16 v[168:171], a[56:59], v[80:83], v[168:171]
    v_rsq_f32 v249, v249
    v_mfma_f32_16x16x32_bf16 v[160:163], a[60:63], v[84:87], v[160:163]
    ds_read_b128 v[72:75], v252 offset:10240
    s_nop 0
    ds_write_b64 v8, v[248:249]
    v_mfma_f32_16x16x32_bf16 v[164:167], a[64:67], v[84:87], v[164:167]
    v_mfma_f32_16x16x32_bf16 v[168:171], a[68:71], v[84:87], v[168:171]
    s_add_u32 m0, s62, 57344
    s_add_u32 s27, s30, 0xc6e000
    buffer_load_dwordx4 v252, s[4:7], s27 offen sc1 lds
    s_waitcnt lgkmcnt(4)
    v_mfma_f32_16x16x32_bf16 v[160:163], a[72:75], v[88:91], v[160:163]
    ds_read_b128 v[76:79], v252 offset:11264
    v_mfma_f32_16x16x32_bf16 v[164:167], a[76:79], v[88:91], v[164:167]
    v_mfma_f32_16x16x32_bf16 v[168:171], a[80:83], v[88:91], v[168:171]
    v_mfma_f32_16x16x32_bf16 v[160:163], a[84:87], v[92:95], v[160:163]
    ds_read_b128 v[80:83], v252 offset:12288
    s_add_u32 m0, s62, 61440
    s_add_u32 s27, s30, 0xc6f000
    buffer_load_dwordx4 v252, s[4:7], s27 offen sc1 lds
    v_mfma_f32_16x16x32_bf16 v[164:167], a[88:91], v[92:95], v[164:167]
    v_mfma_f32_16x16x32_bf16 v[168:171], a[92:95], v[92:95], v[168:171]
    s_waitcnt lgkmcnt(4)
    v_mfma_f32_16x16x32_bf16 v[160:163], a[96:99], v[64:67], v[160:163]
    ds_read_b128 v[84:87], v252 offset:13312
    v_mfma_f32_16x16x32_bf16 v[164:167], a[100:103], v[64:67], v[164:167]
    s_add_u32 m0, s62, 65536
    s_add_u32 s27, s30, 0xc70000
    buffer_load_dwordx4 v252, s[4:7], s27 offen sc1 lds
    v_mfma_f32_16x16x32_bf16 v[168:171], a[104:107], v[64:67], v[168:171]
    v_mfma_f32_16x16x32_bf16 v[160:163], a[108:111], v[68:71], v[160:163]
    ds_read_b128 v[88:91], v252 offset:14336
    v_mfma_f32_16x16x32_bf16 v[164:167], a[112:115], v[68:71], v[164:167]
    v_mfma_f32_16x16x32_bf16 v[168:171], a[116:119], v[68:71], v[168:171]
    s_add_u32 m0, s62, 69632
    s_add_u32 s27, s30, 0xc71000
    buffer_load_dwordx4 v252, s[4:7], s27 offen sc1 lds
    s_waitcnt lgkmcnt(3)
    v_mfma_f32_16x16x32_bf16 v[160:163], a[120:123], v[72:75], v[160:163]
    ds_read_b128 v[92:95], v252 offset:15360
    v_mfma_f32_16x16x32_bf16 v[164:167], a[124:127], v[72:75], v[164:167]
    v_mfma_f32_16x16x32_bf16 v[168:171], a[128:131], v[72:75], v[168:171]
    v_mfma_f32_16x16x32_bf16 v[160:163], a[132:135], v[76:79], v[160:163]
    ds_read_b128 v[64:67], v252 offset:16384
    s_add_u32 m0, s62, 73728
    s_add_u32 s27, s30, 0xc72000
    buffer_load_dwordx4 v252, s[4:7], s27 offen sc1 lds
    v_mfma_f32_16x16x32_bf16 v[164:167], a[136:139], v[76:79], v[164:167]
    v_mfma_f32_16x16x32_bf16 v[168:171], a[140:143], v[76:79], v[168:171]
    s_waitcnt vmcnt(9)
    s_barrier
    ds_read_b64 v[196:197], v9 offset:0
    ds_read_b64 v[198:199], v9 offset:128
    ds_read_b64 v[200:201], v9 offset:256
    ds_read_b64 v[202:203], v9 offset:384
    s_waitcnt lgkmcnt(7)
    v_mfma_f32_16x16x32_bf16 v[160:163], a[144:147], v[80:83], v[160:163]
    ds_read_b128 v[68:71], v252 offset:17408
    s_waitcnt lgkmcnt(1)
    v_cvt_pk_bf16_f32 v208, v196, v196
    v_mfma_f32_16x16x32_bf16 v[164:167], a[148:151], v[80:83], v[164:167]
    s_add_u32 m0, s62, 77824
    s_add_u32 s27, s30, 0xc73000
    buffer_load_dwordx4 v252, s[4:7], s27 offen sc1 lds
    v_mfma_f32_16x16x32_bf16 v[168:171], a[152:155], v[80:83], v[168:171]
    v_lshlrev_b32 v244, 16, v208
    v_sub_f32 v244, v196, v244
    v_mfma_f32_16x16x32_bf16 v[160:163], a[156:159], v[84:87], v[160:163]
    ds_read_b128 v[72:75], v252 offset:18432
    v_cvt_pk_bf16_f32 v244, v244, v244
    v_cndmask_b32 v208, v244, v208, s[82:83]
    v_mfma_f32_16x16x32_bf16 v[164:167], a[160:163], v[84:87], v[164:167]
    v_cndmask_b32 v208, v208, 0, s[58:59]
    v_cvt_pk_bf16_f32 v210, v198, v198
    v_mfma_f32_16x16x32_bf16 v[168:171], a[164:167], v[84:87], v[168:171]
    s_add_u32 s99, s36, 0x1918000
    buffer_load_dwordx4 v[136:139], v252, s[4:7], s99 offen offset:0 sc1
    v_mfma_f32_16x16x32_bf16 v[160:163], a[168:171], v[88:91], v[160:163]
    ds_read_b128 v[76:79], v252 offset:19456
    v_lshlrev_b32 v245, 16, v210
    v_sub_f32 v245, v198, v245
    v_mfma_f32_16x16x32_bf16 v[164:167], a[172:175], v[88:91], v[164:167]
    v_cvt_pk_bf16_f32 v245, v245, v245
    v_cndmask_b32 v210, v245, v210, s[82:83]
    v_mfma_f32_16x16x32_bf16 v[168:171], a[176:179], v[88:91], v[168:171]
    v_cndmask_b32 v210, v210, 0, s[58:59]
    v_cvt_pk_bf16_f32 v212, v200, v200
    v_mfma_f32_16x16x32_bf16 v[160:163], a[180:183], v[92:95], v[160:163]
    ds_read_b128 v[80:83], v252 offset:20480
    buffer_load_dwordx4 v[140:143], v252, s[4:7], s99 offen offset:1024 sc1
    v_mfma_f32_16x16x32_bf16 v[164:167], a[184:187], v[92:95], v[164:167]
    v_lshlrev_b32 v246, 16, v212
    v_sub_f32 v246, v200, v246
    v_mfma_f32_16x16x32_bf16 v[168:171], a[188:191], v[92:95], v[168:171]
    v_cvt_pk_bf16_f32 v246, v246, v246
    v_cndmask_b32 v212, v246, v212, s[82:83]
    s_waitcnt lgkmcnt(3)
    v_mfma_f32_16x16x32_bf16 v[160:163], a[192:195], v[64:67], v[160:163]
    ds_read_b128 v[84:87], v252 offset:21504
    v_cndmask_b32 v212, v212, 0, s[58:59]
    v_cvt_pk_bf16_f32 v214, v202, v202
    v_mfma_f32_16x16x32_bf16 v[164:167], a[196:199], v[64:67], v[164:167]
    buffer_load_dwordx4 v[144:147], v252, s[4:7], s99 offen offset:2048 sc1
    v_mfma_f32_16x16x32_bf16 v[168:171], a[200:203], v[64:67], v[168:171]
    v_lshlrev_b32 v247, 16, v214
    v_sub_f32 v247, v202, v247
    v_mfma_f32_16x16x32_bf16 v[160:163], a[204:207], v[68:71], v[160:163]
    ds_read_b128 v[88:91], v252 offset:22528
    v_cvt_pk_bf16_f32 v247, v247, v247
    v_cndmask_b32 v214, v247, v214, s[82:83]
    v_mfma_f32_16x16x32_bf16 v[164:167], a[208:211], v[68:71], v[164:167]
    v_cndmask_b32 v214, v214, 0, s[58:59]
    v_mul_f32 v57, v197, v197
    v_mfma_f32_16x16x32_bf16 v[168:171], a[212:215], v[68:71], v[168:171]
    buffer_load_dwordx4 v[148:151], v252, s[4:7], s99 offen offset:3072 sc1
    s_waitcnt lgkmcnt(3)
    v_mfma_f32_16x16x32_bf16 v[160:163], a[216:219], v[72:75], v[160:163]
    ds_read_b128 v[92:95], v252 offset:23552
    v_rcp_f32 v56, v197
    v_mfma_f32_16x16x32_bf16 v[164:167], a[220:223], v[72:75], v[164:167]
    v_mul_f32 v55, -2.302208198, v197
    v_mul_f32 v57, v57, v197
    v_mfma_f32_16x16x32_bf16 v[168:171], a[224:227], v[72:75], v[168:171]
    v_mul_f32 v54, -0.10294323957357, v57
    v_mul_f32 v61, v199, v199
    v_mfma_f32_16x16x32_bf16 v[160:163], a[228:231], v[76:79], v[160:163]
    ds_read_b128 v[64:67], v252 offset:24576
    s_add_u32 s99, s36, 0x1919000
    buffer_load_dwordx4 v[152:155], v252, s[4:7], s99 offen offset:0 sc1
    v_mfma_f32_16x16x32_bf16 v[164:167], a[232:235], v[76:79], v[164:167]
    v_rcp_f32 v60, v199
    v_mfma_f32_16x16x32_bf16 v[168:171], a[236:239], v[76:79], v[168:171]
    v_mul_f32 v59, -2.302208198, v199
    v_mul_f32 v61, v61, v199
    v_mul_f32 v58, -0.10294323957357, v61
    v_mul_f32 v221, v201, v201
    v_rcp_f32 v220, v201
    v_mul_f32 v219, -2.302208198, v201
    v_mul_f32 v221, v221, v201
    v_mul_f32 v218, -0.10294323957357, v221
    v_mul_f32 v225, v203, v203
    v_rcp_f32 v224, v203
    v_mul_f32 v223, -2.302208198, v203
    v_mul_f32 v225, v225, v203
    v_mul_f32 v222, -0.10294323957357, v225
    v_mfma_f32_16x16x32_bf16 v[160:163], v[42:45], v[208:211], v[160:163]
    v_mfma_f32_16x16x32_bf16 v[164:167], v[46:49], v[208:211], v[164:167]
    v_mfma_f32_16x16x32_bf16 v[168:171], v[50:53], v[208:211], v[168:171]
    s_waitcnt lgkmcnt(3)
    v_mfma_f32_16x16x32_bf16 v[172:175], a[0:3], v[80:83], 0
    ds_read_b128 v[68:71], v252 offset:25600
    v_mfma_f32_16x16x32_bf16 v[176:179], a[4:7], v[80:83], 0
    s_add_u32 s99, s37, 0x1918000
    buffer_load_dwordx4 v[156:159], v252, s[4:7], s99 offen offset:0 sc1
    v_mfma_f32_16x16x32_bf16 v[180:183], a[8:11], v[80:83], 0
    v_mfma_f32_16x16x32_bf16 v[172:175], a[12:15], v[84:87], v[172:175]
    ds_read_b128 v[72:75], v252 offset:26624
    v_mfma_f32_16x16x32_bf16 v[176:179], a[16:19], v[84:87], v[176:179]
    v_mfma_f32_16x16x32_bf16 v[180:183], a[20:23], v[84:87], v[180:183]
    s_waitcnt lgkmcnt(3)
    v_mfma_f32_16x16x32_bf16 v[172:175], a[24:27], v[88:91], v[172:175]
    ds_read_b128 v[76:79], v252 offset:27648
    v_mul_f32 v232, v160, v160
    v_mul_f32 v233, v161, v161
    v_mfma_f32_16x16x32_bf16 v[176:179], a[28:31], v[88:91], v[176:179]
    buffer_load_dwordx4 a[240:243], v252, s[4:7], s99 offen offset:1024 sc1
    v_mfma_f32_16x16x32_bf16 v[180:183], a[32:35], v[88:91], v[180:183]
    v_mul_f32 v234, v162, v162
    v_mul_f32 v235, v163, v163
    v_mfma_f32_16x16x32_bf16 v[172:175], a[36:39], v[92:95], v[172:175]
    ds_read_b128 v[80:83], v252 offset:28672
    v_mul_f32 v236, v164, v164
    v_mul_f32 v237, v165, v165
    v_mfma_f32_16x16x32_bf16 v[176:179], a[40:43], v[92:95], v[176:179]
    v_mul_f32 v238, v166, v166
    v_mul_f32 v239, v167, v167
    v_mfma_f32_16x16x32_bf16 v[180:183], a[44:47], v[92:95], v[180:183]
    v_mul_f32 v240, v168, v168
    v_mul_f32 v241, v169, v169
    s_waitcnt lgkmcnt(3)
    v_mfma_f32_16x16x32_bf16 v[172:175], a[48:51], v[64:67], v[172:175]
    ds_read_b128 v[84:87], v252 offset:29696
    v_mul_f32 v242, v170, v170
    v_mul_f32 v243, v171, v171
    v_mfma_f32_16x16x32_bf16 v[176:179], a[52:55], v[64:67], v[176:179]
    buffer_load_dwordx4 a[244:247], v252, s[4:7], s99 offen offset:2048 sc1
    v_mfma_f32_16x16x32_bf16 v[180:183], a[56:59], v[64:67], v[180:183]
    v_fma_f32 v232, v232, v54, v55
    v_fma_f32 v233, v233, v54, v55
    v_mfma_f32_16x16x32_bf16 v[172:175], a[60:63], v[68:71], v[172:175]
    ds_read_b128 v[88:91], v252 offset:30720
    v_fma_f32 v234, v234, v54, v55
    v_fma_f32 v235, v235, v54, v55
    v_mfma_f32_16x16x32_bf16 v[176:179], a[64:67], v[68:71], v[176:179]
    v_fma_f32 v236, v236, v54, v55
    v_fma_f32 v237, v237, v54, v55
    v_mfma_f32_16x16x32_bf16 v[180:183], a[68:71], v[68:71], v[180:183]
    v_fma_f32 v238, v238, v54, v55
    v_fma_f32 v239, v239, v54, v55
    s_waitcnt lgkmcnt(3)
    v_mfma_f32_16x16x32_bf16 v[172:175], a[72:75], v[72:75], v[172:175]
    ds_read_b128 v[92:95], v252 offset:31744
    v_fma_f32 v240, v240, v54, v55
    v_fma_f32 v241, v241, v54, v55
    v_mfma_f32_16x16x32_bf16 v[176:179], a[76:79], v[72:75], v[176:179]
    buffer_load_dwordx4 a[248:251], v252, s[4:7], s99 offen offset:3072 sc1
    v_mfma_f32_16x16x32_bf16 v[180:183], a[80:83], v[72:75], v[180:183]
    v_fma_f32 v242, v242, v54, v55
    v_fma_f32 v243, v243, v54, v55
    v_mfma_f32_16x16x32_bf16 v[172:175], a[84:87], v[76:79], v[172:175]
    ds_read_b128 v[64:67], v252 offset:32768
    v_mul_f32 v232, v232, v160
    v_mul_f32 v233, v233, v161
    v_mfma_f32_16x16x32_bf16 v[176:179], a[88:91], v[76:79], v[176:179]
    v_mul_f32 v234, v234, v162
    v_mul_f32 v235, v235, v163
    v_mfma_f32_16x16x32_bf16 v[180:183], a[92:95], v[76:79], v[180:183]
    v_mul_f32 v236, v236, v164
    v_mul_f32 v237, v237, v165
    s_waitcnt lgkmcnt(3)
    v_mfma_f32_16x16x32_bf16 v[172:175], a[96:99], v[80:83], v[172:175]
    ds_read_b128 v[68:71], v252 offset:33792
    v_mul_f32 v238, v238, v166
    v_mul_f32 v239, v239, v167
    v_mfma_f32_16x16x32_bf16 v[176:179], a[100:103], v[80:83], v[176:179]
    s_add_u32 s99, s37, 0x1919000
    buffer_load_dwordx4 a[252:255], v252, s[4:7], s99 offen offset:0 sc1
    v_mfma_f32_16x16x32_bf16 v[180:183], a[104:107], v[80:83], v[180:183]
    v_mul_f32 v240, v240, v168
    v_mul_f32 v241, v241, v169
    v_mfma_f32_16x16x32_bf16 v[172:175], a[108:111], v[84:87], v[172:175]
    ds_read_b128 v[72:75], v252 offset:34816
    v_mul_f32 v242, v242, v170
    v_mul_f32 v243, v243, v171
    v_mfma_f32_16x16x32_bf16 v[176:179], a[112:115], v[84:87], v[176:179]
    v_exp_f32 v232, v232
    v_mfma_f32_16x16x32_bf16 v[180:183], a[116:119], v[84:87], v[180:183]
    v_exp_f32 v233, v233
    s_waitcnt vmcnt(10)
    s_barrier
    s_waitcnt lgkmcnt(3)
    v_mfma_f32_16x16x32_bf16 v[172:175], a[120:123], v[88:91], v[172:175]
    ds_read_b128 v[76:79], v252 offset:35840
    v_exp_f32 v234, v234
    v_mfma_f32_16x16x32_bf16 v[176:179], a[124:127], v[88:91], v[176:179]
    s_add_u32 m0, s49, 0
    s_add_u32 s96, s34, 0x191d000
    buffer_load_dwordx4 v252, s[4:7], s96 offen offset:0 sc1 lds
    v_mfma_f32_16x16x32_bf16 v[180:183], a[128:131], v[88:91], v[180:183]
    v_exp_f32 v235, v235
    v_mfma_f32_16x16x32_bf16 v[172:175], a[132:135], v[92:95], v[172:175]
    ds_read_b128 v[80:83], v252 offset:36864
    v_exp_f32 v236, v236
    v_mfma_f32_16x16x32_bf16 v[176:179], a[136:139], v[92:95], v[176:179]
    v_exp_f32 v237, v237
    v_mfma_f32_16x16x32_bf16 v[180:183], a[140:143], v[92:95], v[180:183]
    v_exp_f32 v238, v238
    s_waitcnt lgkmcnt(3)
    v_mfma_f32_16x16x32_bf16 v[172:175], a[144:147], v[64:67], v[172:175]
    ds_read_b128 v[84:87], v252 offset:37888
    v_exp_f32 v239, v239
    v_mfma_f32_16x16x32_bf16 v[176:179], a[148:151], v[64:67], v[176:179]
    s_add_u32 m0, s49, 0
    s_add_u32 s96, s34, 0x191d000
    buffer_load_dwordx4 v252, s[4:7], s96 offen offset:1024 sc1 lds
    v_mfma_f32_16x16x32_bf16 v[180:183], a[152:155], v[64:67], v[180:183]
    v_exp_f32 v240, v240
    v_mfma_f32_16x16x32_bf16 v[172:175], a[156:159], v[68:71], v[172:175]
    ds_read_b128 v[88:91], v252 offset:38912
    v_exp_f32 v241, v241
    v_mfma_f32_16x16x32_bf16 v[176:179], a[160:163], v[68:71], v[176:179]
    v_exp_f32 v242, v242
    v_mfma_f32_16x16x32_bf16 v[180:183], a[164:167], v[68:71], v[180:183]
    v_exp_f32 v243, v243
    s_waitcnt lgkmcnt(3)
    v_mfma_f32_16x16x32_bf16 v[172:175], a[168:171], v[72:75], v[172:175]
    ds_read_b128 v[92:95], v252 offset:39936
    v_fma_f32 v232, v232, v56, v56
    v_fma_f32 v233, v233, v56, v56
    v_mfma_f32_16x16x32_bf16 v[176:179], a[172:175], v[72:75], v[176:179]
    s_add_u32 m0, s49, 0
    s_add_u32 s96, s34, 0x191d000
    buffer_load_dwordx4 v252, s[4:7], s96 offen offset:2048 sc1 lds
    v_mfma_f32_16x16x32_bf16 v[180:183], a[176:179], v[72:75], v[180:183]
    v_fma_f32 v234, v234, v56, v56
    v_fma_f32 v235, v235, v56, v56
    v_mfma_f32_16x16x32_bf16 v[172:175], a[180:183], v[76:79], v[172:175]
    ds_read_b128 v[64:67], v21 offset:0
    v_fma_f32 v236, v236, v56, v56
    v_fma_f32 v237, v237, v56, v56
    v_mfma_f32_16x16x32_bf16 v[176:179], a[184:187], v[76:79], v[176:179]
    v_fma_f32 v238, v238, v56, v56
    v_fma_f32 v239, v239, v56, v56
    v_mfma_f32_16x16x32_bf16 v[180:183], a[188:191], v[76:79], v[180:183]
    v_fma_f32 v240, v240, v56, v56
    v_fma_f32 v241, v241, v56, v56
    s_waitcnt lgkmcnt(3)
    v_mfma_f32_16x16x32_bf16 v[172:175], a[192:195], v[80:83], v[172:175]
    ds_read_b128 v[68:71], v21 offset:1024
    v_fma_f32 v242, v242, v56, v56
    v_fma_f32 v243, v243, v56, v56
    v_mfma_f32_16x16x32_bf16 v[176:179], a[196:199], v[80:83], v[176:179]
    s_add_u32 m0, s49, 0
    s_add_u32 s96, s34, 0x191d000
    buffer_load_dwordx4 v252, s[4:7], s96 offen offset:3072 sc1 lds
    v_mfma_f32_16x16x32_bf16 v[180:183], a[200:203], v[80:83], v[180:183]
    v_rcp_f32 v232, v232
    v_mfma_f32_16x16x32_bf16 v[172:175], a[204:207], v[84:87], v[172:175]
    ds_read_b128 v[72:75], v21 offset:2048
    v_rcp_f32 v233, v233
    v_mfma_f32_16x16x32_bf16 v[176:179], a[208:211], v[84:87], v[176:179]
    v_rcp_f32 v234, v234
    v_mfma_f32_16x16x32_bf16 v[180:183], a[212:215], v[84:87], v[180:183]
    v_rcp_f32 v235, v235
    s_waitcnt lgkmcnt(3)
    v_mfma_f32_16x16x32_bf16 v[172:175], a[216:219], v[88:91], v[172:175]
    ds_read_b128 v[76:79], v21 offset:3072
    v_rcp_f32 v236, v236
    v_mfma_f32_16x16x32_bf16 v[176:179], a[220:223], v[88:91], v[176:179]
    s_add_u32 m0, s49, 4096
    s_add_u32 s96, s34, 0x191e000
    buffer_load_dwordx4 v252, s[4:7], s96 offen offset:0 sc1 lds
    v_mfma_f32_16x16x32_bf16 v[180:183], a[224:227], v[88:91], v[180:183]
    v_rcp_f32 v237, v237
    v_mfma_f32_16x16x32_bf16 v[172:175], a[228:231], v[92:95], v[172:175]
    ds_read_b128 v[80:83], v21 offset:4096
    v_rcp_f32 v238, v238
    v_mfma_f32_16x16x32_bf16 v[176:179], a[232:235], v[92:95], v[176:179]
    v_rcp_f32 v239, v239
    v_mfma_f32_16x16x32_bf16 v[180:183], a[236:239], v[92:95], v[180:183]
    v_rcp_f32 v240, v240
    v_rcp_f32 v241, v241
    v_rcp_f32 v242, v242
    v_rcp_f32 v243, v243
    v_mul_f32 v160, v160, v232
    v_mul_f32 v161, v161, v233
    v_mul_f32 v162, v162, v234
    v_mul_f32 v163, v163, v235
    v_mul_f32 v164, v164, v236
    v_mul_f32 v165, v165, v237
    v_mul_f32 v166, v166, v238
    v_mul_f32 v167, v167, v239
    v_mul_f32 v168, v168, v240
    v_mul_f32 v169, v169, v241
    v_mul_f32 v170, v170, v242
    v_mul_f32 v171, v171, v243
    v_cvt_pk_bf16_f32 v160, v160, v161
    v_cvt_pk_bf16_f32 v161, v162, v163
    v_cvt_pk_bf16_f32 v162, v164, v165
    v_cvt_pk_bf16_f32 v163, v166, v167
    v_cvt_pk_bf16_f32 v164, v168, v169
    v_cvt_pk_bf16_f32 v165, v170, v171
    buffer_store_dwordx4 v[160:163], v6, s[4:7], s31 offen sc1
    buffer_store_dwordx2 v[164:165], v7, s[4:7], s31 offen sc1
    s_add_u32 s31, s31, 49152
    v_mfma_f32_16x16x32_bf16 v[172:175], v[42:45], v[210:213], v[172:175]
    v_mfma_f32_16x16x32_bf16 v[176:179], v[46:49], v[210:213], v[176:179]
    v_mfma_f32_16x16x32_bf16 v[180:183], v[50:53], v[210:213], v[180:183]
    s_waitcnt lgkmcnt(3)
    v_mfma_f32_16x16x32_bf16 v[184:187], a[0:3], v[64:67], 0
    ds_read_b128 v[84:87], v21 offset:5120
    v_mfma_f32_16x16x32_bf16 v[188:191], a[4:7], v[64:67], 0
    s_add_u32 m0, s49, 5120
    s_add_u32 s96, s35, 0x191d000
    buffer_load_dwordx4 v252, s[4:7], s96 offen offset:0 sc1 lds
    v_mfma_f32_16x16x32_bf16 v[192:195], a[8:11], v[64:67], 0
    v_mfma_f32_16x16x32_bf16 v[184:187], a[12:15], v[68:71], v[184:187]
    ds_read_b128 v[88:91], v21 offset:6144
    v_mfma_f32_16x16x32_bf16 v[188:191], a[16:19], v[68:71], v[188:191]
    v_mfma_f32_16x16x32_bf16 v[192:195], a[20:23], v[68:71], v[192:195]
    s_waitcnt lgkmcnt(3)
    v_mfma_f32_16x16x32_bf16 v[184:187], a[24:27], v[72:75], v[184:187]
    ds_read_b128 v[92:95], v21 offset:7168
    v_mul_f32 v232, v172, v172
    v_mul_f32 v233, v173, v173
    v_mfma_f32_16x16x32_bf16 v[188:191], a[28:31], v[72:75], v[188:191]
    s_add_u32 m0, s49, 5120
    s_add_u32 s96, s35, 0x191d000
    buffer_load_dwordx4 v252, s[4:7], s96 offen offset:1024 sc1 lds
    v_mfma_f32_16x16x32_bf16 v[192:195], a[32:35], v[72:75], v[192:195]
    v_mul_f32 v234, v174, v174
    v_mul_f32 v235, v175, v175
    v_mfma_f32_16x16x32_bf16 v[184:187], a[36:39], v[76:79], v[184:187]
    ds_read_b128 v[64:67], v21 offset:8192
    v_mul_f32 v236, v176, v176
    v_mul_f32 v237, v177, v177
    v_mfma_f32_16x16x32_bf16 v[188:191], a[40:43], v[76:79], v[188:191]
    v_mul_f32 v238, v178, v178
    v_mul_f32 v239, v179, v179
    v_mfma_f32_16x16x32_bf16 v[192:195], a[44:47], v[76:79], v[192:195]
    v_mul_f32 v240, v180, v180
    v_mul_f32 v241, v181, v181
    s_waitcnt lgkmcnt(3)
    v_mfma_f32_16x16x32_bf16 v[184:187], a[48:51], v[80:83], v[184:187]
    ds_read_b128 v[68:71], v21 offset:9216
    v_mul_f32 v242, v182, v182
    v_mul_f32 v243, v183, v183
    v_mfma_f32_16x16x32_bf16 v[188:191], a[52:55], v[80:83], v[188:191]
    s_add_u32 m0, s49, 5120
    s_add_u32 s96, s35, 0x191d000
    buffer_load_dwordx4 v252, s[4:7], s96 offen offset:2048 sc1 lds
    v_mfma_f32_16x16x32_bf16 v[192:195], a[56:59], v[80:83], v[192:195]
    v_fma_f32 v232, v232, v58, v59
    v_fma_f32 v233, v233, v58, v59
    v_mfma_f32_16x16x32_bf16 v[184:187], a[60:63], v[84:87], v[184:187]
    ds_read_b128 v[72:75], v21 offset:10240
    v_fma_f32 v234, v234, v58, v59
    v_fma_f32 v235, v235, v58, v59
    v_mfma_f32_16x16x32_bf16 v[188:191], a[64:67], v[84:87], v[188:191]
    v_fma_f32 v236, v236, v58, v59
    v_fma_f32 v237, v237, v58, v59
    v_mfma_f32_16x16x32_bf16 v[192:195], a[68:71], v[84:87], v[192:195]
    v_fma_f32 v238, v238, v58, v59
    v_fma_f32 v239, v239, v58, v59
    s_waitcnt lgkmcnt(3)
    v_mfma_f32_16x16x32_bf16 v[184:187], a[72:75], v[88:91], v[184:187]
    ds_read_b128 v[76:79], v21 offset:11264
    v_fma_f32 v240, v240, v58, v59
    v_fma_f32 v241, v241, v58, v59
    v_mfma_f32_16x16x32_bf16 v[188:191], a[76:79], v[88:91], v[188:191]
    s_add_u32 m0, s49, 5120
    s_add_u32 s96, s35, 0x191d000
    buffer_load_dwordx4 v252, s[4:7], s96 offen offset:3072 sc1 lds
    v_mfma_f32_16x16x32_bf16 v[192:195], a[80:83], v[88:91], v[192:195]
    v_fma_f32 v242, v242, v58, v59
    v_fma_f32 v243, v243, v58, v59
    v_mfma_f32_16x16x32_bf16 v[184:187], a[84:87], v[92:95], v[184:187]
    ds_read_b128 v[80:83], v21 offset:12288
    v_mul_f32 v232, v232, v172
    v_mul_f32 v233, v233, v173
    v_mfma_f32_16x16x32_bf16 v[188:191], a[88:91], v[92:95], v[188:191]
    v_mul_f32 v234, v234, v174
    v_mul_f32 v235, v235, v175
    v_mfma_f32_16x16x32_bf16 v[192:195], a[92:95], v[92:95], v[192:195]
    v_mul_f32 v236, v236, v176
    v_mul_f32 v237, v237, v177
    s_waitcnt lgkmcnt(3)
    v_mfma_f32_16x16x32_bf16 v[184:187], a[96:99], v[64:67], v[184:187]
    ds_read_b128 v[84:87], v21 offset:13312
    v_mul_f32 v238, v238, v178
    v_mul_f32 v239, v239, v179
    v_mfma_f32_16x16x32_bf16 v[188:191], a[100:103], v[64:67], v[188:191]
    s_add_u32 m0, s49, 9216
    s_add_u32 s96, s35, 0x191e000
    buffer_load_dwordx4 v252, s[4:7], s96 offen offset:0 sc1 lds
    v_mfma_f32_16x16x32_bf16 v[192:195], a[104:107], v[64:67], v[192:195]
    v_mul_f32 v240, v240, v180
    v_mul_f32 v241, v241, v181
    v_mfma_f32_16x16x32_bf16 v[184:187], a[108:111], v[68:71], v[184:187]
    ds_read_b128 v[88:91], v21 offset:14336
    v_mul_f32 v242, v242, v182
    v_mul_f32 v243, v243, v183
    v_mfma_f32_16x16x32_bf16 v[188:191], a[112:115], v[68:71], v[188:191]
    v_exp_f32 v232, v232
    v_mfma_f32_16x16x32_bf16 v[192:195], a[116:119], v[68:71], v[192:195]
    v_exp_f32 v233, v233
    s_waitcnt lgkmcnt(3)
    v_mfma_f32_16x16x32_bf16 v[184:187], a[120:123], v[72:75], v[184:187]
    ds_read_b128 v[92:95], v21 offset:15360
    v_exp_f32 v234, v234
    v_mfma_f32_16x16x32_bf16 v[188:191], a[124:127], v[72:75], v[188:191]
    s_add_u32 m0, s49, 10240
    s_add_u32 s96, s36, 0x191d000
    buffer_load_dwordx4 v252, s[4:7], s96 offen offset:0 sc1 lds
    v_mfma_f32_16x16x32_bf16 v[192:195], a[128:131], v[72:75], v[192:195]
    v_exp_f32 v235, v235
    v_mfma_f32_16x16x32_bf16 v[184:187], a[132:135], v[76:79], v[184:187]
    ds_read_b128 v[64:67], v21 offset:16384
    v_exp_f32 v236, v236
    v_mfma_f32_16x16x32_bf16 v[188:191], a[136:139], v[76:79], v[188:191]
    v_exp_f32 v237, v237
    v_mfma_f32_16x16x32_bf16 v[192:195], a[140:143], v[76:79], v[192:195]
    v_exp_f32 v238, v238
    s_waitcnt lgkmcnt(3)
    v_mfma_f32_16x16x32_bf16 v[184:187], a[144:147], v[80:83], v[184:187]
    ds_read_b128 v[68:71], v21 offset:17408
    v_exp_f32 v239, v239
    v_mfma_f32_16x16x32_bf16 v[188:191], a[148:151], v[80:83], v[188:191]
    s_add_u32 m0, s49, 10240
    s_add_u32 s96, s36, 0x191d000
    buffer_load_dwordx4 v252, s[4:7], s96 offen offset:1024 sc1 lds
    v_mfma_f32_16x16x32_bf16 v[192:195], a[152:155], v[80:83], v[192:195]
    v_exp_f32 v240, v240
    v_mfma_f32_16x16x32_bf16 v[184:187], a[156:159], v[84:87], v[184:187]
    ds_read_b128 v[72:75], v21 offset:18432
    v_exp_f32 v241, v241
    v_mfma_f32_16x16x32_bf16 v[188:191], a[160:163], v[84:87], v[188:191]
    v_exp_f32 v242, v242
    v_mfma_f32_16x16x32_bf16 v[192:195], a[164:167], v[84:87], v[192:195]
    v_exp_f32 v243, v243
    s_waitcnt lgkmcnt(3)
    v_mfma_f32_16x16x32_bf16 v[184:187], a[168:171], v[88:91], v[184:187]
    ds_read_b128 v[76:79], v21 offset:19456
    v_fma_f32 v232, v232, v60, v60
    v_fma_f32 v233, v233, v60, v60
    v_mfma_f32_16x16x32_bf16 v[188:191], a[172:175], v[88:91], v[188:191]
    s_add_u32 m0, s49, 10240
    s_add_u32 s96, s36, 0x191d000
    buffer_load_dwordx4 v252, s[4:7], s96 offen offset:2048 sc1 lds
    v_mfma_f32_16x16x32_bf16 v[192:195], a[176:179], v[88:91], v[192:195]
    v_fma_f32 v234, v234, v60, v60
    v_fma_f32 v235, v235, v60, v60
    v_mfma_f32_16x16x32_bf16 v[184:187], a[180:183], v[92:95], v[184:187]
    ds_read_b128 v[80:83], v21 offset:20480
    v_fma_f32 v236, v236, v60, v60
    v_fma_f32 v237, v237, v60, v60
    v_mfma_f32_16x16x32_bf16 v[188:191], a[184:187], v[92:95], v[188:191]
    v_fma_f32 v238, v238, v60, v60
    v_fma_f32 v239, v239, v60, v60
    v_mfma_f32_16x16x32_bf16 v[192:195], a[188:191], v[92:95], v[192:195]
    v_fma_f32 v240, v240, v60, v60
    v_fma_f32 v241, v241, v60, v60
    s_waitcnt lgkmcnt(3)
    v_mfma_f32_16x16x32_bf16 v[184:187], a[192:195], v[64:67], v[184:187]
    ds_read_b128 v[84:87], v21 offset:21504
    v_fma_f32 v242, v242, v60, v60
    v_fma_f32 v243, v243, v60, v60
    v_mfma_f32_16x16x32_bf16 v[188:191], a[196:199], v[64:67], v[188:191]
    s_add_u32 m0, s49, 10240
    s_add_u32 s96, s36, 0x191d000
    buffer_load_dwordx4 v252, s[4:7], s96 offen offset:3072 sc1 lds
    v_mfma_f32_16x16x32_bf16 v[192:195], a[200:203], v[64:67], v[192:195]
    v_rcp_f32 v232, v232
    v_mfma_f32_16x16x32_bf16 v[184:187], a[204:207], v[68:71], v[184:187]
    ds_read_b128 v[88:91], v21 offset:22528
    v_rcp_f32 v233, v233
    v_mfma_f32_16x16x32_bf16 v[188:191], a[208:211], v[68:71], v[188:191]
    v_rcp_f32 v234, v234
    v_mfma_f32_16x16x32_bf16 v[192:195], a[212:215], v[68:71], v[192:195]
    v_rcp_f32 v235, v235
    s_waitcnt lgkmcnt(3)
    v_mfma_f32_16x16x32_bf16 v[184:187], a[216:219], v[72:75], v[184:187]
    ds_read_b128 v[92:95], v21 offset:23552
    v_rcp_f32 v236, v236
    v_mfma_f32_16x16x32_bf16 v[188:191], a[220:223], v[72:75], v[188:191]
    s_add_u32 m0, s49, 14336
    s_add_u32 s96, s36, 0x191e000
    buffer_load_dwordx4 v252, s[4:7], s96 offen offset:0 sc1 lds
    v_mfma_f32_16x16x32_bf16 v[192:195], a[224:227], v[72:75], v[192:195]
    v_rcp_f32 v237, v237
    v_mfma_f32_16x16x32_bf16 v[184:187], a[228:231], v[76:79], v[184:187]
    ds_read_b128 v[64:67], v21 offset:24576
    v_rcp_f32 v238, v238
    v_mfma_f32_16x16x32_bf16 v[188:191], a[232:235], v[76:79], v[188:191]
    v_rcp_f32 v239, v239
    v_mfma_f32_16x16x32_bf16 v[192:195], a[236:239], v[76:79], v[192:195]
    v_rcp_f32 v240, v240
    v_rcp_f32 v241, v241
    v_rcp_f32 v242, v242
    v_rcp_f32 v243, v243
    v_mul_f32 v172, v172, v232
    v_mul_f32 v173, v173, v233
    v_mul_f32 v174, v174, v234
    v_mul_f32 v175, v175, v235
    v_mul_f32 v176, v176, v236
    v_mul_f32 v177, v177, v237
    v_mul_f32 v178, v178, v238
    v_mul_f32 v179, v179, v239
    v_mul_f32 v180, v180, v240
    v_mul_f32 v181, v181, v241
    v_mul_f32 v182, v182, v242
    v_mul_f32 v183, v183, v243
    v_cvt_pk_bf16_f32 v172, v172, v173
    v_cvt_pk_bf16_f32 v173, v174, v175
    v_cvt_pk_bf16_f32 v174, v176, v177
    v_cvt_pk_bf16_f32 v175, v178, v179
    v_cvt_pk_bf16_f32 v176, v180, v181
    v_cvt_pk_bf16_f32 v177, v182, v183
    buffer_store_dwordx4 v[172:175], v6, s[4:7], s31 offen sc1
    buffer_store_dwordx2 v[176:177], v7, s[4:7], s31 offen sc1
    s_add_u32 s31, s31, 49152
    v_mfma_f32_16x16x32_bf16 v[184:187], v[42:45], v[212:215], v[184:187]
    v_mfma_f32_16x16x32_bf16 v[188:191], v[46:49], v[212:215], v[188:191]
    v_mfma_f32_16x16x32_bf16 v[192:195], v[50:53], v[212:215], v[192:195]
    s_waitcnt lgkmcnt(3)
    v_mfma_f32_16x16x32_bf16 v[196:199], a[0:3], v[80:83], 0
    ds_read_b128 v[68:71], v21 offset:25600
    v_mfma_f32_16x16x32_bf16 v[200:203], a[4:7], v[80:83], 0
    v_mfma_f32_16x16x32_bf16 v[204:207], a[8:11], v[80:83], 0
    v_mfma_f32_16x16x32_bf16 v[196:199], a[12:15], v[84:87], v[196:199]
    ds_read_b128 v[72:75], v21 offset:26624
    v_mfma_f32_16x16x32_bf16 v[200:203], a[16:19], v[84:87], v[200:203]
    v_mfma_f32_16x16x32_bf16 v[204:207], a[20:23], v[84:87], v[204:207]
    s_waitcnt lgkmcnt(3)
    v_mfma_f32_16x16x32_bf16 v[196:199], a[24:27], v[88:91], v[196:199]
    ds_read_b128 v[76:79], v21 offset:27648
    v_mul_f32 v232, v184, v184
    v_mul_f32 v233, v185, v185
    v_mfma_f32_16x16x32_bf16 v[200:203], a[28:31], v[88:91], v[200:203]
    s_add_u32 m0, s49, 15360
    s_add_u32 s96, s37, 0x191d000
    buffer_load_dwordx4 v252, s[4:7], s96 offen offset:0 sc1 lds
    v_mfma_f32_16x16x32_bf16 v[204:207], a[32:35], v[88:91], v[204:207]
    v_mul_f32 v234, v186, v186
    v_mul_f32 v235, v187, v187
    v_mfma_f32_16x16x32_bf16 v[196:199], a[36:39], v[92:95], v[196:199]
    ds_read_b128 v[80:83], v21 offset:28672
    v_mul_f32 v236, v188, v188
    v_mul_f32 v237, v189, v189
    v_mfma_f32_16x16x32_bf16 v[200:203], a[40:43], v[92:95], v[200:203]
    v_mul_f32 v238, v190, v190
    v_mul_f32 v239, v191, v191
    v_mfma_f32_16x16x32_bf16 v[204:207], a[44:47], v[92:95], v[204:207]
    v_mul_f32 v240, v192, v192
    v_mul_f32 v241, v193, v193
    s_waitcnt lgkmcnt(3)
    v_mfma_f32_16x16x32_bf16 v[196:199], a[48:51], v[64:67], v[196:199]
    ds_read_b128 v[84:87], v21 offset:29696
    v_mul_f32 v242, v194, v194
    v_mul_f32 v243, v195, v195
    v_mfma_f32_16x16x32_bf16 v[200:203], a[52:55], v[64:67], v[200:203]
    s_add_u32 m0, s49, 15360
    s_add_u32 s96, s37, 0x191d000
    buffer_load_dwordx4 v252, s[4:7], s96 offen offset:1024 sc1 lds
    v_mfma_f32_16x16x32_bf16 v[204:207], a[56:59], v[64:67], v[204:207]
    v_fma_f32 v232, v232, v218, v219
    v_fma_f32 v233, v233, v218, v219
    v_mfma_f32_16x16x32_bf16 v[196:199], a[60:63], v[68:71], v[196:199]
    ds_read_b128 v[88:91], v21 offset:30720
    v_fma_f32 v234, v234, v218, v219
    v_fma_f32 v235, v235, v218, v219
    v_mfma_f32_16x16x32_bf16 v[200:203], a[64:67], v[68:71], v[200:203]
    v_fma_f32 v236, v236, v218, v219
    v_fma_f32 v237, v237, v218, v219
    v_mfma_f32_16x16x32_bf16 v[204:207], a[68:71], v[68:71], v[204:207]
    v_fma_f32 v238, v238, v218, v219
    v_fma_f32 v239, v239, v218, v219
    s_waitcnt lgkmcnt(3)
    v_mfma_f32_16x16x32_bf16 v[196:199], a[72:75], v[72:75], v[196:199]
    ds_read_b128 v[92:95], v21 offset:31744
    v_fma_f32 v240, v240, v218, v219
    v_fma_f32 v241, v241, v218, v219
    v_mfma_f32_16x16x32_bf16 v[200:203], a[76:79], v[72:75], v[200:203]
    s_add_u32 s99, s37, 0x191d000
    buffer_load_dwordx4 a[0:3], v252, s[4:7], s99 offen offset:2048 sc1
    v_mfma_f32_16x16x32_bf16 v[204:207], a[80:83], v[72:75], v[204:207]
    v_fma_f32 v242, v242, v218, v219
    v_fma_f32 v243, v243, v218, v219
    v_mfma_f32_16x16x32_bf16 v[196:199], a[84:87], v[76:79], v[196:199]
    ds_read_b128 v[64:67], v21 offset:32768
    v_mul_f32 v232, v232, v184
    v_mul_f32 v233, v233, v185
    v_mfma_f32_16x16x32_bf16 v[200:203], a[88:91], v[76:79], v[200:203]
    v_mul_f32 v234, v234, v186
    v_mul_f32 v235, v235, v187
    v_mfma_f32_16x16x32_bf16 v[204:207], a[92:95], v[76:79], v[204:207]
    v_mul_f32 v236, v236, v188
    v_mul_f32 v237, v237, v189
    s_waitcnt lgkmcnt(3)
    v_mfma_f32_16x16x32_bf16 v[196:199], a[96:99], v[80:83], v[196:199]
    ds_read_b128 v[68:71], v21 offset:33792
    v_mul_f32 v238, v238, v190
    v_mul_f32 v239, v239, v191
    v_mfma_f32_16x16x32_bf16 v[200:203], a[100:103], v[80:83], v[200:203]
    buffer_load_dwordx4 a[4:7], v252, s[4:7], s99 offen offset:3072 sc1
    v_mfma_f32_16x16x32_bf16 v[204:207], a[104:107], v[80:83], v[204:207]
    v_mul_f32 v240, v240, v192
    v_mul_f32 v241, v241, v193
    v_mfma_f32_16x16x32_bf16 v[196:199], a[108:111], v[84:87], v[196:199]
    ds_read_b128 v[72:75], v21 offset:34816
    v_mul_f32 v242, v242, v194
    v_mul_f32 v243, v243, v195
    v_mfma_f32_16x16x32_bf16 v[200:203], a[112:115], v[84:87], v[200:203]
    v_exp_f32 v232, v232
    v_mfma_f32_16x16x32_bf16 v[204:207], a[116:119], v[84:87], v[204:207]
    v_exp_f32 v233, v233
    s_waitcnt lgkmcnt(3)
    v_mfma_f32_16x16x32_bf16 v[196:199], a[120:123], v[88:91], v[196:199]
    ds_read_b128 v[76:79], v21 offset:35840
    v_exp_f32 v234, v234
    v_mfma_f32_16x16x32_bf16 v[200:203], a[124:127], v[88:91], v[200:203]
    v_exp_f32 v235, v235
    v_mfma_f32_16x16x32_bf16 v[204:207], a[128:131], v[88:91], v[204:207]
    v_exp_f32 v236, v236
    v_mfma_f32_16x16x32_bf16 v[196:199], a[132:135], v[92:95], v[196:199]
    ds_read_b128 v[80:83], v21 offset:36864
    v_exp_f32 v237, v237
    v_mfma_f32_16x16x32_bf16 v[200:203], a[136:139], v[92:95], v[200:203]
    v_exp_f32 v238, v238
    v_mfma_f32_16x16x32_bf16 v[204:207], a[140:143], v[92:95], v[204:207]
    v_exp_f32 v239, v239
    s_waitcnt lgkmcnt(3)
    v_mfma_f32_16x16x32_bf16 v[196:199], a[144:147], v[64:67], v[196:199]
    ds_read_b128 v[84:87], v21 offset:37888
    v_exp_f32 v240, v240
    v_mfma_f32_16x16x32_bf16 v[200:203], a[148:151], v[64:67], v[200:203]
    v_exp_f32 v241, v241
    v_mfma_f32_16x16x32_bf16 v[204:207], a[152:155], v[64:67], v[204:207]
    v_exp_f32 v242, v242
    v_mfma_f32_16x16x32_bf16 v[196:199], a[156:159], v[68:71], v[196:199]
    ds_read_b128 v[88:91], v21 offset:38912
    v_exp_f32 v243, v243
    v_mfma_f32_16x16x32_bf16 v[200:203], a[160:163], v[68:71], v[200:203]
    v_fma_f32 v232, v232, v220, v220
    v_fma_f32 v233, v233, v220, v220
    v_mfma_f32_16x16x32_bf16 v[204:207], a[164:167], v[68:71], v[204:207]
    v_fma_f32 v234, v234, v220, v220
    v_fma_f32 v235, v235, v220, v220
    s_waitcnt lgkmcnt(3)
    v_mfma_f32_16x16x32_bf16 v[196:199], a[168:171], v[72:75], v[196:199]
    ds_read_b128 v[92:95], v21 offset:39936
    v_fma_f32 v236, v236, v220, v220
    v_fma_f32 v237, v237, v220, v220
    v_mfma_f32_16x16x32_bf16 v[200:203], a[172:175], v[72:75], v[200:203]
    v_fma_f32 v238, v238, v220, v220
    v_fma_f32 v239, v239, v220, v220
    v_mfma_f32_16x16x32_bf16 v[204:207], a[176:179], v[72:75], v[204:207]
    v_fma_f32 v240, v240, v220, v220
    v_fma_f32 v241, v241, v220, v220
    v_mfma_f32_16x16x32_bf16 v[196:199], a[180:183], v[76:79], v[196:199]
    v_fma_f32 v242, v242, v220, v220
    v_fma_f32 v243, v243, v220, v220
    v_mfma_f32_16x16x32_bf16 v[200:203], a[184:187], v[76:79], v[200:203]
    v_rcp_f32 v232, v232
    v_mfma_f32_16x16x32_bf16 v[204:207], a[188:191], v[76:79], v[204:207]
    v_rcp_f32 v233, v233
    s_waitcnt lgkmcnt(2)
    v_mfma_f32_16x16x32_bf16 v[196:199], a[192:195], v[80:83], v[196:199]
    v_rcp_f32 v234, v234
    v_mfma_f32_16x16x32_bf16 v[200:203], a[196:199], v[80:83], v[200:203]
    v_rcp_f32 v235, v235
    v_mfma_f32_16x16x32_bf16 v[204:207], a[200:203], v[80:83], v[204:207]
    v_rcp_f32 v236, v236
    v_mfma_f32_16x16x32_bf16 v[196:199], a[204:207], v[84:87], v[196:199]
    v_rcp_f32 v237, v237
    v_mfma_f32_16x16x32_bf16 v[200:203], a[208:211], v[84:87], v[200:203]
    v_rcp_f32 v238, v238
    v_mfma_f32_16x16x32_bf16 v[204:207], a[212:215], v[84:87], v[204:207]
    v_rcp_f32 v239, v239
    s_waitcnt lgkmcnt(0)
    v_mfma_f32_16x16x32_bf16 v[196:199], a[216:219], v[88:91], v[196:199]
    v_rcp_f32 v240, v240
    v_mfma_f32_16x16x32_bf16 v[200:203], a[220:223], v[88:91], v[200:203]
    v_rcp_f32 v241, v241
    v_mfma_f32_16x16x32_bf16 v[204:207], a[224:227], v[88:91], v[204:207]
    v_rcp_f32 v242, v242
    v_mfma_f32_16x16x32_bf16 v[196:199], a[228:231], v[92:95], v[196:199]
    v_rcp_f32 v243, v243
    v_mfma_f32_16x16x32_bf16 v[200:203], a[232:235], v[92:95], v[200:203]
    v_mul_f32 v184, v184, v232
    v_mul_f32 v185, v185, v233
    v_mfma_f32_16x16x32_bf16 v[204:207], a[236:239], v[92:95], v[204:207]
    v_mul_f32 v186, v186, v234
    v_mul_f32 v187, v187, v235
    v_mul_f32 v188, v188, v236
    v_mul_f32 v189, v189, v237
    v_mul_f32 v190, v190, v238
    v_mul_f32 v191, v191, v239
    v_mul_f32 v192, v192, v240
    v_mul_f32 v193, v193, v241
    v_mul_f32 v194, v194, v242
    v_mul_f32 v195, v195, v243
    v_cvt_pk_bf16_f32 v184, v184, v185
    v_cvt_pk_bf16_f32 v185, v186, v187
    v_cvt_pk_bf16_f32 v186, v188, v189
    v_cvt_pk_bf16_f32 v187, v190, v191
    v_cvt_pk_bf16_f32 v188, v192, v193
    v_cvt_pk_bf16_f32 v189, v194, v195
    buffer_store_dwordx4 v[184:187], v6, s[4:7], s31 offen sc1
    buffer_store_dwordx2 v[188:189], v7, s[4:7], s31 offen sc1
    s_add_u32 s31, s31, 49152
    v_mfma_f32_16x16x32_bf16 v[196:199], v[42:45], v[214:217], v[196:199]
    v_mfma_f32_16x16x32_bf16 v[200:203], v[46:49], v[214:217], v[200:203]
    v_mfma_f32_16x16x32_bf16 v[204:207], v[50:53], v[214:217], v[204:207]
    s_nop 5
    v_pk_mul_f32 v[232:233], v[196:197], v[196:197]
    v_pk_mul_f32 v[234:235], v[198:199], v[198:199]
    v_pk_mul_f32 v[236:237], v[200:201], v[200:201]
    v_pk_mul_f32 v[238:239], v[202:203], v[202:203]
    v_pk_mul_f32 v[240:241], v[204:205], v[204:205]
    v_pk_mul_f32 v[242:243], v[206:207], v[206:207]
    v_pk_fma_f32 v[232:233], v[232:233], v[222:223], v[222:223] op_sel:[0,0,1] op_sel_hi:[1,0,1]
    v_pk_fma_f32 v[234:235], v[234:235], v[222:223], v[222:223] op_sel:[0,0,1] op_sel_hi:[1,0,1]
    v_pk_fma_f32 v[236:237], v[236:237], v[222:223], v[222:223] op_sel:[0,0,1] op_sel_hi:[1,0,1]
    v_pk_fma_f32 v[238:239], v[238:239], v[222:223], v[222:223] op_sel:[0,0,1] op_sel_hi:[1,0,1]
    v_pk_fma_f32 v[240:241], v[240:241], v[222:223], v[222:223] op_sel:[0,0,1] op_sel_hi:[1,0,1]
    v_pk_fma_f32 v[242:243], v[242:243], v[222:223], v[222:223] op_sel:[0,0,1] op_sel_hi:[1,0,1]
    v_pk_mul_f32 v[232:233], v[232:233], v[196:197]
    v_pk_mul_f32 v[234:235], v[234:235], v[198:199]
    v_pk_mul_f32 v[236:237], v[236:237], v[200:201]
    v_pk_mul_f32 v[238:239], v[238:239], v[202:203]
    v_pk_mul_f32 v[240:241], v[240:241], v[204:205]
    v_pk_mul_f32 v[242:243], v[242:243], v[206:207]
    v_exp_f32 v232, v232
    v_exp_f32 v233, v233
    v_exp_f32 v234, v234
    v_exp_f32 v235, v235
    v_exp_f32 v236, v236
    v_exp_f32 v237, v237
    v_exp_f32 v238, v238
    v_exp_f32 v239, v239
    v_exp_f32 v240, v240
    v_exp_f32 v241, v241
    v_exp_f32 v242, v242
    v_exp_f32 v243, v243
    v_pk_fma_f32 v[232:233], v[232:233], v[224:225], v[224:225] op_sel_hi:[1,0,0]
    v_pk_fma_f32 v[234:235], v[234:235], v[224:225], v[224:225] op_sel_hi:[1,0,0]
    v_pk_fma_f32 v[236:237], v[236:237], v[224:225], v[224:225] op_sel_hi:[1,0,0]
    v_pk_fma_f32 v[238:239], v[238:239], v[224:225], v[224:225] op_sel_hi:[1,0,0]
    v_pk_fma_f32 v[240:241], v[240:241], v[224:225], v[224:225] op_sel_hi:[1,0,0]
    v_pk_fma_f32 v[242:243], v[242:243], v[224:225], v[224:225] op_sel_hi:[1,0,0]
    v_rcp_f32 v232, v232
    v_rcp_f32 v233, v233
    v_rcp_f32 v234, v234
    v_rcp_f32 v235, v235
    v_rcp_f32 v236, v236
    v_rcp_f32 v237, v237
    v_rcp_f32 v238, v238
    v_rcp_f32 v239, v239
    v_rcp_f32 v240, v240
    v_rcp_f32 v241, v241
    v_rcp_f32 v242, v242
    v_rcp_f32 v243, v243
    v_pk_mul_f32 v[196:197], v[196:197], v[232:233]
    v_pk_mul_f32 v[198:199], v[198:199], v[234:235]
    v_pk_mul_f32 v[200:201], v[200:201], v[236:237]
    v_pk_mul_f32 v[202:203], v[202:203], v[238:239]
    v_pk_mul_f32 v[204:205], v[204:205], v[240:241]
    v_pk_mul_f32 v[206:207], v[206:207], v[242:243]
    v_cvt_pk_bf16_f32 v196, v196, v197
    v_cvt_pk_bf16_f32 v197, v198, v199
    v_cvt_pk_bf16_f32 v198, v200, v201
    v_cvt_pk_bf16_f32 v199, v202, v203
    v_cvt_pk_bf16_f32 v200, v204, v205
    v_cvt_pk_bf16_f32 v201, v206, v207
    buffer_store_dwordx4 v[196:199], v6, s[4:7], s31 offen sc1
    buffer_store_dwordx2 v[200:201], v7, s[4:7], s31 offen sc1
    s_add_u32 s31, s31, 49152
    s_add_u32 s29, s39, 0x19000
    s_add_u32 s99, s37, 0x191e000
    buffer_load_dwordx4 a[8:11], v252, s[4:7], s99 offen offset:0 sc1
    s_add_u32 s80, s26, 1
    s_and_b32 s80, s80, 3
    s_mul_i32 s12, s80, 49152
    s_mul_i32 s80, s80, 15360
    v_add_u32 v8, s80, v252
    s_add_u32 s80, s26, 2
    s_and_b32 s80, s80, 3
    s_mul_i32 s13, s80, 49152
    s_mul_i32 s80, s80, 15360
    v_add_u32 v9, s80, v252
    s_add_u32 s99, s34, 0x1922000
    buffer_load_dwordx4 a[12:15], v252, s[4:7], s99 offen offset:0 sc1
    s_add_u32 s80, s26, 3
    s_and_b32 s80, s80, 3
    s_mul_i32 s14, s80, 49152
    s_mul_i32 s80, s80, 15360
    v_add_u32 v10, s80, v252
    s_add_u32 s80, s26, 4
    s_and_b32 s80, s80, 3
    s_mul_i32 s15, s80, 49152
    s_mul_i32 s80, s80, 15360
    v_add_u32 v11, s80, v252
    buffer_load_dwordx4 a[16:19], v252, s[4:7], s99 offen offset:1024 sc1
    buffer_load_dwordx4 a[20:23], v252, s[4:7], s99 offen offset:2048 sc1
    buffer_load_dwordx4 a[24:27], v252, s[4:7], s99 offen offset:3072 sc1
    s_add_u32 s99, s34, 0x1923000
    buffer_load_dwordx4 a[28:31], v252, s[4:7], s99 offen offset:0 sc1
    s_add_u32 s99, s35, 0x1922000
    buffer_load_dwordx4 a[32:35], v252, s[4:7], s99 offen offset:0 sc1
    buffer_load_dwordx4 a[36:39], v252, s[4:7], s99 offen offset:1024 sc1
    buffer_load_dwordx4 a[40:43], v252, s[4:7], s99 offen offset:2048 sc1
    buffer_load_dwordx4 a[44:47], v252, s[4:7], s99 offen offset:3072 sc1
    s_add_u32 s99, s35, 0x1923000
    buffer_load_dwordx4 a[48:51], v252, s[4:7], s99 offen offset:0 sc1
    s_waitcnt vmcnt(11)
    s_barrier
    s_cmp_lg_u32 s26, 0
    s_cbranch_scc1 L_sig_33
    s_mov_b64 exec, 1
    buffer_store_dword v254, off, s[4:7], s29 sc1
    s_mov_b64 exec, -1
L_sig_33:
    ds_read_b128 a[172:175], v17 offset:0
    ds_read_b128 a[176:179], v17 offset:1024
    s_add_u32 s99, s36, 0x1922000
    buffer_load_dwordx4 a[52:55], v252, s[4:7], s99 offen offset:0 sc1
    ds_read_b128 a[180:183], v17 offset:2048
    ds_read_b128 a[184:187], v17 offset:3072
    ds_read_b128 a[188:191], v17 offset:4096
    buffer_load_dwordx4 a[56:59], v252, s[4:7], s99 offen offset:1024 sc1
    ds_read_b128 a[192:195], v17 offset:5120
    ds_read_b128 a[196:199], v17 offset:6144
    ds_read_b128 a[200:203], v17 offset:7168
    buffer_load_dwordx4 a[60:63], v252, s[4:7], s99 offen offset:2048 sc1
    ds_read_b128 a[204:207], v17 offset:8192
    ds_read_b128 a[208:211], v17 offset:9216
    ds_read_b128 a[212:215], v17 offset:10240
    buffer_load_dwordx4 a[64:67], v252, s[4:7], s99 offen offset:3072 sc1
    ds_read_b128 a[216:219], v17 offset:11264
    ds_read_b128 a[220:223], v17 offset:12288
    ds_read_b128 a[224:227], v17 offset:13312
    s_add_u32 s99, s36, 0x1923000
    buffer_load_dwordx4 a[68:71], v252, s[4:7], s99 offen offset:0 sc1
    ds_read_b128 a[228:231], v17 offset:14336
    ds_read_b128 a[232:235], v17 offset:15360
    ds_read_b128 a[236:239], v17 offset:16384
    s_add_u32 s99, s37, 0x1922000
    buffer_load_dwordx4 a[72:75], v252, s[4:7], s99 offen offset:0 sc1
    v_add_u32 v14, 4096, v252
    v_add_u32 v15, 8192, v252
    v_lshlrev_b32 v220, 16, v22
    v_and_b32 v221, 0xffff0000, v22
    v_lshlrev_b32 v222, 16, v23
    buffer_load_dwordx4 a[76:79], v252, s[4:7], s99 offen offset:1024 sc1
    v_and_b32 v223, 0xffff0000, v23
    v_lshlrev_b32 v224, 16, v24
    v_and_b32 v225, 0xffff0000, v24
    v_lshlrev_b32 v226, 16, v25
    v_and_b32 v227, 0xffff0000, v25
    buffer_load_dwordx4 a[80:83], v252, s[4:7], s99 offen offset:2048 sc1
    v_lshlrev_b32 v228, 16, v26
    v_and_b32 v229, 0xffff0000, v26
    v_lshlrev_b32 v230, 16, v27
    v_and_b32 v231, 0xffff0000, v27
    v_lshlrev_b32 v232, 16, v28
    buffer_load_dwordx4 a[84:87], v252, s[4:7], s99 offen offset:3072 sc1
    v_and_b32 v233, 0xffff0000, v28
    v_lshlrev_b32 v234, 16, v29
    v_and_b32 v235, 0xffff0000, v29
    v_lshlrev_b32 v236, 16, v30
    v_and_b32 v237, 0xffff0000, v30
    s_add_u32 s99, s37, 0x1923000
    buffer_load_dwordx4 a[88:91], v252, s[4:7], s99 offen offset:0 sc1
    v_lshlrev_b32 v238, 16, v31
    v_and_b32 v239, 0xffff0000, v31
    v_lshlrev_b32 v160, 16, v32
    v_and_b32 v161, 0xffff0000, v32
    v_lshlrev_b32 v162, 16, v33
    v_and_b32 v163, 0xffff0000, v33
    v_lshlrev_b32 v164, 16, v34
    v_and_b32 v165, 0xffff0000, v34
    v_lshlrev_b32 v166, 16, v35
    v_and_b32 v167, 0xffff0000, v35
    s_add_u32 s97, s38, 0x19000
    s_buffer_load_dwordx2 s[64:65], s[4:7], s97 glc
    v_lshlrev_b32 v168, 16, v36
    v_and_b32 v169, 0xffff0000, v36
    v_lshlrev_b32 v170, 16, v37
    v_and_b32 v171, 0xffff0000, v37
    v_lshlrev_b32 v172, 16, v38
    v_and_b32 v173, 0xffff0000, v38
    v_lshlrev_b32 v174, 16, v39
    v_and_b32 v175, 0xffff0000, v39
    v_lshlrev_b32 v176, 16, v40
    v_and_b32 v177, 0xffff0000, v40
    v_lshlrev_b32 v178, 16, v41
    v_and_b32 v179, 0xffff0000, v41
    v_pk_add_f32 v[220:221], v[220:221], v[160:161]
    v_pk_add_f32 v[222:223], v[222:223], v[162:163]
    v_pk_add_f32 v[224:225], v[224:225], v[164:165]
    v_pk_add_f32 v[226:227], v[226:227], v[166:167]
    v_pk_add_f32 v[228:229], v[228:229], v[168:169]
    v_pk_add_f32 v[230:231], v[230:231], v[170:171]
    v_pk_add_f32 v[232:233], v[232:233], v[172:173]
    v_pk_add_f32 v[234:235], v[234:235], v[174:175]
    v_pk_add_f32 v[236:237], v[236:237], v[176:177]
    v_pk_add_f32 v[238:239], v[238:239], v[178:179]
    s_mov_b32 s60, 0
    s_branch L_pc_36
L_poll_35:
    s_buffer_load_dwordx2 s[64:65], s[4:7], s97 glc
    s_add_u32 s60, s60, 1
    s_cmp_gt_u32 s60, 400000
    s_cbranch_scc1 L_end
L_pc_36:
    s_waitcnt lgkmcnt(0)
    s_xor_b64 s[64:65], s[64:65], s[56:57]
    s_cbranch_scc1 L_poll_35
L_p1_34:
    s_barrier
    s_add_u32 s27, s12, s20
    buffer_load_dwordx4 a[92:95], v252, s[4:7], s27 offen sc1
    s_add_u32 s27, s12, s21
    buffer_load_dwordx4 a[96:99], v252, s[4:7], s27 offen sc1
    s_add_u32 s27, s12, s22
    buffer_load_dwordx4 a[100:103], v252, s[4:7], s27 offen sc1
    s_add_u32 s27, s12, s23
    buffer_load_dwordx4 a[104:107], v252, s[4:7], s27 offen sc1
    s_add_u32 s27, s12, s20
    buffer_load_dwordx4 a[108:111], v14, s[4:7], s27 offen sc1
    s_add_u32 s27, s12, s21
    buffer_load_dwordx4 a[112:115], v14, s[4:7], s27 offen sc1
    s_add_u32 s27, s12, s22
    buffer_load_dwordx4 a[116:119], v14, s[4:7], s27 offen sc1
    s_add_u32 s27, s12, s23
    buffer_load_dwordx4 a[120:123], v14, s[4:7], s27 offen sc1
    s_add_u32 s27, s12, s20
    buffer_load_dwordx4 a[124:127], v15, s[4:7], s27 offen sc1
    s_add_u32 s27, s12, s21
    buffer_load_dwordx4 a[128:131], v15, s[4:7], s27 offen sc1
    s_add_u32 s27, s12, s22
    buffer_load_dwordx4 a[132:135], v15, s[4:7], s27 offen sc1
    s_waitcnt lgkmcnt(0)
    s_waitcnt vmcnt(10)
    v_mfma_f32_16x16x32_bf16 v[160:163], v[96:99], a[92:95], 0
    v_mfma_f32_16x16x32_bf16 v[164:167], v[100:103], a[92:95], 0
    s_add_u32 s27, s12, s23
    buffer_load_dwordx4 a[136:139], v15, s[4:7], s27 offen sc1
    v_mfma_f32_16x16x32_bf16 v[168:171], v[104:107], a[92:95], 0
    s_mul_i32 s28, s25, 160
    v_mfma_f32_16x16x32_bf16 v[172:175], v[108:111], a[92:95], 0
    v_mfma_f32_16x16x32_bf16 v[176:179], v[112:115], a[92:95], 0
    s_add_u32 s28, s28, s43
    s_waitcnt vmcnt(10)
    v_mfma_f32_16x16x32_bf16 v[160:163], v[116:119], a[96:99], v[160:163]
    v_mfma_f32_16x16x32_bf16 v[164:167], v[120:123], a[96:99], v[164:167]
    s_add_u32 s27, s13, s20
    buffer_load_dwordx4 a[140:143], v252, s[4:7], s27 offen sc1
    v_mfma_f32_16x16x32_bf16 v[168:171], v[124:127], a[96:99], v[168:171]
    v_and_b32 v47, 15, v1
    v_mfma_f32_16x16x32_bf16 v[172:175], v[128:131], a[96:99], v[172:175]
    v_mfma_f32_16x16x32_bf16 v[176:179], v[132:135], a[96:99], v[176:179]
    v_mul_u32_u24 v47, 1120, v47
    s_waitcnt vmcnt(10)
    v_mfma_f32_16x16x32_bf16 v[160:163], v[136:139], a[100:103], v[160:163]
    v_mfma_f32_16x16x32_bf16 v[164:167], v[140:143], a[100:103], v[164:167]
    s_add_u32 s27, s13, s21
    buffer_load_dwordx4 a[144:147], v252, s[4:7], s27 offen sc1
    v_mfma_f32_16x16x32_bf16 v[168:171], v[144:147], a[100:103], v[168:171]
    v_add_u32 v47, s28, v47
    v_mfma_f32_16x16x32_bf16 v[172:175], v[148:151], a[100:103], v[172:175]
    v_mfma_f32_16x16x32_bf16 v[176:179], v[152:155], a[100:103], v[176:179]
    v_subrev_u32 v47, s49, v47
    s_waitcnt vmcnt(10)
    v_mfma_f32_16x16x32_bf16 v[160:163], v[156:159], a[104:107], v[160:163]
    v_mfma_f32_16x16x32_bf16 v[164:167], a[240:243], a[104:107], v[164:167]
    s_add_u32 s27, s13, s22
    buffer_load_dwordx4 a[148:151], v252, s[4:7], s27 offen sc1
    v_mfma_f32_16x16x32_bf16 v[168:171], a[244:247], a[104:107], v[168:171]
    v_sub_u32 v42, v2, v47
    v_mfma_f32_16x16x32_bf16 v[172:175], a[248:251], a[104:107], v[172:175]
    v_mfma_f32_16x16x32_bf16 v[176:179], a[252:255], a[104:107], v[176:179]
    v_sub_u32 v43, v3, v47
    s_waitcnt vmcnt(10)
    v_mfma_f32_16x16x32_bf16 v[160:163], a[172:175], a[108:111], v[160:163]
    v_mfma_f32_16x16x32_bf16 v[164:167], a[176:179], a[108:111], v[164:167]
    s_add_u32 s27, s13, s23
    buffer_load_dwordx4 a[152:155], v252, s[4:7], s27 offen sc1
    v_mfma_f32_16x16x32_bf16 v[168:171], a[180:183], a[108:111], v[168:171]
    v_mov_b32 v48, 0x40000000
    v_mfma_f32_16x16x32_bf16 v[172:175], a[184:187], a[108:111], v[172:175]
    v_mfma_f32_16x16x32_bf16 v[176:179], a[188:191], a[108:111], v[176:179]
    v_add_u32 v47, 0, v1
    s_waitcnt vmcnt(10)
    v_mfma_f32_16x16x32_bf16 v[160:163], a[192:195], a[112:115], v[160:163]
    v_mfma_f32_16x16x32_bf16 v[164:167], a[196:199], a[112:115], v[164:167]
    s_add_u32 s27, s13, s20
    buffer_load_dwordx4 a[156:159], v14, s[4:7], s27 offen sc1
    v_mfma_f32_16x16x32_bf16 v[168:171], a[200:203], a[112:115], v[168:171]
    v_mul_u32_u24 v44, 6554, v47
    v_mfma_f32_16x16x32_bf16 v[172:175], a[204:207], a[112:115], v[172:175]
    v_mfma_f32_16x16x32_bf16 v[176:179], a[208:211], a[112:115], v[176:179]
    v_lshrrev_b32 v44, 16, v44
    s_waitcnt vmcnt(10)
    v_mfma_f32_16x16x32_bf16 v[160:163], a[212:215], a[116:119], v[160:163]
    v_mfma_f32_16x16x32_bf16 v[164:167], a[216:219], a[116:119], v[164:167]
    s_add_u32 s27, s13, s21
    buffer_load_dwordx4 a[160:163], v14, s[4:7], s27 offen sc1
    v_mfma_f32_16x16x32_bf16 v[168:171], a[220:223], a[116:119], v[168:171]
    v_mul_u32_u24 v44, 1120, v44
    v_mfma_f32_16x16x32_bf16 v[172:175], a[224:227], a[116:119], v[172:175]
    v_mfma_f32_16x16x32_bf16 v[176:179], a[228:231], a[116:119], v[176:179]
    v_lshl_add_u32 v44, v47, 4, v44
    s_waitcnt vmcnt(10)
    v_mfma_f32_16x16x32_bf16 v[160:163], a[232:235], a[120:123], v[160:163]
    v_mfma_f32_16x16x32_bf16 v[164:167], a[236:239], a[120:123], v[164:167]
    s_add_u32 s27, s13, s22
    buffer_load_dwordx4 a[164:167], v14, s[4:7], s27 offen sc1
    v_mfma_f32_16x16x32_bf16 v[168:171], a[0:3], a[120:123], v[168:171]
    v_add_u32 v47, 64, v1
    v_mfma_f32_16x16x32_bf16 v[172:175], a[4:7], a[120:123], v[172:175]
    v_mfma_f32_16x16x32_bf16 v[176:179], a[8:11], a[120:123], v[176:179]
    v_mul_u32_u24 v45, 6554, v47
    s_waitcnt vmcnt(10)
    v_mfma_f32_16x16x32_bf16 v[160:163], a[12:15], a[124:127], v[160:163]
    v_mfma_f32_16x16x32_bf16 v[164:167], a[16:19], a[124:127], v[164:167]
    s_add_u32 s27, s13, s23
    buffer_load_dwordx4 a[168:171], v14, s[4:7], s27 offen sc1
    v_mfma_f32_16x16x32_bf16 v[168:171], a[20:23], a[124:127], v[168:171]
    v_lshrrev_b32 v45, 16, v45
    v_mfma_f32_16x16x32_bf16 v[172:175], a[24:27], a[124:127], v[172:175]
    v_mfma_f32_16x16x32_bf16 v[176:179], a[28:31], a[124:127], v[176:179]
    v_mul_u32_u24 v45, 1120, v45
    s_waitcnt vmcnt(10)
    v_mfma_f32_16x16x32_bf16 v[160:163], a[32:35], a[128:131], v[160:163]
    v_mfma_f32_16x16x32_bf16 v[164:167], a[36:39], a[128:131], v[164:167]
    s_add_u32 s27, s13, s20
    buffer_load_dwordx4 v[64:67], v15, s[4:7], s27 offen sc1
    v_mfma_f32_16x16x32_bf16 v[168:171], a[40:43], a[128:131], v[168:171]
    v_lshl_add_u32 v45, v47, 4, v45
    v_mfma_f32_16x16x32_bf16 v[172:175], a[44:47], a[128:131], v[172:175]
    v_mfma_f32_16x16x32_bf16 v[176:179], a[48:51], a[128:131], v[176:179]
    v_add_u32 v47, 128, v1
    s_waitcnt vmcnt(10)
    v_mfma_f32_16x16x32_bf16 v[160:163], a[52:55], a[132:135], v[160:163]
    v_mfma_f32_16x16x32_bf16 v[164:167], a[56:59], a[132:135], v[164:167]
    s_add_u32 s27, s13, s21
    buffer_load_dwordx4 v[68:71], v15, s[4:7], s27 offen sc1
    v_mfma_f32_16x16x32_bf16 v[168:171], a[60:63], a[132:135], v[168:171]
    v_mul_u32_u24 v46, 6554, v47
    v_mfma_f32_16x16x32_bf16 v[172:175], a[64:67], a[132:135], v[172:175]
    v_mfma_f32_16x16x32_bf16 v[176:179], a[68:71], a[132:135], v[176:179]
    v_lshrrev_b32 v46, 16, v46
    s_waitcnt vmcnt(10)
    v_mfma_f32_16x16x32_bf16 v[160:163], a[72:75], a[136:139], v[160:163]
    v_mfma_f32_16x16x32_bf16 v[164:167], a[76:79], a[136:139], v[164:167]
    s_add_u32 s27, s13, s22
    buffer_load_dwordx4 v[72:75], v15, s[4:7], s27 offen sc1
    v_mfma_f32_16x16x32_bf16 v[168:171], a[80:83], a[136:139], v[168:171]
    v_mul_u32_u24 v46, 1120, v46
    v_mfma_f32_16x16x32_bf16 v[172:175], a[84:87], a[136:139], v[172:175]
    v_mfma_f32_16x16x32_bf16 v[176:179], a[88:91], a[136:139], v[176:179]
    v_lshl_add_u32 v46, v47, 4, v46
    s_waitcnt vmcnt(10)
    v_mfma_f32_16x16x32_bf16 v[180:183], v[96:99], a[140:143], 0
    v_mfma_f32_16x16x32_bf16 v[184:187], v[100:103], a[140:143], 0
    s_add_u32 s27, s13, s23
    buffer_load_dwordx4 v[76:79], v15, s[4:7], s27 offen sc1
    v_mfma_f32_16x16x32_bf16 v[188:191], v[104:107], a[140:143], 0
    v_cndmask_b32 v46, v46, v48, s[58:59]
    v_mfma_f32_16x16x32_bf16 v[192:195], v[108:111], a[140:143], 0
    v_mfma_f32_16x16x32_bf16 v[196:199], v[112:115], a[140:143], 0
    s_waitcnt vmcnt(10)
    v_mfma_f32_16x16x32_bf16 v[180:183], v[116:119], a[144:147], v[180:183]
    v_mfma_f32_16x16x32_bf16 v[184:187], v[120:123], a[144:147], v[184:187]
    s_add_u32 s27, s14, s20
    buffer_load_dwordx4 v[80:83], v252, s[4:7], s27 offen sc1
    v_mfma_f32_16x16x32_bf16 v[188:191], v[124:127], a[144:147], v[188:191]
    v_mfma_f32_16x16x32_bf16 v[192:195], v[128:131], a[144:147], v[192:195]
    ds_write_b128 v8, v[160:163] offset:0
    v_mfma_f32_16x16x32_bf16 v[196:199], v[132:135], a[144:147], v[196:199]
    s_waitcnt vmcnt(10)
    v_mfma_f32_16x16x32_bf16 v[180:183], v[136:139], a[148:151], v[180:183]
    v_mfma_f32_16x16x32_bf16 v[184:187], v[140:143], a[148:151], v[184:187]
    s_add_u32 s27, s14, s21
    buffer_load_dwordx4 v[84:87], v252, s[4:7], s27 offen sc1
    v_mfma_f32_16x16x32_bf16 v[188:191], v[144:147], a[148:151], v[188:191]
    v_mfma_f32_16x16x32_bf16 v[192:195], v[148:151], a[148:151], v[192:195]
    ds_write_b128 v8, v[164:167] offset:1024
    v_mfma_f32_16x16x32_bf16 v[196:199], v[152:155], a[148:151], v[196:199]
    s_waitcnt vmcnt(10)
    v_mfma_f32_16x16x32_bf16 v[180:183], v[156:159], a[152:155], v[180:183]
    v_mfma_f32_16x16x32_bf16 v[184:187], a[240:243], a[152:155], v[184:187]
    s_add_u32 s27, s14, s22
    buffer_load_dwordx4 v[88:91], v252, s[4:7], s27 offen sc1
    v_mfma_f32_16x16x32_bf16 v[188:191], a[244:247], a[152:155], v[188:191]
    v_mfma_f32_16x16x32_bf16 v[192:195], a[248:251], a[152:155], v[192:195]
    ds_write_b128 v8, v[168:171] offset:2048
    v_mfma_f32_16x16x32_bf16 v[196:199], a[252:255], a[152:155], v[196:199]
    s_waitcnt vmcnt(10)
    v_mfma_f32_16x16x32_bf16 v[180:183], a[172:175], a[156:159], v[180:183]
    v_mfma_f32_16x16x32_bf16 v[184:187], a[176:179], a[156:159], v[184:187]
    s_add_u32 s27, s14, s23
    buffer_load_dwordx4 v[92:95], v252, s[4:7], s27 offen sc1
    v_mfma_f32_16x16x32_bf16 v[188:191], a[180:183], a[156:159], v[188:191]
    v_mfma_f32_16x16x32_bf16 v[192:195], a[184:187], a[156:159], v[192:195]
    ds_write_b128 v8, v[172:175] offset:3072
    v_mfma_f32_16x16x32_bf16 v[196:199], a[188:191], a[156:159], v[196:199]
    s_waitcnt vmcnt(10)
    v_mfma_f32_16x16x32_bf16 v[180:183], a[192:195], a[160:163], v[180:183]
    v_mfma_f32_16x16x32_bf16 v[184:187], a[196:199], a[160:163], v[184:187]
    s_add_u32 s27, s14, s20
    buffer_load_dwordx4 a[92:95], v14, s[4:7], s27 offen sc1
    v_mfma_f32_16x16x32_bf16 v[188:191], a[200:203], a[160:163], v[188:191]
    v_mfma_f32_16x16x32_bf16 v[192:195], a[204:207], a[160:163], v[192:195]
    ds_write_b128 v8, v[176:179] offset:4096
    v_mfma_f32_16x16x32_bf16 v[196:199], a[208:211], a[160:163], v[196:199]
    s_waitcnt vmcnt(10)
    v_mfma_f32_16x16x32_bf16 v[180:183], a[212:215], a[164:167], v[180:183]
    v_mfma_f32_16x16x32_bf16 v[184:187], a[216:219], a[164:167], v[184:187]
    s_add_u32 s27, s14, s21
    buffer_load_dwordx4 a[96:99], v14, s[4:7], s27 offen sc1
    v_mfma_f32_16x16x32_bf16 v[188:191], a[220:223], a[164:167], v[188:191]
    v_mfma_f32_16x16x32_bf16 v[192:195], a[224:227], a[164:167], v[192:195]
    v_mfma_f32_16x16x32_bf16 v[196:199], a[228:231], a[164:167], v[196:199]
    s_waitcnt vmcnt(10)
    v_mfma_f32_16x16x32_bf16 v[180:183], a[232:235], a[168:171], v[180:183]
    v_mfma_f32_16x16x32_bf16 v[184:187], a[236:239], a[168:171], v[184:187]
    s_add_u32 s27, s14, s22
    buffer_load_dwordx4 a[100:103], v14, s[4:7], s27 offen sc1
    v_mfma_f32_16x16x32_bf16 v[188:191], a[0:3], a[168:171], v[188:191]
    v_mfma_f32_16x16x32_bf16 v[192:195], a[4:7], a[168:171], v[192:195]
    v_mfma_f32_16x16x32_bf16 v[196:199], a[8:11], a[168:171], v[196:199]
    s_waitcnt vmcnt(10)
    v_mfma_f32_16x16x32_bf16 v[180:183], a[12:15], v[64:67], v[180:183]
    v_mfma_f32_16x16x32_bf16 v[184:187], a[16:19], v[64:67], v[184:187]
    s_add_u32 s27, s14, s23
    buffer_load_dwordx4 a[104:107], v14, s[4:7], s27 offen sc1
    v_mfma_f32_16x16x32_bf16 v[188:191], a[20:23], v[64:67], v[188:191]
    v_mfma_f32_16x16x32_bf16 v[192:195], a[24:27], v[64:67], v[192:195]
    v_mfma_f32_16x16x32_bf16 v[196:199], a[28:31], v[64:67], v[196:199]
    s_waitcnt vmcnt(10)
    v_mfma_f32_16x16x32_bf16 v[180:183], a[32:35], v[68:71], v[180:183]
    v_mfma_f32_16x16x32_bf16 v[184:187], a[36:39], v[68:71], v[184:187]
    s_add_u32 s27, s14, s20
    buffer_load_dwordx4 a[108:111], v15, s[4:7], s27 offen sc1
    v_mfma_f32_16x16x32_bf16 v[188:191], a[40:43], v[68:71], v[188:191]
    v_mfma_f32_16x16x32_bf16 v[192:195], a[44:47], v[68:71], v[192:195]
    v_mfma_f32_16x16x32_bf16 v[196:199], a[48:51], v[68:71], v[196:199]
    s_waitcnt vmcnt(10)
    v_mfma_f32_16x16x32_bf16 v[180:183], a[52:55], v[72:75], v[180:183]
    v_mfma_f32_16x16x32_bf16 v[184:187], a[56:59], v[72:75], v[184:187]
    s_add_u32 s27, s14, s21
    buffer_load_dwordx4 a[112:115], v15, s[4:7], s27 offen sc1
    v_mfma_f32_16x16x32_bf16 v[188:191], a[60:63], v[72:75], v[188:191]
    v_mfma_f32_16x16x32_bf16 v[192:195], a[64:67], v[72:75], v[192:195]
    v_mfma_f32_16x16x32_bf16 v[196:199], a[68:71], v[72:75], v[196:199]
    s_waitcnt vmcnt(10)
    v_mfma_f32_16x16x32_bf16 v[180:183], a[72:75], v[76:79], v[180:183]
    v_mfma_f32_16x16x32_bf16 v[184:187], a[76:79], v[76:79], v[184:187]
    s_add_u32 s27, s14, s22
    buffer_load_dwordx4 a[116:119], v15, s[4:7], s27 offen sc1
    v_mfma_f32_16x16x32_bf16 v[188:191], a[80:83], v[76:79], v[188:191]
    v_mfma_f32_16x16x32_bf16 v[192:195], a[84:87], v[76:79], v[192:195]
    v_mfma_f32_16x16x32_bf16 v[196:199], a[88:91], v[76:79], v[196:199]
    s_waitcnt vmcnt(10)
    v_mfma_f32_16x16x32_bf16 v[200:203], v[96:99], v[80:83], 0
    v_mfma_f32_16x16x32_bf16 v[204:207], v[100:103], v[80:83], 0
    s_add_u32 s27, s14, s23
    buffer_load_dwordx4 a[120:123], v15, s[4:7], s27 offen sc1
    v_mfma_f32_16x16x32_bf16 v[208:211], v[104:107], v[80:83], 0
    v_mfma_f32_16x16x32_bf16 v[212:215], v[108:111], v[80:83], 0
    v_mfma_f32_16x16x32_bf16 v[216:219], v[112:115], v[80:83], 0
    s_waitcnt vmcnt(10)
    v_mfma_f32_16x16x32_bf16 v[200:203], v[116:119], v[84:87], v[200:203]
    v_mfma_f32_16x16x32_bf16 v[204:207], v[120:123], v[84:87], v[204:207]
    s_add_u32 s27, s15, s20
    buffer_load_dwordx4 a[124:127], v252, s[4:7], s27 offen sc1
    v_mfma_f32_16x16x32_bf16 v[208:211], v[124:127], v[84:87], v[208:211]
    v_mfma_f32_16x16x32_bf16 v[212:215], v[128:131], v[84:87], v[212:215]
    ds_write_b128 v9, v[180:183] offset:5120
    v_mfma_f32_16x16x32_bf16 v[216:219], v[132:135], v[84:87], v[216:219]
    s_waitcnt vmcnt(10)
    v_mfma_f32_16x16x32_bf16 v[200:203], v[136:139], v[88:91], v[200:203]
    v_mfma_f32_16x16x32_bf16 v[204:207], v[140:143], v[88:91], v[204:207]
    s_add_u32 s27, s15, s21
    buffer_load_dwordx4 a[128:131], v252, s[4:7], s27 offen sc1
    v_mfma_f32_16x16x32_bf16 v[208:211], v[144:147], v[88:91], v[208:211]
    v_mfma_f32_16x16x32_bf16 v[212:215], v[148:151], v[88:91], v[212:215]
    ds_write_b128 v9, v[184:187] offset:6144
    v_mfma_f32_16x16x32_bf16 v[216:219], v[152:155], v[88:91], v[216:219]
    s_waitcnt vmcnt(10)
    v_mfma_f32_16x16x32_bf16 v[200:203], v[156:159], v[92:95], v[200:203]
    v_mfma_f32_16x16x32_bf16 v[204:207], a[240:243], v[92:95], v[204:207]
    s_add_u32 s27, s15, s22
    buffer_load_dwordx4 a[132:135], v252, s[4:7], s27 offen sc1
    v_mfma_f32_16x16x32_bf16 v[208:211], a[244:247], v[92:95], v[208:211]
    v_mfma_f32_16x16x32_bf16 v[212:215], a[248:251], v[92:95], v[212:215]
    ds_write_b128 v9, v[188:191] offset:7168
    v_mfma_f32_16x16x32_bf16 v[216:219], a[252:255], v[92:95], v[216:219]
    s_waitcnt vmcnt(10)
    v_mfma_f32_16x16x32_bf16 v[200:203], a[172:175], a[92:95], v[200:203]
    v_mfma_f32_16x16x32_bf16 v[204:207], a[176:179], a[92:95], v[204:207]
    s_add_u32 s27, s15, s23
    buffer_load_dwordx4 a[136:139], v252, s[4:7], s27 offen sc1
    v_mfma_f32_16x16x32_bf16 v[208:211], a[180:183], a[92:95], v[208:211]
    v_mfma_f32_16x16x32_bf16 v[212:215], a[184:187], a[92:95], v[212:215]
    ds_write_b128 v9, v[192:195] offset:8192
    v_mfma_f32_16x16x32_bf16 v[216:219], a[188:191], a[92:95], v[216:219]
    s_waitcnt vmcnt(10)
    v_mfma_f32_16x16x32_bf16 v[200:203], a[192:195], a[96:99], v[200:203]
    v_mfma_f32_16x16x32_bf16 v[204:207], a[196:199], a[96:99], v[204:207]
    s_add_u32 s27, s15, s20
    buffer_load_dwordx4 a[140:143], v14, s[4:7], s27 offen sc1
    v_mfma_f32_16x16x32_bf16 v[208:211], a[200:203], a[96:99], v[208:211]
    v_mfma_f32_16x16x32_bf16 v[212:215], a[204:207], a[96:99], v[212:215]
    ds_write_b128 v9, v[196:199] offset:9216
    v_mfma_f32_16x16x32_bf16 v[216:219], a[208:211], a[96:99], v[216:219]
    s_waitcnt vmcnt(10)
    v_mfma_f32_16x16x32_bf16 v[200:203], a[212:215], a[100:103], v[200:203]
    v_mfma_f32_16x16x32_bf16 v[204:207], a[216:219], a[100:103], v[204:207]
    s_add_u32 s27, s15, s21
    buffer_load_dwordx4 a[144:147], v14, s[4:7], s27 offen sc1
    v_mfma_f32_16x16x32_bf16 v[208:211], a[220:223], a[100:103], v[208:211]
    v_mfma_f32_16x16x32_bf16 v[212:215], a[224:227], a[100:103], v[212:215]
    v_mfma_f32_16x16x32_bf16 v[216:219], a[228:231], a[100:103], v[216:219]
    s_waitcnt vmcnt(10)
    v_mfma_f32_16x16x32_bf16 v[200:203], a[232:235], a[104:107], v[200:203]
    v_mfma_f32_16x16x32_bf16 v[204:207], a[236:239], a[104:107], v[204:207]
    s_add_u32 s27, s15, s22
    buffer_load_dwordx4 a[148:151], v14, s[4:7], s27 offen sc1
    v_mfma_f32_16x16x32_bf16 v[208:211], a[0:3], a[104:107], v[208:211]
    v_mfma_f32_16x16x32_bf16 v[212:215], a[4:7], a[104:107], v[212:215]
    v_mfma_f32_16x16x32_bf16 v[216:219], a[8:11], a[104:107], v[216:219]
    s_waitcnt vmcnt(10)
    v_mfma_f32_16x16x32_bf16 v[200:203], a[12:15], a[108:111], v[200:203]
    v_mfma_f32_16x16x32_bf16 v[204:207], a[16:19], a[108:111], v[204:207]
    s_add_u32 s27, s15, s23
    buffer_load_dwordx4 a[152:155], v14, s[4:7], s27 offen sc1
    v_mfma_f32_16x16x32_bf16 v[208:211], a[20:23], a[108:111], v[208:211]
    v_mfma_f32_16x16x32_bf16 v[212:215], a[24:27], a[108:111], v[212:215]
    v_mfma_f32_16x16x32_bf16 v[216:219], a[28:31], a[108:111], v[216:219]
    s_waitcnt vmcnt(10)
    v_mfma_f32_16x16x32_bf16 v[200:203], a[32:35], a[112:115], v[200:203]
    v_mfma_f32_16x16x32_bf16 v[204:207], a[36:39], a[112:115], v[204:207]
    s_add_u32 s27, s15, s20
    buffer_load_dwordx4 a[156:159], v15, s[4:7], s27 offen sc1
    v_mfma_f32_16x16x32_bf16 v[208:211], a[40:43], a[112:115], v[208:211]
    v_mfma_f32_16x16x32_bf16 v[212:215], a[44:47], a[112:115], v[212:215]
    v_mfma_f32_16x16x32_bf16 v[216:219], a[48:51], a[112:115], v[216:219]
    s_waitcnt vmcnt(10)
    v_mfma_f32_16x16x32_bf16 v[200:203], a[52:55], a[116:119], v[200:203]
    v_mfma_f32_16x16x32_bf16 v[204:207], a[56:59], a[116:119], v[204:207]
    s_add_u32 s27, s15, s21
    buffer_load_dwordx4 a[160:163], v15, s[4:7], s27 offen sc1
    v_mfma_f32_16x16x32_bf16 v[208:211], a[60:63], a[116:119], v[208:211]
    v_mfma_f32_16x16x32_bf16 v[212:215], a[64:67], a[116:119], v[212:215]
    v_mfma_f32_16x16x32_bf16 v[216:219], a[68:71], a[116:119], v[216:219]
    s_waitcnt vmcnt(10)
    v_mfma_f32_16x16x32_bf16 v[200:203], a[72:75], a[120:123], v[200:203]
    v_mfma_f32_16x16x32_bf16 v[204:207], a[76:79], a[120:123], v[204:207]
    s_add_u32 s27, s15, s22
    buffer_load_dwordx4 a[164:167], v15, s[4:7], s27 offen sc1
    v_mfma_f32_16x16x32_bf16 v[208:211], a[80:83], a[120:123], v[208:211]
    v_mfma_f32_16x16x32_bf16 v[212:215], a[84:87], a[120:123], v[212:215]
    v_mfma_f32_16x16x32_bf16 v[216:219], a[88:91], a[120:123], v[216:219]
    s_waitcnt vmcnt(10)
    v_mfma_f32_16x16x32_bf16 v[220:223], v[96:99], a[124:127], v[220:223]
    v_mfma_f32_16x16x32_bf16 v[224:227], v[100:103], a[124:127], v[224:227]
    s_add_u32 s27, s15, s23
    buffer_load_dwordx4 a[168:171], v15, s[4:7], s27 offen sc1
    v_mfma_f32_16x16x32_bf16 v[228:231], v[104:107], a[124:127], v[228:231]
    v_mfma_f32_16x16x32_bf16 v[232:235], v[108:111], a[124:127], v[232:235]
    v_mfma_f32_16x16x32_bf16 v[236:239], v[112:115], a[124:127], v[236:239]
    s_waitcnt vmcnt(10)
    v_mfma_f32_16x16x32_bf16 v[220:223], v[116:119], a[128:131], v[220:223]
    v_mfma_f32_16x16x32_bf16 v[224:227], v[120:123], a[128:131], v[224:227]
    v_mfma_f32_16x16x32_bf16 v[228:231], v[124:127], a[128:131], v[228:231]
    v_mfma_f32_16x16x32_bf16 v[232:235], v[128:131], a[128:131], v[232:235]
    ds_write_b128 v10, v[200:203] offset:10240
    v_mfma_f32_16x16x32_bf16 v[236:239], v[132:135], a[128:131], v[236:239]
    s_waitcnt vmcnt(9)
    v_mfma_f32_16x16x32_bf16 v[220:223], v[136:139], a[132:135], v[220:223]
    v_mfma_f32_16x16x32_bf16 v[224:227], v[140:143], a[132:135], v[224:227]
    v_mfma_f32_16x16x32_bf16 v[228:231], v[144:147], a[132:135], v[228:231]
    v_mfma_f32_16x16x32_bf16 v[232:235], v[148:151], a[132:135], v[232:235]
    ds_write_b128 v10, v[204:207] offset:11264
    v_mfma_f32_16x16x32_bf16 v[236:239], v[152:155], a[132:135], v[236:239]
    s_waitcnt vmcnt(8)
    v_mfma_f32_16x16x32_bf16 v[220:223], v[156:159], a[136:139], v[220:223]
    v_mfma_f32_16x16x32_bf16 v[224:227], a[240:243], a[136:139], v[224:227]
    v_mfma_f32_16x16x32_bf16 v[228:231], a[244:247], a[136:139], v[228:231]
    v_mfma_f32_16x16x32_bf16 v[232:235], a[248:251], a[136:139], v[232:235]
    ds_write_b128 v10, v[208:211] offset:12288
    v_mfma_f32_16x16x32_bf16 v[236:239], a[252:255], a[136:139], v[236:239]
    s_waitcnt vmcnt(7)
    v_mfma_f32_16x16x32_bf16 v[220:223], a[172:175], a[140:143], v[220:223]
    v_mfma_f32_16x16x32_bf16 v[224:227], a[176:179], a[140:143], v[224:227]
    v_mfma_f32_16x16x32_bf16 v[228:231], a[180:183], a[140:143], v[228:231]
    v_mfma_f32_16x16x32_bf16 v[232:235], a[184:187], a[140:143], v[232:235]
    ds_write_b128 v10, v[212:215] offset:13312
    v_mfma_f32_16x16x32_bf16 v[236:239], a[188:191], a[140:143], v[236:239]
    s_waitcnt vmcnt(6)
    v_mfma_f32_16x16x32_bf16 v[220:223], a[192:195], a[144:147], v[220:223]
    v_mfma_f32_16x16x32_bf16 v[224:227], a[196:199], a[144:147], v[224:227]
    v_mfma_f32_16x16x32_bf16 v[228:231], a[200:203], a[144:147], v[228:231]
    v_mfma_f32_16x16x32_bf16 v[232:235], a[204:207], a[144:147], v[232:235]
    ds_write_b128 v10, v[216:219] offset:14336
    v_mfma_f32_16x16x32_bf16 v[236:239], a[208:211], a[144:147], v[236:239]
    s_waitcnt vmcnt(5)
    v_mfma_f32_16x16x32_bf16 v[220:223], a[212:215], a[148:151], v[220:223]
    v_mfma_f32_16x16x32_bf16 v[224:227], a[216:219], a[148:151], v[224:227]
    v_mfma_f32_16x16x32_bf16 v[228:231], a[220:223], a[148:151], v[228:231]
    v_mfma_f32_16x16x32_bf16 v[232:235], a[224:227], a[148:151], v[232:235]
    v_mfma_f32_16x16x32_bf16 v[236:239], a[228:231], a[148:151], v[236:239]
    s_waitcnt lgkmcnt(0)
    s_barrier
    s_waitcnt vmcnt(4)
    v_mfma_f32_16x16x32_bf16 v[220:223], a[232:235], a[152:155], v[220:223]
    ds_read_b128 v[160:163], v11 offset:0
    v_mfma_f32_16x16x32_bf16 v[224:227], a[236:239], a[152:155], v[224:227]
    ds_read_b128 v[164:167], v11 offset:1024
    v_mfma_f32_16x16x32_bf16 v[228:231], a[0:3], a[152:155], v[228:231]
    ds_read_b128 v[168:171], v11 offset:2048
    v_mfma_f32_16x16x32_bf16 v[232:235], a[4:7], a[152:155], v[232:235]
    ds_read_b128 v[172:175], v11 offset:3072
    v_mfma_f32_16x16x32_bf16 v[236:239], a[8:11], a[152:155], v[236:239]
    ds_read_b128 v[176:179], v11 offset:4096
    s_waitcnt vmcnt(3)
    v_mfma_f32_16x16x32_bf16 v[220:223], a[12:15], a[156:159], v[220:223]
    ds_read_b128 v[180:183], v11 offset:5120
    v_mfma_f32_16x16x32_bf16 v[224:227], a[16:19], a[156:159], v[224:227]
    ds_read_b128 v[184:187], v11 offset:6144
    v_mfma_f32_16x16x32_bf16 v[228:231], a[20:23], a[156:159], v[228:231]
    ds_read_b128 v[188:191], v11 offset:7168
    v_mfma_f32_16x16x32_bf16 v[232:235], a[24:27], a[156:159], v[232:235]
    ds_read_b128 v[192:195], v11 offset:8192
    v_mfma_f32_16x16x32_bf16 v[236:239], a[28:31], a[156:159], v[236:239]
    ds_read_b128 v[196:199], v11 offset:9216
    s_waitcnt vmcnt(2)
    v_mfma_f32_16x16x32_bf16 v[220:223], a[32:35], a[160:163], v[220:223]
    ds_read_b128 v[200:203], v11 offset:10240
    v_mfma_f32_16x16x32_bf16 v[224:227], a[36:39], a[160:163], v[224:227]
    ds_read_b128 v[204:207], v11 offset:11264
    v_mfma_f32_16x16x32_bf16 v[228:231], a[40:43], a[160:163], v[228:231]
    ds_read_b128 v[208:211], v11 offset:12288
    v_mfma_f32_16x16x32_bf16 v[232:235], a[44:47], a[160:163], v[232:235]
    ds_read_b128 v[212:215], v11 offset:13312
    v_mfma_f32_16x16x32_bf16 v[236:239], a[48:51], a[160:163], v[236:239]
    ds_read_b128 v[216:219], v11 offset:14336
    s_waitcnt vmcnt(1)
    v_mfma_f32_16x16x32_bf16 v[220:223], a[52:55], a[164:167], v[220:223]
    v_mfma_f32_16x16x32_bf16 v[224:227], a[56:59], a[164:167], v[224:227]
    v_mfma_f32_16x16x32_bf16 v[228:231], a[60:63], a[164:167], v[228:231]
    s_waitcnt lgkmcnt(0)
    v_add_f32 v160, v160, v180
    v_add_f32 v161, v161, v181
    v_mfma_f32_16x16x32_bf16 v[232:235], a[64:67], a[164:167], v[232:235]
    v_add_f32 v162, v162, v182
    v_add_f32 v163, v163, v183
    v_mfma_f32_16x16x32_bf16 v[236:239], a[68:71], a[164:167], v[236:239]
    v_add_f32 v164, v164, v184
    v_add_f32 v165, v165, v185
    s_waitcnt vmcnt(0)
    v_mfma_f32_16x16x32_bf16 v[220:223], a[72:75], a[168:171], v[220:223]
    v_add_f32 v166, v166, v186
    v_add_f32 v167, v167, v187
    v_mfma_f32_16x16x32_bf16 v[224:227], a[76:79], a[168:171], v[224:227]
    v_add_f32 v168, v168, v188
    v_add_f32 v169, v169, v189
    v_mfma_f32_16x16x32_bf16 v[228:231], a[80:83], a[168:171], v[228:231]
    v_add_f32 v170, v170, v190
    v_add_f32 v171, v171, v191
    v_mfma_f32_16x16x32_bf16 v[232:235], a[84:87], a[168:171], v[232:235]
    v_add_f32 v172, v172, v192
    v_add_f32 v173, v173, v193
    v_mfma_f32_16x16x32_bf16 v[236:239], a[88:91], a[168:171], v[236:239]
    v_add_f32 v174, v174, v194
    v_add_f32 v175, v175, v195
    v_add_f32 v176, v176, v196
    v_add_f32 v177, v177, v197
    v_add_f32 v178, v178, v198
    v_add_f32 v179, v179, v199
    v_pk_add_f32 v[160:161], v[160:161], v[200:201]
    v_pk_add_f32 v[162:163], v[162:163], v[202:203]
    v_pk_add_f32 v[164:165], v[164:165], v[204:205]
    v_pk_add_f32 v[166:167], v[166:167], v[206:207]
    v_pk_add_f32 v[168:169], v[168:169], v[208:209]
    v_pk_add_f32 v[170:171], v[170:171], v[210:211]
    v_pk_add_f32 v[172:173], v[172:173], v[212:213]
    v_pk_add_f32 v[174:175], v[174:175], v[214:215]
    v_pk_add_f32 v[176:177], v[176:177], v[216:217]
    v_pk_add_f32 v[178:179], v[178:179], v[218:219]
    v_pk_add_f32 v[220:221], v[220:221], v[160:161]
    v_pk_add_f32 v[222:223], v[222:223], v[162:163]
    v_pk_add_f32 v[224:225], v[224:225], v[164:165]
    v_pk_add_f32 v[226:227], v[226:227], v[166:167]
    v_pk_add_f32 v[228:229], v[228:229], v[168:169]
    v_pk_add_f32 v[230:231], v[230:231], v[170:171]
    v_pk_add_f32 v[232:233], v[232:233], v[172:173]
    v_pk_add_f32 v[234:235], v[234:235], v[174:175]
    v_pk_add_f32 v[236:237], v[236:237], v[176:177]
    v_pk_add_f32 v[238:239], v[238:239], v[178:179]
    v_cvt_pk_bf16_f32 v160, v220, v221
    v_cvt_pk_bf16_f32 v161, v222, v223
    v_cvt_pk_bf16_f32 v162, v224, v225
    v_cvt_pk_bf16_f32 v163, v226, v227
    v_cvt_pk_bf16_f32 v164, v228, v229
    v_cvt_pk_bf16_f32 v165, v230, v231
    v_cvt_pk_bf16_f32 v166, v232, v233
    v_cvt_pk_bf16_f32 v167, v234, v235
    v_cvt_pk_bf16_f32 v168, v236, v237
    v_cvt_pk_bf16_f32 v169, v238, v239
    ds_write_b128 v42, v[160:163]
    ds_write_b128 v42, v[164:167] offset:16
    ds_write_b64 v43, v[168:169]
    ds_read_b128 v[172:175], v17 offset:0
    ds_read_b128 v[176:179], v17 offset:1024
    ds_read_b128 v[180:183], v17 offset:2048
    s_waitcnt lgkmcnt(2)
    buffer_store_dwordx4 v[172:175], v44, s[16:19], s28 offen nt
    s_waitcnt lgkmcnt(1)
    buffer_store_dwordx4 v[176:179], v45, s[16:19], s28 offen nt
    s_waitcnt lgkmcnt(0)
    buffer_store_dwordx4 v[180:183], v46, s[16:19], s28 offen nt
L_fin:
    s_or_b32 s27, s2, s26
    s_cmp_lg_u32 s27, 0
    s_cbranch_scc1 L_noep
    s_mov_b64 exec, 1
    buffer_store_dword v254, off, s[4:7], 0 sc1
    s_mov_b64 exec, -1
L_noep:
L_end:
    s_endpgm
L_codeend:
.section .rodata,"a"
.p2align 6
.amdhsa_kernel sequential_preLN__linear_kernel_hedgehog__mixer_s_mlp__prompt_kernel
  .amdhsa_next_free_vgpr 512
  .amdhsa_next_free_sgpr 102
  .amdhsa_accum_offset 256
  .amdhsa_group_segment_fixed_size 0
  .amdhsa_kernarg_size 96
  .amdhsa_user_sgpr_count 2
  .amdhsa_user_sgpr_kernarg_segment_ptr 1
  .amdhsa_system_sgpr_workgroup_id_x 1
.end_amdhsa_kernel
```
